```python
import torch

def _softmax(x, axis=-1):
    return torch.softmax(x, dim=axis)
def _gelu(x):
    return torch.nn.functional.gelu(x, approximate="tanh")
def _silu(x):
    return torch.nn.functional.silu(x)
def _sigmoid(x):
    return torch.sigmoid(x)
def _layernorm(x, axis=-1, eps=1e-5):
    m = x.mean(dim=axis, keepdim=True)
    v = x.var(dim=axis, keepdim=True, unbiased=False)
    return (x - m) / torch.sqrt(v + eps)
def _scatter_add(tgt, idx, src, axis=0):
    return tgt.clone().index_add_(axis, idx, src)
def _segment_sum(src, seg, n):
    out = torch.zeros((n,) + src.shape[1:], dtype=src.dtype)
    return out.index_add_(0, seg, src)
def _pad(x, pw):
    flat = tuple(v for pair in reversed(pw) for v in pair)
    return torch.nn.functional.pad(x, flat)

kernel_name = 'concat_heads__gqa_block_cached__gqa_block_cached__near_ridge'

def setup_inputs():

    _w = (lambda a: (lambda t: t.to(torch.bfloat16) if t.is_floating_point() else t)(torch.as_tensor(a)))
    def _A_setup():
        B, Sq, D = 8, 96, 640
        Hq, Hkv, Sk, Dh = 32, 32, 512, 128
        assert Hq % Hkv == 0, (Hq, Hkv)
        return {
            "x": _w((lambda *s: torch.randn(*s, dtype=torch.bfloat16) * 0.8)(B, Sq, D)),
            "k_cache": _w((lambda *s: torch.randn(*s, dtype=torch.bfloat16) * 0.8)(B, Hkv, Sk, Dh)),
            "v_cache": _w((lambda *s: torch.randn(*s, dtype=torch.bfloat16) * 0.05)(B, Hkv, Sk, Dh)),
            "wq": _w((lambda *s: torch.randn(*s, dtype=torch.bfloat16) * 0.8)(D, Hq * Dh) * (D ** -0.5)),
            "wo": _w((lambda *s: torch.randn(*s, dtype=torch.bfloat16) * 0.05)(Hq * Dh, D) * ((Hq * Dh) ** -0.5)),
        }
    _A_in = _A_setup()

    def _B_setup():
        B, Sq, D = 8, 96, 640
        Hq, Hkv, Sk, Dh = 32, 32, 512, 128
        assert Hq % Hkv == 0, (Hq, Hkv)
        return {
            "x": _w((lambda *s: torch.randn(*s, dtype=torch.bfloat16) * 0.8)(B, Sq, D)),
            "k_cache": _w((lambda *s: torch.randn(*s, dtype=torch.bfloat16) * 0.8)(B, Hkv, Sk, Dh)),
            "v_cache": _w((lambda *s: torch.randn(*s, dtype=torch.bfloat16) * 0.05)(B, Hkv, Sk, Dh)),
            "wq": _w((lambda *s: torch.randn(*s, dtype=torch.bfloat16) * 0.8)(D, Hq * Dh) * (D ** -0.5)),
            "wo": _w((lambda *s: torch.randn(*s, dtype=torch.bfloat16) * 0.05)(Hq * Dh, D) * ((Hq * Dh) ** -0.5)),
        }
    _B_in = _B_setup()

    return {
        "A_x": _A_in["x"],
        "A_k_cache": _A_in["k_cache"],
        "A_v_cache": _A_in["v_cache"],
        "A_wq": _A_in["wq"],
        "A_wo": _A_in["wo"],
        "B_x": _B_in["x"],
        "B_k_cache": _B_in["k_cache"],
        "B_v_cache": _B_in["v_cache"],
        "B_wq": _B_in["wq"],
        "B_wo": _B_in["wo"],
    }

def reference(A_x, A_k_cache, A_v_cache, A_wq, A_wo, B_x, B_k_cache, B_v_cache, B_wq, B_wo):
    def _A_ref(x, k_cache, v_cache, wq, wo):
        B, Sq, D = x.shape
        Hq, Dh = 32, 128
        Hkv = k_cache.shape[1]
        rep = Hq // Hkv
        q = (lambda x, *d: x.permute(*d))((x @ wq).reshape(B, Sq, Hq, Dh), 0, 2, 1, 3)
        k = (lambda x, n, axis: torch.repeat_interleave(x, n, dim=axis))(k_cache, rep, axis=1)
        v = (lambda x, n, axis: torch.repeat_interleave(x, n, dim=axis))(v_cache, rep, axis=1)
        scores = torch.einsum("bhqd,bhkd->bhqk", q, k) * (Dh ** -0.5)
        p = _softmax(scores, axis=-1)
        o = torch.einsum("bhqk,bhkd->bhqd", p, v)
        return (lambda x, *d: x.permute(*d))(o, 0, 2, 1, 3).reshape(B, Sq, Hq * Dh) @ wo

    def _B_ref(x, k_cache, v_cache, wq, wo):
        B, Sq, D = x.shape
        Hq, Dh = 32, 128
        Hkv = k_cache.shape[1]
        rep = Hq // Hkv
        q = (lambda x, *d: x.permute(*d))((x @ wq).reshape(B, Sq, Hq, Dh), 0, 2, 1, 3)
        k = (lambda x, n, axis: torch.repeat_interleave(x, n, dim=axis))(k_cache, rep, axis=1)
        v = (lambda x, n, axis: torch.repeat_interleave(x, n, dim=axis))(v_cache, rep, axis=1)
        scores = torch.einsum("bhqd,bhkd->bhqk", q, k) * (Dh ** -0.5)
        p = _softmax(scores, axis=-1)
        o = torch.einsum("bhqk,bhkd->bhqd", p, v)
        return (lambda x, *d: x.permute(*d))(o, 0, 2, 1, 3).reshape(B, Sq, Hq * Dh) @ wo

    a = _A_ref(A_x, A_k_cache, A_v_cache, A_wq, A_wo)
    b = _B_ref(B_x, B_k_cache, B_v_cache, B_wq, B_wo)
    return torch.concatenate([a, b], axis=-1)
```

```asm
; @launch grid=(256,1,1) block=(256,1,1) lds=163840
.amdgcn_target "amdgcn-amd-amdhsa--gfx950"
.text
.globl concat_heads__gqa_block_cached__gqa_block_cached__near_ridge_kernel
.p2align 8
.type concat_heads__gqa_block_cached__gqa_block_cached__near_ridge_kernel,@function
concat_heads__gqa_block_cached__gqa_block_cached__near_ridge_kernel:
  s_cmp_ge_u32 s2, 256
  s_cbranch_scc1 L_k1_end
  s_and_b32 s3, s2, 7
  s_lshr_b32 s31, s3, 2
  s_mul_i32 s4, s31, 40
  s_add_u32 s4, s0, s4
  s_addc_u32 s5, s1, 0
  s_load_dwordx2 s[8:9], s[4:5], 0
  s_load_dwordx2 s[12:13], s[4:5], 24
  s_load_dwordx2 s[16:17], s[4:5], 8
  s_load_dwordx2 s[20:21], s[4:5], 16
  s_load_dwordx2 s[24:25], s[0:1], 96
  s_load_dwordx2 s[48:49], s[4:5], 32
  s_load_dwordx2 s[52:53], s[0:1], 80
  s_load_dwordx2 s[56:57], s[0:1], 88
  v_lshrrev_b32 v2, 6, v0
  v_and_b32 v1, 63, v0
  v_readfirstlane_b32 s28, v2
  s_and_b32 s3, s3, 3
  s_lshr_b32 s60, s2, 3
  s_lshl_b32 s60, s60, 2
  s_or_b32 s60, s60, s28
  s_cmpk_ge_u32 s60, 128
  s_cbranch_scc1 L_wa_back
  s_mov_b32 s62, 0x8ee53d54
  s_mov_b32 s63, 0x9936000c
  s_mov_b32 s64, 0xac242a42
  s_mov_b32 s65, 0xc7887156
  s_bitcmp1_b32 s60, 6
  s_cselect_b64 s[62:63], s[64:65], s[62:63]
  s_bitcmp1_b64 s[62:63], s60
  s_cselect_b32 s61, 4, 0
  s_cmpk_ge_u32 s60, 3
  s_cselect_b32 s62, 0x1c00, 0
  s_add_u32 s61, s61, s62
  s_mul_i32 s60, s60, 0x100
  s_add_u32 s60, s60, s61
  s_getpc_b64 s[64:65]
L_wa_pc:
  s_add_u32 s60, s60, L_wa_base-L_wa_pc+0x10000
  s_sub_u32 s60, s60, 0x10000
  s_add_u32 s64, s64, s60
  s_addc_u32 s65, s65, 0
  s_mov_b64 exec, 0
  s_setpc_b64 s[64:65]
L_wa_back:
  s_mov_b64 exec, -1
  s_lshr_b32 s6, s2, 3
  s_and_b32 s7, s6, 3
L_ws0:
  s_cbranch_execz L_wa_back
  s_lshr_b32 s32, s6, 2
  s_lshl_b32 s3, s3, 3
  s_lshl_b32 s7, s7, 1
  s_add_u32 s33, s3, s7
  s_and_b32 s29, s28, 1
  s_lshr_b32 s30, s28, 1
  s_mul_i32 s44, s32, 122880
  s_add_u32 s45, s44, 1280
  s_lshl_b32 s46, s33, 8
  s_add_u32 s47, s46, 5242880
  s_add_u32 s4, s32, s7
  s_and_b32 s4, s4, 7
  s_mul_i32 s4, s4, 5
  s_lshr_b32 s4, s4, 2
  s_lshl_b32 s5, s4, 7
  s_add_u32 s34, s44, s5
  s_lshl_b32 s5, s4, 19
  s_add_u32 s35, s46, s5
  s_lshl_b32 s3, s32, 5
  s_add_u32 s3, s3, s33
  s_lshl_b32 s36, s3, 17
  s_lshl_b32 s38, s28, 12
  s_mul_i32 s39, s28, 3072
  s_add_u32 s39, s39, 131072
  v_and_b32 v2, 15, v1
  v_lshrrev_b32 v3, 4, v1
  v_lshrrev_b32 v60, 3, v1
  v_and_b32 v61, 6, v60
  v_and_b32 v62, 7, v1
  v_xor_b32 v61, v61, v62
  v_lshlrev_b32 v61, 4, v61
  v_mul_u32_u24 v60, 1280, v60
  v_add_u32 v60, v60, v61
  s_mul_i32 s3, s28, 30720
  v_add_u32 v10, s3, v60
  v_add_u32 v11, 9216, v10
  v_add_u32 v12, 18432, v10
  v_lshrrev_b32 v62, 5, v1
  v_and_b32 v60, 31, v1
  v_lshlrev_b32 v61, 1, v62
  v_xor_b32 v60, v60, v61
  s_lshl_b32 s3, s29, 3
  v_xor_b32 v60, s3, v60
  v_lshlrev_b32 v60, 4, v60
  v_lshlrev_b32 v61, 13, v62
  s_lshl_b32 s3, s28, 16
  v_add3_u32 v61, v61, s3, v60
  v_mov_b32 v6, v61
  v_xor_b32 v60, 64, v61
  v_add_u32 v7, 15360, v60
  v_add_u32 v8, 30720, v61
L_ws1:
  s_cbranch_execz L_wa_back
  v_add_u32 v9, 46080, v60
  v_lshlrev_b32 v60, 1, v3
  v_xor_b32 v60, v60, v2
  v_lshlrev_b32 v60, 4, v60
  v_lshl_add_u32 v60, v3, 8, v60
  v_add_u32 v4, s38, v60
  v_xor_b32 v5, 128, v4
  s_waitcnt lgkmcnt(0)
  s_and_b32 s9, s9, 0xffff
  s_mov_b32 s10, 983040
  s_mov_b32 s11, 0x00020000
  s_and_b32 s13, s13, 0xffff
  s_mov_b32 s14, 5242880
  s_mov_b32 s15, 0x00020000
  s_and_b32 s17, s17, 0xffff
  s_mov_b32 s18, 33554432
  s_mov_b32 s19, 0x00020000
  s_and_b32 s21, s21, 0xffff
  s_mov_b32 s22, 33554432
  s_mov_b32 s23, 0x00020000
  s_and_b32 s25, s25, 0xffff
  s_mov_b32 s26, 31457280
  s_mov_b32 s27, 0x00020000
  s_add_u32 m0, s39, 0
  s_nop 0
  buffer_load_dwordx4 v10, s[8:11], s34 offen offset:0 lds
  buffer_load_dwordx4 v11, s[8:11], s34 offen offset:1024 lds
  buffer_load_dwordx4 v12, s[8:11], s34 offen offset:2048 lds
  s_add_u32 s34, s34, 128
  s_cmp_eq_u32 s34, s45
  s_cselect_b32 s34, s44, s34
  s_add_u32 m0, s38, 65536
  s_nop 0
  buffer_load_dwordx4 v6, s[12:15], s35 offen offset:0 lds
  buffer_load_dwordx4 v7, s[12:15], s35 offen offset:1024 lds
  buffer_load_dwordx4 v8, s[12:15], s35 offen offset:2048 lds
  buffer_load_dwordx4 v9, s[12:15], s35 offen offset:3072 lds
L_ws2:
  s_cbranch_execz L_wa_back
  s_add_u32 s35, s35, 262144
  s_cmp_eq_u32 s35, s47
  s_cselect_b32 s35, s46, s35
  s_add_u32 m0, s38, 81920
  s_nop 0
  buffer_load_dwordx4 v6, s[12:15], s35 offen offset:0 lds
  buffer_load_dwordx4 v7, s[12:15], s35 offen offset:1024 lds
  buffer_load_dwordx4 v8, s[12:15], s35 offen offset:2048 lds
  buffer_load_dwordx4 v9, s[12:15], s35 offen offset:3072 lds
  s_add_u32 s35, s35, 262144
  s_cmp_eq_u32 s35, s47
  s_cselect_b32 s35, s46, s35
  s_add_u32 m0, s39, 12288
  s_nop 0
  buffer_load_dwordx4 v10, s[8:11], s34 offen offset:0 lds
  buffer_load_dwordx4 v11, s[8:11], s34 offen offset:1024 lds
  buffer_load_dwordx4 v12, s[8:11], s34 offen offset:2048 lds
  s_add_u32 s34, s34, 128
  s_cmp_eq_u32 s34, s45
  s_cselect_b32 s34, s44, s34
  s_add_u32 m0, s38, 98304
  s_nop 0
  buffer_load_dwordx4 v6, s[12:15], s35 offen offset:0 lds
  buffer_load_dwordx4 v7, s[12:15], s35 offen offset:1024 lds
  buffer_load_dwordx4 v8, s[12:15], s35 offen offset:2048 lds
  buffer_load_dwordx4 v9, s[12:15], s35 offen offset:3072 lds
  s_add_u32 s35, s35, 262144
  s_cmp_eq_u32 s35, s47
  s_cselect_b32 s35, s46, s35
  s_and_b32 s49, s49, 0xffff
  s_mov_b32 s50, 5242880
  s_mov_b32 s51, 0x00020000
  s_and_b32 s53, s53, 0xffff
  s_mov_b32 s54, 1966080
  s_mov_b32 s55, 0x00020000
  s_and_b32 s57, s57, 0xffff
  s_mov_b32 s58, 256
  s_mov_b32 s59, 0x00020000
  s_lshl_b32 s43, s31, 3
  s_add_u32 s43, s43, s32
  s_lshl_b32 s43, s43, 2
  s_and_b32 s3, s2, 0x1b
  s_or_b32 s3, s3, s28
  s_cmp_eq_u32 s3, 0
  s_cbranch_scc0 L_nolead
  s_memrealtime s[4:5]
  s_waitcnt lgkmcnt(0)
  s_mul_i32 s4, s4, 0x9e3779b1
  s_and_b32 s4, s4, 0xbfffbfff
  s_or_b32 s4, s4, 0x00010001
  v_mov_b32 v58, s4
  s_mov_b64 exec, 1
  buffer_store_dword v58, off, s[56:59], s43 sc1
  s_mov_b64 exec, -1
L_nolead:
  v_lshrrev_b32 v60, 2, v2
  v_and_b32 v61, 3, v2
  v_and_b32 v62, 1, v3
  v_lshl_add_u32 v62, v62, 2, v60
  v_lshl_add_u32 v63, v3, 3, v60
  v_lshlrev_b32 v63, 9, v63
  v_lshl_add_u32 v63, v62, 5, v63
  v_lshl_add_u32 v63, v61, 3, v63
  s_lshl_b32 s3, s30, 8
  s_add_u32 s3, s3, 65536
  v_add_u32 v17, s3, v63
  v_xor_b32 v18, 32, v17
  v_xor_b32 v19, 64, v17
  v_xor_b32 v20, 96, v17
  v_xor_b32 v21, 128, v17
  v_xor_b32 v22, 160, v17
  v_xor_b32 v23, 192, v17
  v_xor_b32 v24, 224, v17
  v_and_b32 v63, 6, v2
  v_xor_b32 v63, v63, v3
  v_lshlrev_b32 v63, 4, v63
  v_lshl_add_u32 v63, v2, 7, v63
  s_mul_i32 s3, s29, 6144
  s_add_u32 s3, s3, 131072
  v_add_u32 v25, s3, v63
  v_xor_b32 v26, 64, v25
  v_and_b32 v63, 7, v2
  v_lshlrev_b32 v63, 1, v63
  v_xor_b32 v63, v63, v3
  v_lshlrev_b32 v63, 4, v63
  v_lshl_add_u32 v63, v2, 8, v63
  s_lshl_b32 s3, s30, 13
  v_add_u32 v13, s3, v63
  v_xor_b32 v14, 64, v13
  v_xor_b32 v15, 128, v13
  v_xor_b32 v16, 192, v13
  v_lshlrev_b32 v27, 4, v1
  s_mul_i32 s3, s28, 12288
  s_add_u32 s3, s3, 114688
  v_lshlrev_b32 v63, 4, v1
  v_add_u32 v28, s3, v63
  s_xor_b32 s4, s28, 2
  s_mul_i32 s3, s4, 12288
  s_add_u32 s3, s3, 114688
  v_add_u32 v29, s3, v63
  s_lshl_b32 s3, s28, 11
  s_add_u32 s3, s3, 155648
  v_add_u32 v30, s3, v63
  v_mov_b32 v44, 0x3e0293ee
  s_add_u32 s3, s38, 0
  v_add_u32 v0, s3, v63
  v_lshrrev_b32 v63, 1, v3
  v_xor_b32 v63, v63, v2
  v_lshlrev_b32 v63, 4, v63
  v_lshl_add_u32 v63, v2, 8, v63
  v_and_b32 v59, 1, v3
  v_lshl_add_u32 v63, v59, 3, v63
  s_mul_i32 s4, s29, 12288
  s_add_u32 s4, s4, 131072
  v_add_u32 v31, s4, v63
  v_xor_b32 v59, v3, v2
  v_lshlrev_b32 v59, 4, v59
  v_lshl_add_u32 v59, v2, 8, v59
  v_add_u32 v59, s4, v59
  s_lshr_b32 s60, s2, 3
  s_lshl_b32 s60, s60, 2
  s_or_b32 s60, s60, s28
  s_cmpk_ge_u32 s60, 37
  s_cbranch_scc1 L_wb_back
  s_mov_b32 s62, 0x4245d1d1
  s_mov_b32 s63, 0x24924923
  s_mov_b32 s64, 0x49249249
  s_mov_b32 s65, 0x92492492
  s_bitcmp1_b32 s60, 6
  s_cselect_b64 s[62:63], s[64:65], s[62:63]
  s_bitcmp1_b64 s[62:63], s60
  s_cselect_b32 s61, 4, 0
  s_mul_i32 s60, s60, 0x100
  s_add_u32 s60, s60, s61
  s_getpc_b64 s[64:65]
L_wb_pc:
  s_add_u32 s60, s60, L_wb_base-L_wb_pc+0x10000
  s_sub_u32 s60, s60, 0x10000
  s_add_u32 s64, s64, s60
  s_addc_u32 s65, s65, 0
  s_mov_b64 exec, 0
  s_setpc_b64 s[64:65]
L_wb_back:
  s_mov_b64 exec, -1
  s_waitcnt vmcnt(11)
  s_barrier
  ds_read_b128 a[128:131], v25 offset:0
  ds_read_b128 a[132:135], v25 offset:2048
  ds_read_b128 a[136:139], v25 offset:4096
  ds_read_b64_tr_b16 a[96:97], v17 offset:0
  ds_read_b64_tr_b16 a[98:99], v17 offset:2048
  ds_read_b64_tr_b16 a[100:101], v18 offset:0
  ds_read_b64_tr_b16 a[102:103], v18 offset:2048
  ds_read_b64_tr_b16 a[104:105], v19 offset:0
  ds_read_b64_tr_b16 a[106:107], v19 offset:2048
  ds_read_b64_tr_b16 a[108:109], v20 offset:0
  ds_read_b64_tr_b16 a[110:111], v20 offset:2048
  ds_read_b64_tr_b16 a[112:113], v21 offset:0
  ds_read_b64_tr_b16 a[114:115], v21 offset:2048
  ds_read_b64_tr_b16 a[116:117], v22 offset:0
  ds_read_b64_tr_b16 a[118:119], v22 offset:2048
  ds_read_b64_tr_b16 a[120:121], v23 offset:0
  ds_read_b64_tr_b16 a[122:123], v23 offset:2048
  ds_read_b64_tr_b16 a[124:125], v24 offset:0
  ds_read_b64_tr_b16 a[126:127], v24 offset:2048
  s_waitcnt vmcnt(7) lgkmcnt(0)
  s_barrier
  v_mfma_f32_16x16x32_bf16 v[64:67], a[96:99], a[128:131], 0
  ds_read_b128 a[172:175], v26 offset:0
  v_mfma_f32_16x16x32_bf16 v[68:71], a[96:99], a[132:135], 0
  ds_read_b128 a[176:179], v26 offset:2048
  s_add_u32 m0, s38, 114688
  s_nop 0
  buffer_load_dwordx4 v6, s[12:15], s35 offen offset:0 lds
  v_mfma_f32_16x16x32_bf16 v[72:75], a[96:99], a[136:139], 0
  ds_read_b128 a[180:183], v26 offset:4096
  v_mfma_f32_16x16x32_bf16 v[76:79], a[100:103], a[128:131], 0
  ds_read_b64_tr_b16 a[140:141], v17 offset:16384
  v_mfma_f32_16x16x32_bf16 v[80:83], a[100:103], a[132:135], 0
  ds_read_b64_tr_b16 a[142:143], v17 offset:18432
  buffer_load_dwordx4 v7, s[12:15], s35 offen offset:1024 lds
  v_mfma_f32_16x16x32_bf16 v[84:87], a[100:103], a[136:139], 0
  ds_read_b64_tr_b16 a[144:145], v18 offset:16384
  v_mfma_f32_16x16x32_bf16 v[88:91], a[104:107], a[128:131], 0
  ds_read_b64_tr_b16 a[146:147], v18 offset:18432
  v_mfma_f32_16x16x32_bf16 v[92:95], a[104:107], a[132:135], 0
  ds_read_b64_tr_b16 a[148:149], v19 offset:16384
  buffer_load_dwordx4 v8, s[12:15], s35 offen offset:2048 lds
  v_mfma_f32_16x16x32_bf16 v[96:99], a[104:107], a[136:139], 0
  ds_read_b64_tr_b16 a[150:151], v19 offset:18432
  v_mfma_f32_16x16x32_bf16 v[100:103], a[108:111], a[128:131], 0
  ds_read_b64_tr_b16 a[152:153], v20 offset:16384
  v_mfma_f32_16x16x32_bf16 v[104:107], a[108:111], a[132:135], 0
  ds_read_b64_tr_b16 a[154:155], v20 offset:18432
  buffer_load_dwordx4 v9, s[12:15], s35 offen offset:3072 lds
  s_add_u32 s35, s35, 262144
  s_cmp_eq_u32 s35, s47
  s_cselect_b32 s35, s46, s35
  v_mfma_f32_16x16x32_bf16 v[108:111], a[108:111], a[136:139], 0
  ds_read_b64_tr_b16 a[156:157], v21 offset:16384
  v_mfma_f32_16x16x32_bf16 v[112:115], a[112:115], a[128:131], 0
  ds_read_b64_tr_b16 a[158:159], v21 offset:18432
  v_mfma_f32_16x16x32_bf16 v[116:119], a[112:115], a[132:135], 0
  ds_read_b64_tr_b16 a[160:161], v22 offset:16384
  s_add_u32 m0, s38, 65536
  s_nop 0
  buffer_load_dwordx4 v6, s[12:15], s35 offen offset:0 lds
  v_mfma_f32_16x16x32_bf16 v[120:123], a[112:115], a[136:139], 0
  ds_read_b64_tr_b16 a[162:163], v22 offset:18432
  v_mfma_f32_16x16x32_bf16 v[124:127], a[116:119], a[128:131], 0
  ds_read_b64_tr_b16 a[164:165], v23 offset:16384
  v_mfma_f32_16x16x32_bf16 v[128:131], a[116:119], a[132:135], 0
  ds_read_b64_tr_b16 a[166:167], v23 offset:18432
  buffer_load_dwordx4 v7, s[12:15], s35 offen offset:1024 lds
  v_mfma_f32_16x16x32_bf16 v[132:135], a[116:119], a[136:139], 0
  ds_read_b64_tr_b16 a[168:169], v24 offset:16384
  v_mfma_f32_16x16x32_bf16 v[136:139], a[120:123], a[128:131], 0
  ds_read_b64_tr_b16 a[170:171], v24 offset:18432
  v_mfma_f32_16x16x32_bf16 v[140:143], a[120:123], a[132:135], 0
  buffer_load_dwordx4 v8, s[12:15], s35 offen offset:2048 lds
  v_mfma_f32_16x16x32_bf16 v[144:147], a[120:123], a[136:139], 0
  v_mfma_f32_16x16x32_bf16 v[148:151], a[124:127], a[128:131], 0
  v_mfma_f32_16x16x32_bf16 v[152:155], a[124:127], a[132:135], 0
  buffer_load_dwordx4 v9, s[12:15], s35 offen offset:3072 lds
  s_add_u32 s35, s35, 262144
  s_cmp_eq_u32 s35, s47
  s_cselect_b32 s35, s46, s35
  v_mfma_f32_16x16x32_bf16 v[156:159], a[124:127], a[136:139], 0
  s_waitcnt vmcnt(8) lgkmcnt(0)
  s_barrier
  v_mfma_f32_16x16x32_bf16 v[64:67], a[140:143], a[172:175], v[64:67]
  ds_read_b128 a[128:131], v25 offset:12288
  s_add_u32 m0, s39, 0
  s_nop 0
  buffer_load_dwordx4 v10, s[8:11], s34 offen offset:0 lds
  v_mfma_f32_16x16x32_bf16 v[68:71], a[140:143], a[176:179], v[68:71]
  ds_read_b128 a[132:135], v25 offset:14336
  v_mfma_f32_16x16x32_bf16 v[72:75], a[140:143], a[180:183], v[72:75]
  ds_read_b128 a[136:139], v25 offset:16384
  buffer_load_dwordx4 v11, s[8:11], s34 offen offset:1024 lds
  v_mfma_f32_16x16x32_bf16 v[76:79], a[144:147], a[172:175], v[76:79]
  ds_read_b64_tr_b16 a[96:97], v17 offset:32768
  v_mfma_f32_16x16x32_bf16 v[80:83], a[144:147], a[176:179], v[80:83]
  ds_read_b64_tr_b16 a[98:99], v17 offset:34816
  buffer_load_dwordx4 v12, s[8:11], s34 offen offset:2048 lds
  s_add_u32 s34, s34, 128
  s_cmp_eq_u32 s34, s45
  s_cselect_b32 s34, s44, s34
  v_mfma_f32_16x16x32_bf16 v[84:87], a[144:147], a[180:183], v[84:87]
  ds_read_b64_tr_b16 a[100:101], v18 offset:32768
  v_mfma_f32_16x16x32_bf16 v[88:91], a[148:151], a[172:175], v[88:91]
  ds_read_b64_tr_b16 a[102:103], v18 offset:34816
  s_add_u32 m0, s38, 81920
  s_nop 0
  buffer_load_dwordx4 v6, s[12:15], s35 offen offset:0 lds
  v_mfma_f32_16x16x32_bf16 v[92:95], a[148:151], a[176:179], v[92:95]
  ds_read_b64_tr_b16 a[104:105], v19 offset:32768
  v_mfma_f32_16x16x32_bf16 v[96:99], a[148:151], a[180:183], v[96:99]
  ds_read_b64_tr_b16 a[106:107], v19 offset:34816
  buffer_load_dwordx4 v7, s[12:15], s35 offen offset:1024 lds
  v_mfma_f32_16x16x32_bf16 v[100:103], a[152:155], a[172:175], v[100:103]
  ds_read_b64_tr_b16 a[108:109], v20 offset:32768
  v_mfma_f32_16x16x32_bf16 v[104:107], a[152:155], a[176:179], v[104:107]
  ds_read_b64_tr_b16 a[110:111], v20 offset:34816
  buffer_load_dwordx4 v8, s[12:15], s35 offen offset:2048 lds
  v_mfma_f32_16x16x32_bf16 v[108:111], a[152:155], a[180:183], v[108:111]
  ds_read_b64_tr_b16 a[112:113], v21 offset:32768
  v_mfma_f32_16x16x32_bf16 v[112:115], a[156:159], a[172:175], v[112:115]
  ds_read_b64_tr_b16 a[114:115], v21 offset:34816
  v_mfma_f32_16x16x32_bf16 v[116:119], a[156:159], a[176:179], v[116:119]
  ds_read_b64_tr_b16 a[116:117], v22 offset:32768
  buffer_load_dwordx4 v9, s[12:15], s35 offen offset:3072 lds
  s_add_u32 s35, s35, 262144
  s_cmp_eq_u32 s35, s47
  s_cselect_b32 s35, s46, s35
  v_mfma_f32_16x16x32_bf16 v[120:123], a[156:159], a[180:183], v[120:123]
  ds_read_b64_tr_b16 a[118:119], v22 offset:34816
  v_mfma_f32_16x16x32_bf16 v[124:127], a[160:163], a[172:175], v[124:127]
  ds_read_b64_tr_b16 a[120:121], v23 offset:32768
  s_add_u32 m0, s38, 0
  s_add_u32 s37, s36, 0
  buffer_load_dwordx4 v4, s[16:19], s37 offen offset:0 nt lds
  v_mfma_f32_16x16x32_bf16 v[128:131], a[160:163], a[176:179], v[128:131]
  ds_read_b64_tr_b16 a[122:123], v23 offset:34816
  v_mfma_f32_16x16x32_bf16 v[132:135], a[160:163], a[180:183], v[132:135]
  ds_read_b64_tr_b16 a[124:125], v24 offset:32768
  buffer_load_dwordx4 v5, s[16:19], s37 offen offset:1024 nt lds
  v_mfma_f32_16x16x32_bf16 v[136:139], a[164:167], a[172:175], v[136:139]
  ds_read_b64_tr_b16 a[126:127], v24 offset:34816
  v_mfma_f32_16x16x32_bf16 v[140:143], a[164:167], a[176:179], v[140:143]
  buffer_load_dwordx4 v4, s[16:19], s37 offen offset:2048 nt lds
  v_mfma_f32_16x16x32_bf16 v[144:147], a[164:167], a[180:183], v[144:147]
  v_mfma_f32_16x16x32_bf16 v[148:151], a[168:171], a[172:175], v[148:151]
  buffer_load_dwordx4 v5, s[16:19], s37 offen offset:3072 nt lds
  v_mfma_f32_16x16x32_bf16 v[152:155], a[168:171], a[176:179], v[152:155]
  v_mfma_f32_16x16x32_bf16 v[156:159], a[168:171], a[180:183], v[156:159]
  s_waitcnt vmcnt(15) lgkmcnt(0)
  s_barrier
  v_mfma_f32_16x16x32_bf16 v[64:67], a[96:99], a[128:131], v[64:67]
  ds_read_b128 a[172:175], v26 offset:12288
  v_mfma_f32_16x16x32_bf16 v[68:71], a[96:99], a[132:135], v[68:71]
  ds_read_b128 a[176:179], v26 offset:14336
  s_add_u32 m0, s38, 98304
  s_nop 0
  buffer_load_dwordx4 v6, s[12:15], s35 offen offset:0 lds
  v_mfma_f32_16x16x32_bf16 v[72:75], a[96:99], a[136:139], v[72:75]
  ds_read_b128 a[180:183], v26 offset:16384
  v_mfma_f32_16x16x32_bf16 v[76:79], a[100:103], a[128:131], v[76:79]
  ds_read_b64_tr_b16 a[140:141], v17 offset:49152
  v_mfma_f32_16x16x32_bf16 v[80:83], a[100:103], a[132:135], v[80:83]
  ds_read_b64_tr_b16 a[142:143], v17 offset:51200
  buffer_load_dwordx4 v7, s[12:15], s35 offen offset:1024 lds
  v_mfma_f32_16x16x32_bf16 v[84:87], a[100:103], a[136:139], v[84:87]
  ds_read_b64_tr_b16 a[144:145], v18 offset:49152
  v_mfma_f32_16x16x32_bf16 v[88:91], a[104:107], a[128:131], v[88:91]
  ds_read_b64_tr_b16 a[146:147], v18 offset:51200
  v_mfma_f32_16x16x32_bf16 v[92:95], a[104:107], a[132:135], v[92:95]
  ds_read_b64_tr_b16 a[148:149], v19 offset:49152
  buffer_load_dwordx4 v8, s[12:15], s35 offen offset:2048 lds
  v_mfma_f32_16x16x32_bf16 v[96:99], a[104:107], a[136:139], v[96:99]
  ds_read_b64_tr_b16 a[150:151], v19 offset:51200
  v_mfma_f32_16x16x32_bf16 v[100:103], a[108:111], a[128:131], v[100:103]
  ds_read_b64_tr_b16 a[152:153], v20 offset:49152
  v_mfma_f32_16x16x32_bf16 v[104:107], a[108:111], a[132:135], v[104:107]
  ds_read_b64_tr_b16 a[154:155], v20 offset:51200
  buffer_load_dwordx4 v9, s[12:15], s35 offen offset:3072 lds
  s_add_u32 s35, s35, 262144
  s_cmp_eq_u32 s35, s47
  s_cselect_b32 s35, s46, s35
  v_mfma_f32_16x16x32_bf16 v[108:111], a[108:111], a[136:139], v[108:111]
  ds_read_b64_tr_b16 a[156:157], v21 offset:49152
  v_mfma_f32_16x16x32_bf16 v[112:115], a[112:115], a[128:131], v[112:115]
  ds_read_b64_tr_b16 a[158:159], v21 offset:51200
  v_mfma_f32_16x16x32_bf16 v[116:119], a[112:115], a[132:135], v[116:119]
  ds_read_b64_tr_b16 a[160:161], v22 offset:49152
  v_mfma_f32_16x16x32_bf16 v[120:123], a[112:115], a[136:139], v[120:123]
  ds_read_b64_tr_b16 a[162:163], v22 offset:51200
  v_mfma_f32_16x16x32_bf16 v[124:127], a[116:119], a[128:131], v[124:127]
  ds_read_b64_tr_b16 a[164:165], v23 offset:49152
  v_mfma_f32_16x16x32_bf16 v[128:131], a[116:119], a[132:135], v[128:131]
  ds_read_b64_tr_b16 a[166:167], v23 offset:51200
  v_mfma_f32_16x16x32_bf16 v[132:135], a[116:119], a[136:139], v[132:135]
  ds_read_b64_tr_b16 a[168:169], v24 offset:49152
  v_mfma_f32_16x16x32_bf16 v[136:139], a[120:123], a[128:131], v[136:139]
  ds_read_b64_tr_b16 a[170:171], v24 offset:51200
  v_mfma_f32_16x16x32_bf16 v[140:143], a[120:123], a[132:135], v[140:143]
  v_mfma_f32_16x16x32_bf16 v[144:147], a[120:123], a[136:139], v[144:147]
  v_mfma_f32_16x16x32_bf16 v[148:151], a[124:127], a[128:131], v[148:151]
  v_mfma_f32_16x16x32_bf16 v[152:155], a[124:127], a[132:135], v[152:155]
  v_mfma_f32_16x16x32_bf16 v[156:159], a[124:127], a[136:139], v[156:159]
  s_waitcnt vmcnt(12) lgkmcnt(0)
  s_barrier
  v_mfma_f32_16x16x32_bf16 v[64:67], a[140:143], a[172:175], v[64:67]
  ds_read_b128 a[128:131], v25 offset:0
  v_mfma_f32_16x16x32_bf16 v[68:71], a[140:143], a[176:179], v[68:71]
  ds_read_b128 a[132:135], v25 offset:2048
  v_mfma_f32_16x16x32_bf16 v[72:75], a[140:143], a[180:183], v[72:75]
  ds_read_b128 a[136:139], v25 offset:4096
  v_mfma_f32_16x16x32_bf16 v[76:79], a[144:147], a[172:175], v[76:79]
  ds_read_b64_tr_b16 a[96:97], v17 offset:0
  v_mfma_f32_16x16x32_bf16 v[80:83], a[144:147], a[176:179], v[80:83]
  ds_read_b64_tr_b16 a[98:99], v17 offset:2048
  v_mfma_f32_16x16x32_bf16 v[84:87], a[144:147], a[180:183], v[84:87]
  ds_read_b64_tr_b16 a[100:101], v18 offset:0
  v_mfma_f32_16x16x32_bf16 v[88:91], a[148:151], a[172:175], v[88:91]
  ds_read_b64_tr_b16 a[102:103], v18 offset:2048
  v_mfma_f32_16x16x32_bf16 v[92:95], a[148:151], a[176:179], v[92:95]
  ds_read_b64_tr_b16 a[104:105], v19 offset:0
  v_mfma_f32_16x16x32_bf16 v[96:99], a[148:151], a[180:183], v[96:99]
  ds_read_b64_tr_b16 a[106:107], v19 offset:2048
  v_mfma_f32_16x16x32_bf16 v[100:103], a[152:155], a[172:175], v[100:103]
  ds_read_b64_tr_b16 a[108:109], v20 offset:0
  v_mfma_f32_16x16x32_bf16 v[104:107], a[152:155], a[176:179], v[104:107]
  ds_read_b64_tr_b16 a[110:111], v20 offset:2048
  v_mfma_f32_16x16x32_bf16 v[108:111], a[152:155], a[180:183], v[108:111]
  ds_read_b64_tr_b16 a[112:113], v21 offset:0
  v_mfma_f32_16x16x32_bf16 v[112:115], a[156:159], a[172:175], v[112:115]
  ds_read_b64_tr_b16 a[114:115], v21 offset:2048
  v_mfma_f32_16x16x32_bf16 v[116:119], a[156:159], a[176:179], v[116:119]
  ds_read_b64_tr_b16 a[116:117], v22 offset:0
  v_mfma_f32_16x16x32_bf16 v[120:123], a[156:159], a[180:183], v[120:123]
  ds_read_b64_tr_b16 a[118:119], v22 offset:2048
  s_add_u32 m0, s39, 12288
  s_nop 0
  buffer_load_dwordx4 v10, s[8:11], s34 offen offset:0 lds
  v_mfma_f32_16x16x32_bf16 v[124:127], a[160:163], a[172:175], v[124:127]
  ds_read_b64_tr_b16 a[120:121], v23 offset:0
  buffer_load_dwordx4 v11, s[8:11], s34 offen offset:1024 lds
  v_mfma_f32_16x16x32_bf16 v[128:131], a[160:163], a[176:179], v[128:131]
  ds_read_b64_tr_b16 a[122:123], v23 offset:2048
  buffer_load_dwordx4 v12, s[8:11], s34 offen offset:2048 lds
  s_add_u32 s34, s34, 128
  s_cmp_eq_u32 s34, s45
  s_cselect_b32 s34, s44, s34
  v_mfma_f32_16x16x32_bf16 v[132:135], a[160:163], a[180:183], v[132:135]
  ds_read_b64_tr_b16 a[124:125], v24 offset:0
  v_mfma_f32_16x16x32_bf16 v[136:139], a[164:167], a[172:175], v[136:139]
  ds_read_b64_tr_b16 a[126:127], v24 offset:2048
  s_add_u32 m0, s38, 114688
  s_nop 0
  buffer_load_dwordx4 v6, s[12:15], s35 offen offset:0 lds
  v_mfma_f32_16x16x32_bf16 v[140:143], a[164:167], a[176:179], v[140:143]
  buffer_load_dwordx4 v7, s[12:15], s35 offen offset:1024 lds
  v_mfma_f32_16x16x32_bf16 v[144:147], a[164:167], a[180:183], v[144:147]
  v_mfma_f32_16x16x32_bf16 v[148:151], a[168:171], a[172:175], v[148:151]
  buffer_load_dwordx4 v8, s[12:15], s35 offen offset:2048 lds
  v_mfma_f32_16x16x32_bf16 v[152:155], a[168:171], a[176:179], v[152:155]
  buffer_load_dwordx4 v9, s[12:15], s35 offen offset:3072 lds
  s_add_u32 s35, s35, 262144
  s_cmp_eq_u32 s35, s47
  s_cselect_b32 s35, s46, s35
  v_mfma_f32_16x16x32_bf16 v[156:159], a[168:171], a[180:183], v[156:159]
  s_waitcnt vmcnt(15) lgkmcnt(0)
  s_barrier
  v_mfma_f32_16x16x32_bf16 v[64:67], a[96:99], a[128:131], v[64:67]
  ds_read_b128 a[172:175], v26 offset:0
  v_mfma_f32_16x16x32_bf16 v[68:71], a[96:99], a[132:135], v[68:71]
  ds_read_b128 a[176:179], v26 offset:2048
  s_add_u32 m0, s38, 65536
  s_nop 0
  buffer_load_dwordx4 v6, s[12:15], s35 offen offset:0 lds
  v_mfma_f32_16x16x32_bf16 v[72:75], a[96:99], a[136:139], v[72:75]
  ds_read_b128 a[180:183], v26 offset:4096
  v_mfma_f32_16x16x32_bf16 v[76:79], a[100:103], a[128:131], v[76:79]
  ds_read_b64_tr_b16 a[140:141], v17 offset:16384
  v_mfma_f32_16x16x32_bf16 v[80:83], a[100:103], a[132:135], v[80:83]
  ds_read_b64_tr_b16 a[142:143], v17 offset:18432
  buffer_load_dwordx4 v7, s[12:15], s35 offen offset:1024 lds
  v_mfma_f32_16x16x32_bf16 v[84:87], a[100:103], a[136:139], v[84:87]
  ds_read_b64_tr_b16 a[144:145], v18 offset:16384
  v_mfma_f32_16x16x32_bf16 v[88:91], a[104:107], a[128:131], v[88:91]
  ds_read_b64_tr_b16 a[146:147], v18 offset:18432
  v_mfma_f32_16x16x32_bf16 v[92:95], a[104:107], a[132:135], v[92:95]
  ds_read_b64_tr_b16 a[148:149], v19 offset:16384
  buffer_load_dwordx4 v8, s[12:15], s35 offen offset:2048 lds
  v_mfma_f32_16x16x32_bf16 v[96:99], a[104:107], a[136:139], v[96:99]
  ds_read_b64_tr_b16 a[150:151], v19 offset:18432
  v_mfma_f32_16x16x32_bf16 v[100:103], a[108:111], a[128:131], v[100:103]
  ds_read_b64_tr_b16 a[152:153], v20 offset:16384
  v_mfma_f32_16x16x32_bf16 v[104:107], a[108:111], a[132:135], v[104:107]
  ds_read_b64_tr_b16 a[154:155], v20 offset:18432
  buffer_load_dwordx4 v9, s[12:15], s35 offen offset:3072 lds
  s_add_u32 s35, s35, 262144
  s_cmp_eq_u32 s35, s47
  s_cselect_b32 s35, s46, s35
  v_mfma_f32_16x16x32_bf16 v[108:111], a[108:111], a[136:139], v[108:111]
  ds_read_b64_tr_b16 a[156:157], v21 offset:16384
  v_mfma_f32_16x16x32_bf16 v[112:115], a[112:115], a[128:131], v[112:115]
  ds_read_b64_tr_b16 a[158:159], v21 offset:18432
  v_mfma_f32_16x16x32_bf16 v[116:119], a[112:115], a[132:135], v[116:119]
  ds_read_b64_tr_b16 a[160:161], v22 offset:16384
  v_mfma_f32_16x16x32_bf16 v[120:123], a[112:115], a[136:139], v[120:123]
  ds_read_b64_tr_b16 a[162:163], v22 offset:18432
  v_mfma_f32_16x16x32_bf16 v[124:127], a[116:119], a[128:131], v[124:127]
  ds_read_b64_tr_b16 a[164:165], v23 offset:16384
  v_mfma_f32_16x16x32_bf16 v[128:131], a[116:119], a[132:135], v[128:131]
  ds_read_b64_tr_b16 a[166:167], v23 offset:18432
  v_mfma_f32_16x16x32_bf16 v[132:135], a[116:119], a[136:139], v[132:135]
  ds_read_b64_tr_b16 a[168:169], v24 offset:16384
  v_mfma_f32_16x16x32_bf16 v[136:139], a[120:123], a[128:131], v[136:139]
  ds_read_b64_tr_b16 a[170:171], v24 offset:18432
  v_mfma_f32_16x16x32_bf16 v[140:143], a[120:123], a[132:135], v[140:143]
  v_mfma_f32_16x16x32_bf16 v[144:147], a[120:123], a[136:139], v[144:147]
  v_mfma_f32_16x16x32_bf16 v[148:151], a[124:127], a[128:131], v[148:151]
  v_mfma_f32_16x16x32_bf16 v[152:155], a[124:127], a[132:135], v[152:155]
  v_mfma_f32_16x16x32_bf16 v[156:159], a[124:127], a[136:139], v[156:159]
  s_waitcnt vmcnt(8) lgkmcnt(0)
  s_barrier
  v_mfma_f32_16x16x32_bf16 v[64:67], a[140:143], a[172:175], v[64:67]
  ds_read_b128 a[128:131], v25 offset:12288
  s_add_u32 m0, s39, 0
  s_nop 0
  buffer_load_dwordx4 v10, s[8:11], s34 offen offset:0 lds
  v_mfma_f32_16x16x32_bf16 v[68:71], a[140:143], a[176:179], v[68:71]
  ds_read_b128 a[132:135], v25 offset:14336
  v_mfma_f32_16x16x32_bf16 v[72:75], a[140:143], a[180:183], v[72:75]
  ds_read_b128 a[136:139], v25 offset:16384
  buffer_load_dwordx4 v11, s[8:11], s34 offen offset:1024 lds
  v_mfma_f32_16x16x32_bf16 v[76:79], a[144:147], a[172:175], v[76:79]
  ds_read_b64_tr_b16 a[96:97], v17 offset:32768
  v_mfma_f32_16x16x32_bf16 v[80:83], a[144:147], a[176:179], v[80:83]
  ds_read_b64_tr_b16 a[98:99], v17 offset:34816
  buffer_load_dwordx4 v12, s[8:11], s34 offen offset:2048 lds
  s_add_u32 s34, s34, 128
  s_cmp_eq_u32 s34, s45
  s_cselect_b32 s34, s44, s34
  v_mfma_f32_16x16x32_bf16 v[84:87], a[144:147], a[180:183], v[84:87]
  ds_read_b64_tr_b16 a[100:101], v18 offset:32768
  v_mfma_f32_16x16x32_bf16 v[88:91], a[148:151], a[172:175], v[88:91]
  ds_read_b64_tr_b16 a[102:103], v18 offset:34816
  s_add_u32 m0, s38, 81920
  s_nop 0
  buffer_load_dwordx4 v6, s[12:15], s35 offen offset:0 lds
  v_mfma_f32_16x16x32_bf16 v[92:95], a[148:151], a[176:179], v[92:95]
  ds_read_b64_tr_b16 a[104:105], v19 offset:32768
  v_mfma_f32_16x16x32_bf16 v[96:99], a[148:151], a[180:183], v[96:99]
  ds_read_b64_tr_b16 a[106:107], v19 offset:34816
  buffer_load_dwordx4 v7, s[12:15], s35 offen offset:1024 lds
  v_mfma_f32_16x16x32_bf16 v[100:103], a[152:155], a[172:175], v[100:103]
  ds_read_b64_tr_b16 a[108:109], v20 offset:32768
  v_mfma_f32_16x16x32_bf16 v[104:107], a[152:155], a[176:179], v[104:107]
  ds_read_b64_tr_b16 a[110:111], v20 offset:34816
  buffer_load_dwordx4 v8, s[12:15], s35 offen offset:2048 lds
  v_mfma_f32_16x16x32_bf16 v[108:111], a[152:155], a[180:183], v[108:111]
  ds_read_b64_tr_b16 a[112:113], v21 offset:32768
  v_mfma_f32_16x16x32_bf16 v[112:115], a[156:159], a[172:175], v[112:115]
  ds_read_b64_tr_b16 a[114:115], v21 offset:34816
  v_mfma_f32_16x16x32_bf16 v[116:119], a[156:159], a[176:179], v[116:119]
  ds_read_b64_tr_b16 a[116:117], v22 offset:32768
  buffer_load_dwordx4 v9, s[12:15], s35 offen offset:3072 lds
  s_add_u32 s35, s35, 262144
  s_cmp_eq_u32 s35, s47
  s_cselect_b32 s35, s46, s35
  v_mfma_f32_16x16x32_bf16 v[120:123], a[156:159], a[180:183], v[120:123]
  ds_read_b64_tr_b16 a[118:119], v22 offset:34816
  v_mfma_f32_16x16x32_bf16 v[124:127], a[160:163], a[172:175], v[124:127]
  ds_read_b64_tr_b16 a[120:121], v23 offset:32768
  s_add_u32 m0, s38, 16384
  s_add_u32 s37, s36, 16384
  buffer_load_dwordx4 v4, s[16:19], s37 offen offset:0 nt lds
  v_mfma_f32_16x16x32_bf16 v[128:131], a[160:163], a[176:179], v[128:131]
  ds_read_b64_tr_b16 a[122:123], v23 offset:34816
  v_mfma_f32_16x16x32_bf16 v[132:135], a[160:163], a[180:183], v[132:135]
  ds_read_b64_tr_b16 a[124:125], v24 offset:32768
  buffer_load_dwordx4 v5, s[16:19], s37 offen offset:1024 nt lds
  v_mfma_f32_16x16x32_bf16 v[136:139], a[164:167], a[172:175], v[136:139]
  ds_read_b64_tr_b16 a[126:127], v24 offset:34816
  v_mfma_f32_16x16x32_bf16 v[140:143], a[164:167], a[176:179], v[140:143]
  buffer_load_dwordx4 v4, s[16:19], s37 offen offset:2048 nt lds
  v_mfma_f32_16x16x32_bf16 v[144:147], a[164:167], a[180:183], v[144:147]
  v_mfma_f32_16x16x32_bf16 v[148:151], a[168:171], a[172:175], v[148:151]
  buffer_load_dwordx4 v5, s[16:19], s37 offen offset:3072 nt lds
  v_mfma_f32_16x16x32_bf16 v[152:155], a[168:171], a[176:179], v[152:155]
  v_mfma_f32_16x16x32_bf16 v[156:159], a[168:171], a[180:183], v[156:159]
  s_waitcnt vmcnt(15) lgkmcnt(0)
  s_barrier
  v_mfma_f32_16x16x32_bf16 v[64:67], a[96:99], a[128:131], v[64:67]
  ds_read_b128 a[172:175], v26 offset:12288
  v_mfma_f32_16x16x32_bf16 v[68:71], a[96:99], a[132:135], v[68:71]
  ds_read_b128 a[176:179], v26 offset:14336
  s_add_u32 m0, s38, 98304
  s_nop 0
  buffer_load_dwordx4 v6, s[12:15], s35 offen offset:0 lds
  v_mfma_f32_16x16x32_bf16 v[72:75], a[96:99], a[136:139], v[72:75]
  ds_read_b128 a[180:183], v26 offset:16384
  v_mfma_f32_16x16x32_bf16 v[76:79], a[100:103], a[128:131], v[76:79]
  ds_read_b64_tr_b16 a[140:141], v17 offset:49152
  v_mfma_f32_16x16x32_bf16 v[80:83], a[100:103], a[132:135], v[80:83]
  ds_read_b64_tr_b16 a[142:143], v17 offset:51200
  buffer_load_dwordx4 v7, s[12:15], s35 offen offset:1024 lds
  v_mfma_f32_16x16x32_bf16 v[84:87], a[100:103], a[136:139], v[84:87]
  ds_read_b64_tr_b16 a[144:145], v18 offset:49152
  v_mfma_f32_16x16x32_bf16 v[88:91], a[104:107], a[128:131], v[88:91]
  ds_read_b64_tr_b16 a[146:147], v18 offset:51200
  v_mfma_f32_16x16x32_bf16 v[92:95], a[104:107], a[132:135], v[92:95]
  ds_read_b64_tr_b16 a[148:149], v19 offset:49152
  buffer_load_dwordx4 v8, s[12:15], s35 offen offset:2048 lds
  v_mfma_f32_16x16x32_bf16 v[96:99], a[104:107], a[136:139], v[96:99]
  ds_read_b64_tr_b16 a[150:151], v19 offset:51200
  v_mfma_f32_16x16x32_bf16 v[100:103], a[108:111], a[128:131], v[100:103]
  ds_read_b64_tr_b16 a[152:153], v20 offset:49152
  v_mfma_f32_16x16x32_bf16 v[104:107], a[108:111], a[132:135], v[104:107]
  ds_read_b64_tr_b16 a[154:155], v20 offset:51200
  buffer_load_dwordx4 v9, s[12:15], s35 offen offset:3072 lds
  s_add_u32 s35, s35, 262144
  s_cmp_eq_u32 s35, s47
  s_cselect_b32 s35, s46, s35
  v_mfma_f32_16x16x32_bf16 v[108:111], a[108:111], a[136:139], v[108:111]
  ds_read_b64_tr_b16 a[156:157], v21 offset:49152
  v_mfma_f32_16x16x32_bf16 v[112:115], a[112:115], a[128:131], v[112:115]
  ds_read_b64_tr_b16 a[158:159], v21 offset:51200
  v_mfma_f32_16x16x32_bf16 v[116:119], a[112:115], a[132:135], v[116:119]
  ds_read_b64_tr_b16 a[160:161], v22 offset:49152
  v_mfma_f32_16x16x32_bf16 v[120:123], a[112:115], a[136:139], v[120:123]
  ds_read_b64_tr_b16 a[162:163], v22 offset:51200
  v_mfma_f32_16x16x32_bf16 v[124:127], a[116:119], a[128:131], v[124:127]
  ds_read_b64_tr_b16 a[164:165], v23 offset:49152
  v_mfma_f32_16x16x32_bf16 v[128:131], a[116:119], a[132:135], v[128:131]
  ds_read_b64_tr_b16 a[166:167], v23 offset:51200
  v_mfma_f32_16x16x32_bf16 v[132:135], a[116:119], a[136:139], v[132:135]
  ds_read_b64_tr_b16 a[168:169], v24 offset:49152
  v_mfma_f32_16x16x32_bf16 v[136:139], a[120:123], a[128:131], v[136:139]
  ds_read_b64_tr_b16 a[170:171], v24 offset:51200
  v_mfma_f32_16x16x32_bf16 v[140:143], a[120:123], a[132:135], v[140:143]
  v_mfma_f32_16x16x32_bf16 v[144:147], a[120:123], a[136:139], v[144:147]
  v_mfma_f32_16x16x32_bf16 v[148:151], a[124:127], a[128:131], v[148:151]
  v_mfma_f32_16x16x32_bf16 v[152:155], a[124:127], a[132:135], v[152:155]
  v_mfma_f32_16x16x32_bf16 v[156:159], a[124:127], a[136:139], v[156:159]
  s_waitcnt vmcnt(12) lgkmcnt(0)
  s_barrier
  v_mfma_f32_16x16x32_bf16 v[64:67], a[140:143], a[172:175], v[64:67]
  ds_read_b128 a[128:131], v25 offset:0
  v_mfma_f32_16x16x32_bf16 v[68:71], a[140:143], a[176:179], v[68:71]
  ds_read_b128 a[132:135], v25 offset:2048
  v_mfma_f32_16x16x32_bf16 v[72:75], a[140:143], a[180:183], v[72:75]
  ds_read_b128 a[136:139], v25 offset:4096
  v_mfma_f32_16x16x32_bf16 v[76:79], a[144:147], a[172:175], v[76:79]
  ds_read_b64_tr_b16 a[96:97], v17 offset:0
  v_mfma_f32_16x16x32_bf16 v[80:83], a[144:147], a[176:179], v[80:83]
  ds_read_b64_tr_b16 a[98:99], v17 offset:2048
  v_mfma_f32_16x16x32_bf16 v[84:87], a[144:147], a[180:183], v[84:87]
  ds_read_b64_tr_b16 a[100:101], v18 offset:0
  v_mfma_f32_16x16x32_bf16 v[88:91], a[148:151], a[172:175], v[88:91]
  ds_read_b64_tr_b16 a[102:103], v18 offset:2048
  v_mfma_f32_16x16x32_bf16 v[92:95], a[148:151], a[176:179], v[92:95]
  ds_read_b64_tr_b16 a[104:105], v19 offset:0
  v_mfma_f32_16x16x32_bf16 v[96:99], a[148:151], a[180:183], v[96:99]
  ds_read_b64_tr_b16 a[106:107], v19 offset:2048
  v_mfma_f32_16x16x32_bf16 v[100:103], a[152:155], a[172:175], v[100:103]
  ds_read_b64_tr_b16 a[108:109], v20 offset:0
  v_mfma_f32_16x16x32_bf16 v[104:107], a[152:155], a[176:179], v[104:107]
  ds_read_b64_tr_b16 a[110:111], v20 offset:2048
  v_mfma_f32_16x16x32_bf16 v[108:111], a[152:155], a[180:183], v[108:111]
  ds_read_b64_tr_b16 a[112:113], v21 offset:0
  v_mfma_f32_16x16x32_bf16 v[112:115], a[156:159], a[172:175], v[112:115]
  ds_read_b64_tr_b16 a[114:115], v21 offset:2048
  v_mfma_f32_16x16x32_bf16 v[116:119], a[156:159], a[176:179], v[116:119]
  ds_read_b64_tr_b16 a[116:117], v22 offset:0
  v_mfma_f32_16x16x32_bf16 v[120:123], a[156:159], a[180:183], v[120:123]
  ds_read_b64_tr_b16 a[118:119], v22 offset:2048
  s_add_u32 m0, s39, 12288
  s_nop 0
  buffer_load_dwordx4 v10, s[8:11], s34 offen offset:0 lds
  v_mfma_f32_16x16x32_bf16 v[124:127], a[160:163], a[172:175], v[124:127]
  ds_read_b64_tr_b16 a[120:121], v23 offset:0
  buffer_load_dwordx4 v11, s[8:11], s34 offen offset:1024 lds
  v_mfma_f32_16x16x32_bf16 v[128:131], a[160:163], a[176:179], v[128:131]
  ds_read_b64_tr_b16 a[122:123], v23 offset:2048
  buffer_load_dwordx4 v12, s[8:11], s34 offen offset:2048 lds
  s_add_u32 s34, s34, 128
  s_cmp_eq_u32 s34, s45
  s_cselect_b32 s34, s44, s34
  v_mfma_f32_16x16x32_bf16 v[132:135], a[160:163], a[180:183], v[132:135]
  ds_read_b64_tr_b16 a[124:125], v24 offset:0
  v_mfma_f32_16x16x32_bf16 v[136:139], a[164:167], a[172:175], v[136:139]
  ds_read_b64_tr_b16 a[126:127], v24 offset:2048
  s_add_u32 m0, s38, 114688
  s_nop 0
  buffer_load_dwordx4 v6, s[12:15], s35 offen offset:0 lds
  v_mfma_f32_16x16x32_bf16 v[140:143], a[164:167], a[176:179], v[140:143]
  buffer_load_dwordx4 v7, s[12:15], s35 offen offset:1024 lds
  v_mfma_f32_16x16x32_bf16 v[144:147], a[164:167], a[180:183], v[144:147]
  v_mfma_f32_16x16x32_bf16 v[148:151], a[168:171], a[172:175], v[148:151]
  buffer_load_dwordx4 v8, s[12:15], s35 offen offset:2048 lds
  v_mfma_f32_16x16x32_bf16 v[152:155], a[168:171], a[176:179], v[152:155]
  buffer_load_dwordx4 v9, s[12:15], s35 offen offset:3072 lds
  s_add_u32 s35, s35, 262144
  s_cmp_eq_u32 s35, s47
  s_cselect_b32 s35, s46, s35
  v_mfma_f32_16x16x32_bf16 v[156:159], a[168:171], a[180:183], v[156:159]
  s_waitcnt vmcnt(15) lgkmcnt(0)
  s_barrier
  v_mfma_f32_16x16x32_bf16 v[64:67], a[96:99], a[128:131], v[64:67]
  ds_read_b128 a[172:175], v26 offset:0
  v_mfma_f32_16x16x32_bf16 v[68:71], a[96:99], a[132:135], v[68:71]
  ds_read_b128 a[176:179], v26 offset:2048
  s_add_u32 m0, s38, 65536
  s_nop 0
  buffer_load_dwordx4 v6, s[12:15], s35 offen offset:0 lds
  v_mfma_f32_16x16x32_bf16 v[72:75], a[96:99], a[136:139], v[72:75]
  ds_read_b128 a[180:183], v26 offset:4096
  v_mfma_f32_16x16x32_bf16 v[76:79], a[100:103], a[128:131], v[76:79]
  ds_read_b64_tr_b16 a[140:141], v17 offset:16384
  v_mfma_f32_16x16x32_bf16 v[80:83], a[100:103], a[132:135], v[80:83]
  ds_read_b64_tr_b16 a[142:143], v17 offset:18432
  buffer_load_dwordx4 v7, s[12:15], s35 offen offset:1024 lds
  v_mfma_f32_16x16x32_bf16 v[84:87], a[100:103], a[136:139], v[84:87]
  ds_read_b64_tr_b16 a[144:145], v18 offset:16384
  v_mfma_f32_16x16x32_bf16 v[88:91], a[104:107], a[128:131], v[88:91]
  ds_read_b64_tr_b16 a[146:147], v18 offset:18432
  v_mfma_f32_16x16x32_bf16 v[92:95], a[104:107], a[132:135], v[92:95]
  ds_read_b64_tr_b16 a[148:149], v19 offset:16384
  buffer_load_dwordx4 v8, s[12:15], s35 offen offset:2048 lds
  v_mfma_f32_16x16x32_bf16 v[96:99], a[104:107], a[136:139], v[96:99]
  ds_read_b64_tr_b16 a[150:151], v19 offset:18432
  v_mfma_f32_16x16x32_bf16 v[100:103], a[108:111], a[128:131], v[100:103]
  ds_read_b64_tr_b16 a[152:153], v20 offset:16384
  v_mfma_f32_16x16x32_bf16 v[104:107], a[108:111], a[132:135], v[104:107]
  ds_read_b64_tr_b16 a[154:155], v20 offset:18432
  buffer_load_dwordx4 v9, s[12:15], s35 offen offset:3072 lds
  s_add_u32 s35, s35, 262144
  s_cmp_eq_u32 s35, s47
  s_cselect_b32 s35, s46, s35
  v_mfma_f32_16x16x32_bf16 v[108:111], a[108:111], a[136:139], v[108:111]
  ds_read_b64_tr_b16 a[156:157], v21 offset:16384
  v_mfma_f32_16x16x32_bf16 v[112:115], a[112:115], a[128:131], v[112:115]
  ds_read_b64_tr_b16 a[158:159], v21 offset:18432
  v_mfma_f32_16x16x32_bf16 v[116:119], a[112:115], a[132:135], v[116:119]
  ds_read_b64_tr_b16 a[160:161], v22 offset:16384
  v_mfma_f32_16x16x32_bf16 v[120:123], a[112:115], a[136:139], v[120:123]
  ds_read_b64_tr_b16 a[162:163], v22 offset:18432
  v_mfma_f32_16x16x32_bf16 v[124:127], a[116:119], a[128:131], v[124:127]
  ds_read_b64_tr_b16 a[164:165], v23 offset:16384
  v_mfma_f32_16x16x32_bf16 v[128:131], a[116:119], a[132:135], v[128:131]
  ds_read_b64_tr_b16 a[166:167], v23 offset:18432
  v_mfma_f32_16x16x32_bf16 v[132:135], a[116:119], a[136:139], v[132:135]
  ds_read_b64_tr_b16 a[168:169], v24 offset:16384
  v_mfma_f32_16x16x32_bf16 v[136:139], a[120:123], a[128:131], v[136:139]
  ds_read_b64_tr_b16 a[170:171], v24 offset:18432
  v_mfma_f32_16x16x32_bf16 v[140:143], a[120:123], a[132:135], v[140:143]
  v_mfma_f32_16x16x32_bf16 v[144:147], a[120:123], a[136:139], v[144:147]
  v_mfma_f32_16x16x32_bf16 v[148:151], a[124:127], a[128:131], v[148:151]
  v_mfma_f32_16x16x32_bf16 v[152:155], a[124:127], a[132:135], v[152:155]
  v_mfma_f32_16x16x32_bf16 v[156:159], a[124:127], a[136:139], v[156:159]
  s_waitcnt vmcnt(8) lgkmcnt(0)
  s_barrier
  v_mfma_f32_16x16x32_bf16 v[64:67], a[140:143], a[172:175], v[64:67]
  ds_read_b128 a[128:131], v25 offset:12288
  s_add_u32 m0, s39, 0
  s_nop 0
  buffer_load_dwordx4 v10, s[8:11], s34 offen offset:0 lds
  v_mfma_f32_16x16x32_bf16 v[68:71], a[140:143], a[176:179], v[68:71]
  ds_read_b128 a[132:135], v25 offset:14336
  v_mfma_f32_16x16x32_bf16 v[72:75], a[140:143], a[180:183], v[72:75]
  ds_read_b128 a[136:139], v25 offset:16384
  buffer_load_dwordx4 v11, s[8:11], s34 offen offset:1024 lds
  v_mfma_f32_16x16x32_bf16 v[76:79], a[144:147], a[172:175], v[76:79]
  ds_read_b64_tr_b16 a[96:97], v17 offset:32768
  v_mfma_f32_16x16x32_bf16 v[80:83], a[144:147], a[176:179], v[80:83]
  ds_read_b64_tr_b16 a[98:99], v17 offset:34816
  buffer_load_dwordx4 v12, s[8:11], s34 offen offset:2048 lds
  s_add_u32 s34, s34, 128
  s_cmp_eq_u32 s34, s45
  s_cselect_b32 s34, s44, s34
  v_mfma_f32_16x16x32_bf16 v[84:87], a[144:147], a[180:183], v[84:87]
  ds_read_b64_tr_b16 a[100:101], v18 offset:32768
  v_mfma_f32_16x16x32_bf16 v[88:91], a[148:151], a[172:175], v[88:91]
  ds_read_b64_tr_b16 a[102:103], v18 offset:34816
  s_add_u32 m0, s38, 81920
  s_nop 0
  buffer_load_dwordx4 v6, s[12:15], s35 offen offset:0 lds
  v_mfma_f32_16x16x32_bf16 v[92:95], a[148:151], a[176:179], v[92:95]
  ds_read_b64_tr_b16 a[104:105], v19 offset:32768
  v_mfma_f32_16x16x32_bf16 v[96:99], a[148:151], a[180:183], v[96:99]
  ds_read_b64_tr_b16 a[106:107], v19 offset:34816
  buffer_load_dwordx4 v7, s[12:15], s35 offen offset:1024 lds
  v_mfma_f32_16x16x32_bf16 v[100:103], a[152:155], a[172:175], v[100:103]
  ds_read_b64_tr_b16 a[108:109], v20 offset:32768
  v_mfma_f32_16x16x32_bf16 v[104:107], a[152:155], a[176:179], v[104:107]
  ds_read_b64_tr_b16 a[110:111], v20 offset:34816
  buffer_load_dwordx4 v8, s[12:15], s35 offen offset:2048 lds
  v_mfma_f32_16x16x32_bf16 v[108:111], a[152:155], a[180:183], v[108:111]
  ds_read_b64_tr_b16 a[112:113], v21 offset:32768
  v_mfma_f32_16x16x32_bf16 v[112:115], a[156:159], a[172:175], v[112:115]
  ds_read_b64_tr_b16 a[114:115], v21 offset:34816
  v_mfma_f32_16x16x32_bf16 v[116:119], a[156:159], a[176:179], v[116:119]
  ds_read_b64_tr_b16 a[116:117], v22 offset:32768
  buffer_load_dwordx4 v9, s[12:15], s35 offen offset:3072 lds
  s_add_u32 s35, s35, 262144
  s_cmp_eq_u32 s35, s47
  s_cselect_b32 s35, s46, s35
  v_mfma_f32_16x16x32_bf16 v[120:123], a[156:159], a[180:183], v[120:123]
  ds_read_b64_tr_b16 a[118:119], v22 offset:34816
  v_mfma_f32_16x16x32_bf16 v[124:127], a[160:163], a[172:175], v[124:127]
  ds_read_b64_tr_b16 a[120:121], v23 offset:32768
  s_add_u32 m0, s38, 32768
  s_add_u32 s37, s36, 32768
  buffer_load_dwordx4 v4, s[16:19], s37 offen offset:0 nt lds
  v_mfma_f32_16x16x32_bf16 v[128:131], a[160:163], a[176:179], v[128:131]
  ds_read_b64_tr_b16 a[122:123], v23 offset:34816
  v_mfma_f32_16x16x32_bf16 v[132:135], a[160:163], a[180:183], v[132:135]
  ds_read_b64_tr_b16 a[124:125], v24 offset:32768
  buffer_load_dwordx4 v5, s[16:19], s37 offen offset:1024 nt lds
  v_mfma_f32_16x16x32_bf16 v[136:139], a[164:167], a[172:175], v[136:139]
  ds_read_b64_tr_b16 a[126:127], v24 offset:34816
  v_mfma_f32_16x16x32_bf16 v[140:143], a[164:167], a[176:179], v[140:143]
  buffer_load_dwordx4 v4, s[16:19], s37 offen offset:2048 nt lds
  v_mfma_f32_16x16x32_bf16 v[144:147], a[164:167], a[180:183], v[144:147]
  v_mfma_f32_16x16x32_bf16 v[148:151], a[168:171], a[172:175], v[148:151]
  buffer_load_dwordx4 v5, s[16:19], s37 offen offset:3072 nt lds
  v_mfma_f32_16x16x32_bf16 v[152:155], a[168:171], a[176:179], v[152:155]
  v_mfma_f32_16x16x32_bf16 v[156:159], a[168:171], a[180:183], v[156:159]
  s_waitcnt vmcnt(15) lgkmcnt(0)
  s_barrier
  v_mfma_f32_16x16x32_bf16 v[64:67], a[96:99], a[128:131], v[64:67]
  ds_read_b128 a[172:175], v26 offset:12288
  v_mfma_f32_16x16x32_bf16 v[68:71], a[96:99], a[132:135], v[68:71]
  ds_read_b128 a[176:179], v26 offset:14336
  s_add_u32 m0, s38, 98304
  s_nop 0
  buffer_load_dwordx4 v6, s[12:15], s35 offen offset:0 lds
  v_mfma_f32_16x16x32_bf16 v[72:75], a[96:99], a[136:139], v[72:75]
  ds_read_b128 a[180:183], v26 offset:16384
  v_mfma_f32_16x16x32_bf16 v[76:79], a[100:103], a[128:131], v[76:79]
  ds_read_b64_tr_b16 a[140:141], v17 offset:49152
  v_mfma_f32_16x16x32_bf16 v[80:83], a[100:103], a[132:135], v[80:83]
  ds_read_b64_tr_b16 a[142:143], v17 offset:51200
  buffer_load_dwordx4 v7, s[12:15], s35 offen offset:1024 lds
  v_mfma_f32_16x16x32_bf16 v[84:87], a[100:103], a[136:139], v[84:87]
  ds_read_b64_tr_b16 a[144:145], v18 offset:49152
  v_mfma_f32_16x16x32_bf16 v[88:91], a[104:107], a[128:131], v[88:91]
  ds_read_b64_tr_b16 a[146:147], v18 offset:51200
  v_mfma_f32_16x16x32_bf16 v[92:95], a[104:107], a[132:135], v[92:95]
  ds_read_b64_tr_b16 a[148:149], v19 offset:49152
  buffer_load_dwordx4 v8, s[12:15], s35 offen offset:2048 lds
  v_mfma_f32_16x16x32_bf16 v[96:99], a[104:107], a[136:139], v[96:99]
  ds_read_b64_tr_b16 a[150:151], v19 offset:51200
  v_mfma_f32_16x16x32_bf16 v[100:103], a[108:111], a[128:131], v[100:103]
  ds_read_b64_tr_b16 a[152:153], v20 offset:49152
  v_mfma_f32_16x16x32_bf16 v[104:107], a[108:111], a[132:135], v[104:107]
  ds_read_b64_tr_b16 a[154:155], v20 offset:51200
  buffer_load_dwordx4 v9, s[12:15], s35 offen offset:3072 lds
  s_add_u32 s35, s35, 262144
  s_cmp_eq_u32 s35, s47
  s_cselect_b32 s35, s46, s35
  v_mfma_f32_16x16x32_bf16 v[108:111], a[108:111], a[136:139], v[108:111]
  ds_read_b64_tr_b16 a[156:157], v21 offset:49152
  v_mfma_f32_16x16x32_bf16 v[112:115], a[112:115], a[128:131], v[112:115]
  ds_read_b64_tr_b16 a[158:159], v21 offset:51200
  v_mfma_f32_16x16x32_bf16 v[116:119], a[112:115], a[132:135], v[116:119]
  ds_read_b64_tr_b16 a[160:161], v22 offset:49152
  v_mfma_f32_16x16x32_bf16 v[120:123], a[112:115], a[136:139], v[120:123]
  ds_read_b64_tr_b16 a[162:163], v22 offset:51200
  v_mfma_f32_16x16x32_bf16 v[124:127], a[116:119], a[128:131], v[124:127]
  ds_read_b64_tr_b16 a[164:165], v23 offset:49152
  v_mfma_f32_16x16x32_bf16 v[128:131], a[116:119], a[132:135], v[128:131]
  ds_read_b64_tr_b16 a[166:167], v23 offset:51200
  v_mfma_f32_16x16x32_bf16 v[132:135], a[116:119], a[136:139], v[132:135]
  ds_read_b64_tr_b16 a[168:169], v24 offset:49152
  v_mfma_f32_16x16x32_bf16 v[136:139], a[120:123], a[128:131], v[136:139]
  ds_read_b64_tr_b16 a[170:171], v24 offset:51200
  v_mfma_f32_16x16x32_bf16 v[140:143], a[120:123], a[132:135], v[140:143]
  v_mfma_f32_16x16x32_bf16 v[144:147], a[120:123], a[136:139], v[144:147]
  v_mfma_f32_16x16x32_bf16 v[148:151], a[124:127], a[128:131], v[148:151]
  v_mfma_f32_16x16x32_bf16 v[152:155], a[124:127], a[132:135], v[152:155]
  v_mfma_f32_16x16x32_bf16 v[156:159], a[124:127], a[136:139], v[156:159]
  s_waitcnt vmcnt(12) lgkmcnt(0)
  s_barrier
  v_mfma_f32_16x16x32_bf16 v[64:67], a[140:143], a[172:175], v[64:67]
  ds_read_b128 a[128:131], v25 offset:0
  v_mfma_f32_16x16x32_bf16 v[68:71], a[140:143], a[176:179], v[68:71]
  ds_read_b128 a[132:135], v25 offset:2048
  v_mfma_f32_16x16x32_bf16 v[72:75], a[140:143], a[180:183], v[72:75]
  ds_read_b128 a[136:139], v25 offset:4096
  v_mfma_f32_16x16x32_bf16 v[76:79], a[144:147], a[172:175], v[76:79]
  ds_read_b64_tr_b16 a[96:97], v17 offset:0
  v_mfma_f32_16x16x32_bf16 v[80:83], a[144:147], a[176:179], v[80:83]
  ds_read_b64_tr_b16 a[98:99], v17 offset:2048
  v_mfma_f32_16x16x32_bf16 v[84:87], a[144:147], a[180:183], v[84:87]
  ds_read_b64_tr_b16 a[100:101], v18 offset:0
  v_mfma_f32_16x16x32_bf16 v[88:91], a[148:151], a[172:175], v[88:91]
  ds_read_b64_tr_b16 a[102:103], v18 offset:2048
  v_mfma_f32_16x16x32_bf16 v[92:95], a[148:151], a[176:179], v[92:95]
  ds_read_b64_tr_b16 a[104:105], v19 offset:0
  v_mfma_f32_16x16x32_bf16 v[96:99], a[148:151], a[180:183], v[96:99]
  ds_read_b64_tr_b16 a[106:107], v19 offset:2048
  v_mfma_f32_16x16x32_bf16 v[100:103], a[152:155], a[172:175], v[100:103]
  ds_read_b64_tr_b16 a[108:109], v20 offset:0
  v_mfma_f32_16x16x32_bf16 v[104:107], a[152:155], a[176:179], v[104:107]
  ds_read_b64_tr_b16 a[110:111], v20 offset:2048
  v_mfma_f32_16x16x32_bf16 v[108:111], a[152:155], a[180:183], v[108:111]
  ds_read_b64_tr_b16 a[112:113], v21 offset:0
  v_mfma_f32_16x16x32_bf16 v[112:115], a[156:159], a[172:175], v[112:115]
  ds_read_b64_tr_b16 a[114:115], v21 offset:2048
  v_mfma_f32_16x16x32_bf16 v[116:119], a[156:159], a[176:179], v[116:119]
  ds_read_b64_tr_b16 a[116:117], v22 offset:0
  v_mfma_f32_16x16x32_bf16 v[120:123], a[156:159], a[180:183], v[120:123]
  ds_read_b64_tr_b16 a[118:119], v22 offset:2048
  s_add_u32 m0, s39, 12288
  s_nop 0
  buffer_load_dwordx4 v10, s[8:11], s34 offen offset:0 lds
  v_mfma_f32_16x16x32_bf16 v[124:127], a[160:163], a[172:175], v[124:127]
  ds_read_b64_tr_b16 a[120:121], v23 offset:0
  buffer_load_dwordx4 v11, s[8:11], s34 offen offset:1024 lds
  v_mfma_f32_16x16x32_bf16 v[128:131], a[160:163], a[176:179], v[128:131]
  ds_read_b64_tr_b16 a[122:123], v23 offset:2048
  buffer_load_dwordx4 v12, s[8:11], s34 offen offset:2048 lds
  s_add_u32 s34, s34, 128
  s_cmp_eq_u32 s34, s45
  s_cselect_b32 s34, s44, s34
  v_mfma_f32_16x16x32_bf16 v[132:135], a[160:163], a[180:183], v[132:135]
  ds_read_b64_tr_b16 a[124:125], v24 offset:0
  v_mfma_f32_16x16x32_bf16 v[136:139], a[164:167], a[172:175], v[136:139]
  ds_read_b64_tr_b16 a[126:127], v24 offset:2048
  s_add_u32 m0, s38, 114688
  s_nop 0
  buffer_load_dwordx4 v6, s[12:15], s35 offen offset:0 lds
  v_mfma_f32_16x16x32_bf16 v[140:143], a[164:167], a[176:179], v[140:143]
  buffer_load_dwordx4 v7, s[12:15], s35 offen offset:1024 lds
  v_mfma_f32_16x16x32_bf16 v[144:147], a[164:167], a[180:183], v[144:147]
  v_mfma_f32_16x16x32_bf16 v[148:151], a[168:171], a[172:175], v[148:151]
  buffer_load_dwordx4 v8, s[12:15], s35 offen offset:2048 lds
  v_mfma_f32_16x16x32_bf16 v[152:155], a[168:171], a[176:179], v[152:155]
  buffer_load_dwordx4 v9, s[12:15], s35 offen offset:3072 lds
  s_add_u32 s35, s35, 262144
  s_cmp_eq_u32 s35, s47
  s_cselect_b32 s35, s46, s35
  v_mfma_f32_16x16x32_bf16 v[156:159], a[168:171], a[180:183], v[156:159]
  s_waitcnt vmcnt(15) lgkmcnt(0)
  s_barrier
  v_mfma_f32_16x16x32_bf16 v[64:67], a[96:99], a[128:131], v[64:67]
  ds_read_b128 a[172:175], v26 offset:0
  v_mfma_f32_16x16x32_bf16 v[68:71], a[96:99], a[132:135], v[68:71]
  ds_read_b128 a[176:179], v26 offset:2048
  s_add_u32 m0, s38, 65536
  s_nop 0
  buffer_load_dwordx4 v6, s[12:15], s35 offen offset:0 lds
  v_mfma_f32_16x16x32_bf16 v[72:75], a[96:99], a[136:139], v[72:75]
  ds_read_b128 a[180:183], v26 offset:4096
  v_mfma_f32_16x16x32_bf16 v[76:79], a[100:103], a[128:131], v[76:79]
  ds_read_b64_tr_b16 a[140:141], v17 offset:16384
  v_mfma_f32_16x16x32_bf16 v[80:83], a[100:103], a[132:135], v[80:83]
  ds_read_b64_tr_b16 a[142:143], v17 offset:18432
  buffer_load_dwordx4 v7, s[12:15], s35 offen offset:1024 lds
  v_mfma_f32_16x16x32_bf16 v[84:87], a[100:103], a[136:139], v[84:87]
  ds_read_b64_tr_b16 a[144:145], v18 offset:16384
  v_mfma_f32_16x16x32_bf16 v[88:91], a[104:107], a[128:131], v[88:91]
  ds_read_b64_tr_b16 a[146:147], v18 offset:18432
  v_mfma_f32_16x16x32_bf16 v[92:95], a[104:107], a[132:135], v[92:95]
  ds_read_b64_tr_b16 a[148:149], v19 offset:16384
  buffer_load_dwordx4 v8, s[12:15], s35 offen offset:2048 lds
  v_mfma_f32_16x16x32_bf16 v[96:99], a[104:107], a[136:139], v[96:99]
  ds_read_b64_tr_b16 a[150:151], v19 offset:18432
  v_mfma_f32_16x16x32_bf16 v[100:103], a[108:111], a[128:131], v[100:103]
  ds_read_b64_tr_b16 a[152:153], v20 offset:16384
  v_mfma_f32_16x16x32_bf16 v[104:107], a[108:111], a[132:135], v[104:107]
  ds_read_b64_tr_b16 a[154:155], v20 offset:18432
  buffer_load_dwordx4 v9, s[12:15], s35 offen offset:3072 lds
  s_add_u32 s35, s35, 262144
  s_cmp_eq_u32 s35, s47
  s_cselect_b32 s35, s46, s35
  v_mfma_f32_16x16x32_bf16 v[108:111], a[108:111], a[136:139], v[108:111]
  ds_read_b64_tr_b16 a[156:157], v21 offset:16384
  v_mfma_f32_16x16x32_bf16 v[112:115], a[112:115], a[128:131], v[112:115]
  ds_read_b64_tr_b16 a[158:159], v21 offset:18432
  v_mfma_f32_16x16x32_bf16 v[116:119], a[112:115], a[132:135], v[116:119]
  ds_read_b64_tr_b16 a[160:161], v22 offset:16384
  v_mfma_f32_16x16x32_bf16 v[120:123], a[112:115], a[136:139], v[120:123]
  ds_read_b64_tr_b16 a[162:163], v22 offset:18432
  v_mfma_f32_16x16x32_bf16 v[124:127], a[116:119], a[128:131], v[124:127]
  ds_read_b64_tr_b16 a[164:165], v23 offset:16384
  v_mfma_f32_16x16x32_bf16 v[128:131], a[116:119], a[132:135], v[128:131]
  ds_read_b64_tr_b16 a[166:167], v23 offset:18432
  v_mfma_f32_16x16x32_bf16 v[132:135], a[116:119], a[136:139], v[132:135]
  ds_read_b64_tr_b16 a[168:169], v24 offset:16384
  v_mfma_f32_16x16x32_bf16 v[136:139], a[120:123], a[128:131], v[136:139]
  ds_read_b64_tr_b16 a[170:171], v24 offset:18432
  v_mfma_f32_16x16x32_bf16 v[140:143], a[120:123], a[132:135], v[140:143]
  v_mfma_f32_16x16x32_bf16 v[144:147], a[120:123], a[136:139], v[144:147]
  v_mfma_f32_16x16x32_bf16 v[148:151], a[124:127], a[128:131], v[148:151]
  v_mfma_f32_16x16x32_bf16 v[152:155], a[124:127], a[132:135], v[152:155]
  v_mfma_f32_16x16x32_bf16 v[156:159], a[124:127], a[136:139], v[156:159]
  s_waitcnt vmcnt(8) lgkmcnt(0)
  s_barrier
  v_mfma_f32_16x16x32_bf16 v[64:67], a[140:143], a[172:175], v[64:67]
  ds_read_b128 a[128:131], v25 offset:12288
  s_add_u32 m0, s39, 0
  s_nop 0
  buffer_load_dwordx4 v10, s[8:11], s34 offen offset:0 lds
  v_mfma_f32_16x16x32_bf16 v[68:71], a[140:143], a[176:179], v[68:71]
  ds_read_b128 a[132:135], v25 offset:14336
  v_mfma_f32_16x16x32_bf16 v[72:75], a[140:143], a[180:183], v[72:75]
  ds_read_b128 a[136:139], v25 offset:16384
  buffer_load_dwordx4 v11, s[8:11], s34 offen offset:1024 lds
  v_mfma_f32_16x16x32_bf16 v[76:79], a[144:147], a[172:175], v[76:79]
  ds_read_b64_tr_b16 a[96:97], v17 offset:32768
  v_mfma_f32_16x16x32_bf16 v[80:83], a[144:147], a[176:179], v[80:83]
  ds_read_b64_tr_b16 a[98:99], v17 offset:34816
  buffer_load_dwordx4 v12, s[8:11], s34 offen offset:2048 lds
  s_add_u32 s34, s34, 128
  s_cmp_eq_u32 s34, s45
  s_cselect_b32 s34, s44, s34
  v_mfma_f32_16x16x32_bf16 v[84:87], a[144:147], a[180:183], v[84:87]
  ds_read_b64_tr_b16 a[100:101], v18 offset:32768
  v_mfma_f32_16x16x32_bf16 v[88:91], a[148:151], a[172:175], v[88:91]
  ds_read_b64_tr_b16 a[102:103], v18 offset:34816
  s_add_u32 m0, s38, 81920
  s_nop 0
  buffer_load_dwordx4 v6, s[12:15], s35 offen offset:0 lds
  v_mfma_f32_16x16x32_bf16 v[92:95], a[148:151], a[176:179], v[92:95]
  ds_read_b64_tr_b16 a[104:105], v19 offset:32768
  v_mfma_f32_16x16x32_bf16 v[96:99], a[148:151], a[180:183], v[96:99]
  ds_read_b64_tr_b16 a[106:107], v19 offset:34816
  buffer_load_dwordx4 v7, s[12:15], s35 offen offset:1024 lds
  v_mfma_f32_16x16x32_bf16 v[100:103], a[152:155], a[172:175], v[100:103]
  ds_read_b64_tr_b16 a[108:109], v20 offset:32768
  v_mfma_f32_16x16x32_bf16 v[104:107], a[152:155], a[176:179], v[104:107]
  ds_read_b64_tr_b16 a[110:111], v20 offset:34816
  buffer_load_dwordx4 v8, s[12:15], s35 offen offset:2048 lds
  v_mfma_f32_16x16x32_bf16 v[108:111], a[152:155], a[180:183], v[108:111]
  ds_read_b64_tr_b16 a[112:113], v21 offset:32768
  v_mfma_f32_16x16x32_bf16 v[112:115], a[156:159], a[172:175], v[112:115]
  ds_read_b64_tr_b16 a[114:115], v21 offset:34816
  v_mfma_f32_16x16x32_bf16 v[116:119], a[156:159], a[176:179], v[116:119]
  ds_read_b64_tr_b16 a[116:117], v22 offset:32768
  buffer_load_dwordx4 v9, s[12:15], s35 offen offset:3072 lds
  s_add_u32 s35, s35, 262144
  s_cmp_eq_u32 s35, s47
  s_cselect_b32 s35, s46, s35
  v_mfma_f32_16x16x32_bf16 v[120:123], a[156:159], a[180:183], v[120:123]
  ds_read_b64_tr_b16 a[118:119], v22 offset:34816
  v_mfma_f32_16x16x32_bf16 v[124:127], a[160:163], a[172:175], v[124:127]
  ds_read_b64_tr_b16 a[120:121], v23 offset:32768
  s_add_u32 m0, s38, 49152
  s_add_u32 s37, s36, 49152
  buffer_load_dwordx4 v4, s[16:19], s37 offen offset:0 nt lds
  v_mfma_f32_16x16x32_bf16 v[128:131], a[160:163], a[176:179], v[128:131]
  ds_read_b64_tr_b16 a[122:123], v23 offset:34816
  v_mfma_f32_16x16x32_bf16 v[132:135], a[160:163], a[180:183], v[132:135]
  ds_read_b64_tr_b16 a[124:125], v24 offset:32768
  buffer_load_dwordx4 v5, s[16:19], s37 offen offset:1024 nt lds
  v_mfma_f32_16x16x32_bf16 v[136:139], a[164:167], a[172:175], v[136:139]
  ds_read_b64_tr_b16 a[126:127], v24 offset:34816
  v_mfma_f32_16x16x32_bf16 v[140:143], a[164:167], a[176:179], v[140:143]
  buffer_load_dwordx4 v4, s[16:19], s37 offen offset:2048 nt lds
  v_mfma_f32_16x16x32_bf16 v[144:147], a[164:167], a[180:183], v[144:147]
  v_mfma_f32_16x16x32_bf16 v[148:151], a[168:171], a[172:175], v[148:151]
  buffer_load_dwordx4 v5, s[16:19], s37 offen offset:3072 nt lds
  v_mfma_f32_16x16x32_bf16 v[152:155], a[168:171], a[176:179], v[152:155]
  v_mfma_f32_16x16x32_bf16 v[156:159], a[168:171], a[180:183], v[156:159]
  s_waitcnt vmcnt(15) lgkmcnt(0)
  s_barrier
  v_mfma_f32_16x16x32_bf16 v[64:67], a[96:99], a[128:131], v[64:67]
  ds_read_b128 a[172:175], v26 offset:12288
  v_mfma_f32_16x16x32_bf16 v[68:71], a[96:99], a[132:135], v[68:71]
  ds_read_b128 a[176:179], v26 offset:14336
  s_add_u32 m0, s38, 98304
  s_nop 0
  buffer_load_dwordx4 v6, s[12:15], s35 offen offset:0 lds
  v_mfma_f32_16x16x32_bf16 v[72:75], a[96:99], a[136:139], v[72:75]
L_ws3:
  s_cbranch_execz L_wa_back
  ds_read_b128 a[180:183], v26 offset:16384
  v_mfma_f32_16x16x32_bf16 v[76:79], a[100:103], a[128:131], v[76:79]
  ds_read_b64_tr_b16 a[140:141], v17 offset:49152
  v_mfma_f32_16x16x32_bf16 v[80:83], a[100:103], a[132:135], v[80:83]
  ds_read_b64_tr_b16 a[142:143], v17 offset:51200
  buffer_load_dwordx4 v7, s[12:15], s35 offen offset:1024 lds
  v_mfma_f32_16x16x32_bf16 v[84:87], a[100:103], a[136:139], v[84:87]
  ds_read_b64_tr_b16 a[144:145], v18 offset:49152
  v_mfma_f32_16x16x32_bf16 v[88:91], a[104:107], a[128:131], v[88:91]
  ds_read_b64_tr_b16 a[146:147], v18 offset:51200
  v_mfma_f32_16x16x32_bf16 v[92:95], a[104:107], a[132:135], v[92:95]
  ds_read_b64_tr_b16 a[148:149], v19 offset:49152
  buffer_load_dwordx4 v8, s[12:15], s35 offen offset:2048 lds
  v_mfma_f32_16x16x32_bf16 v[96:99], a[104:107], a[136:139], v[96:99]
  ds_read_b64_tr_b16 a[150:151], v19 offset:51200
  v_mfma_f32_16x16x32_bf16 v[100:103], a[108:111], a[128:131], v[100:103]
  ds_read_b64_tr_b16 a[152:153], v20 offset:49152
  v_mfma_f32_16x16x32_bf16 v[104:107], a[108:111], a[132:135], v[104:107]
  ds_read_b64_tr_b16 a[154:155], v20 offset:51200
  buffer_load_dwordx4 v9, s[12:15], s35 offen offset:3072 lds
  s_add_u32 s35, s35, 262144
  s_cmp_eq_u32 s35, s47
  s_cselect_b32 s35, s46, s35
  v_mfma_f32_16x16x32_bf16 v[108:111], a[108:111], a[136:139], v[108:111]
  ds_read_b64_tr_b16 a[156:157], v21 offset:49152
  v_mfma_f32_16x16x32_bf16 v[112:115], a[112:115], a[128:131], v[112:115]
  ds_read_b64_tr_b16 a[158:159], v21 offset:51200
  v_mfma_f32_16x16x32_bf16 v[116:119], a[112:115], a[132:135], v[116:119]
  ds_read_b64_tr_b16 a[160:161], v22 offset:49152
  v_mfma_f32_16x16x32_bf16 v[120:123], a[112:115], a[136:139], v[120:123]
  ds_read_b64_tr_b16 a[162:163], v22 offset:51200
  v_mfma_f32_16x16x32_bf16 v[124:127], a[116:119], a[128:131], v[124:127]
  ds_read_b64_tr_b16 a[164:165], v23 offset:49152
L_ws4:
  s_cbranch_execz L_wa_back
  v_mfma_f32_16x16x32_bf16 v[128:131], a[116:119], a[132:135], v[128:131]
  ds_read_b64_tr_b16 a[166:167], v23 offset:51200
  v_mfma_f32_16x16x32_bf16 v[132:135], a[116:119], a[136:139], v[132:135]
  ds_read_b64_tr_b16 a[168:169], v24 offset:49152
  v_mfma_f32_16x16x32_bf16 v[136:139], a[120:123], a[128:131], v[136:139]
  ds_read_b64_tr_b16 a[170:171], v24 offset:51200
  v_mfma_f32_16x16x32_bf16 v[140:143], a[120:123], a[132:135], v[140:143]
  v_mfma_f32_16x16x32_bf16 v[144:147], a[120:123], a[136:139], v[144:147]
  v_mfma_f32_16x16x32_bf16 v[148:151], a[124:127], a[128:131], v[148:151]
  v_mfma_f32_16x16x32_bf16 v[152:155], a[124:127], a[132:135], v[152:155]
  v_mfma_f32_16x16x32_bf16 v[156:159], a[124:127], a[136:139], v[156:159]
  s_waitcnt vmcnt(12) lgkmcnt(0)
  s_barrier
  v_mfma_f32_16x16x32_bf16 v[64:67], a[140:143], a[172:175], v[64:67]
  ds_read_b128 a[128:131], v25 offset:0
  v_mfma_f32_16x16x32_bf16 v[68:71], a[140:143], a[176:179], v[68:71]
  ds_read_b128 a[132:135], v25 offset:2048
  v_mfma_f32_16x16x32_bf16 v[72:75], a[140:143], a[180:183], v[72:75]
  ds_read_b128 a[136:139], v25 offset:4096
  v_mfma_f32_16x16x32_bf16 v[76:79], a[144:147], a[172:175], v[76:79]
  ds_read_b64_tr_b16 a[96:97], v17 offset:0
  v_mfma_f32_16x16x32_bf16 v[80:83], a[144:147], a[176:179], v[80:83]
  ds_read_b64_tr_b16 a[98:99], v17 offset:2048
  v_mfma_f32_16x16x32_bf16 v[84:87], a[144:147], a[180:183], v[84:87]
  ds_read_b64_tr_b16 a[100:101], v18 offset:0
  v_mfma_f32_16x16x32_bf16 v[88:91], a[148:151], a[172:175], v[88:91]
  ds_read_b64_tr_b16 a[102:103], v18 offset:2048
  v_mfma_f32_16x16x32_bf16 v[92:95], a[148:151], a[176:179], v[92:95]
  ds_read_b64_tr_b16 a[104:105], v19 offset:0
  v_mfma_f32_16x16x32_bf16 v[96:99], a[148:151], a[180:183], v[96:99]
  ds_read_b64_tr_b16 a[106:107], v19 offset:2048
  v_mfma_f32_16x16x32_bf16 v[100:103], a[152:155], a[172:175], v[100:103]
L_ws5:
  s_cbranch_execz L_wa_back
  ds_read_b64_tr_b16 a[108:109], v20 offset:0
  v_mfma_f32_16x16x32_bf16 v[104:107], a[152:155], a[176:179], v[104:107]
  ds_read_b64_tr_b16 a[110:111], v20 offset:2048
  v_mfma_f32_16x16x32_bf16 v[108:111], a[152:155], a[180:183], v[108:111]
  ds_read_b64_tr_b16 a[112:113], v21 offset:0
  v_mfma_f32_16x16x32_bf16 v[112:115], a[156:159], a[172:175], v[112:115]
  ds_read_b64_tr_b16 a[114:115], v21 offset:2048
  v_mfma_f32_16x16x32_bf16 v[116:119], a[156:159], a[176:179], v[116:119]
  ds_read_b64_tr_b16 a[116:117], v22 offset:0
  v_mfma_f32_16x16x32_bf16 v[120:123], a[156:159], a[180:183], v[120:123]
  ds_read_b64_tr_b16 a[118:119], v22 offset:2048
  s_add_u32 m0, s39, 12288
  s_nop 0
  buffer_load_dwordx4 v10, s[8:11], s34 offen offset:0 lds
  v_mfma_f32_16x16x32_bf16 v[124:127], a[160:163], a[172:175], v[124:127]
  ds_read_b64_tr_b16 a[120:121], v23 offset:0
  buffer_load_dwordx4 v11, s[8:11], s34 offen offset:1024 lds
  v_mfma_f32_16x16x32_bf16 v[128:131], a[160:163], a[176:179], v[128:131]
  ds_read_b64_tr_b16 a[122:123], v23 offset:2048
  buffer_load_dwordx4 v12, s[8:11], s34 offen offset:2048 lds
  s_add_u32 s34, s34, 128
  s_cmp_eq_u32 s34, s45
  s_cselect_b32 s34, s44, s34
  v_mfma_f32_16x16x32_bf16 v[132:135], a[160:163], a[180:183], v[132:135]
  ds_read_b64_tr_b16 a[124:125], v24 offset:0
  v_mfma_f32_16x16x32_bf16 v[136:139], a[164:167], a[172:175], v[136:139]
  ds_read_b64_tr_b16 a[126:127], v24 offset:2048
  s_add_u32 m0, s38, 114688
  s_nop 0
  buffer_load_dwordx4 v6, s[12:15], s35 offen offset:0 lds
  v_mfma_f32_16x16x32_bf16 v[140:143], a[164:167], a[176:179], v[140:143]
  buffer_load_dwordx4 v7, s[12:15], s35 offen offset:1024 lds
  v_mfma_f32_16x16x32_bf16 v[144:147], a[164:167], a[180:183], v[144:147]
  v_mfma_f32_16x16x32_bf16 v[148:151], a[168:171], a[172:175], v[148:151]
L_ws6:
  s_cbranch_execz L_wa_back
  buffer_load_dwordx4 v8, s[12:15], s35 offen offset:2048 lds
  v_mfma_f32_16x16x32_bf16 v[152:155], a[168:171], a[176:179], v[152:155]
  buffer_load_dwordx4 v9, s[12:15], s35 offen offset:3072 lds
  s_add_u32 s35, s35, 262144
  s_cmp_eq_u32 s35, s47
  s_cselect_b32 s35, s46, s35
  v_mfma_f32_16x16x32_bf16 v[156:159], a[168:171], a[180:183], v[156:159]
  s_waitcnt vmcnt(15) lgkmcnt(0)
  s_barrier
  v_mfma_f32_16x16x32_bf16 v[64:67], a[96:99], a[128:131], v[64:67]
  ds_read_b128 a[172:175], v26 offset:0
  s_add_u32 m0, s38, 65536
  s_add_u32 s37, s36, 65536
  buffer_load_dwordx4 v4, s[16:19], s37 offen offset:0 nt lds
  v_mfma_f32_16x16x32_bf16 v[68:71], a[96:99], a[132:135], v[68:71]
  ds_read_b128 a[176:179], v26 offset:2048
  v_mfma_f32_16x16x32_bf16 v[72:75], a[96:99], a[136:139], v[72:75]
  ds_read_b128 a[180:183], v26 offset:4096
  buffer_load_dwordx4 v5, s[16:19], s37 offen offset:1024 nt lds
  v_mfma_f32_16x16x32_bf16 v[76:79], a[100:103], a[128:131], v[76:79]
  ds_read_b64_tr_b16 a[140:141], v17 offset:16384
  v_mfma_f32_16x16x32_bf16 v[80:83], a[100:103], a[132:135], v[80:83]
  ds_read_b64_tr_b16 a[142:143], v17 offset:18432
  buffer_load_dwordx4 v4, s[16:19], s37 offen offset:2048 nt lds
  v_mfma_f32_16x16x32_bf16 v[84:87], a[100:103], a[136:139], v[84:87]
  ds_read_b64_tr_b16 a[144:145], v18 offset:16384
  v_mfma_f32_16x16x32_bf16 v[88:91], a[104:107], a[128:131], v[88:91]
  ds_read_b64_tr_b16 a[146:147], v18 offset:18432
  v_mfma_f32_16x16x32_bf16 v[92:95], a[104:107], a[132:135], v[92:95]
  ds_read_b64_tr_b16 a[148:149], v19 offset:16384
  v_mfma_f32_16x16x32_bf16 v[96:99], a[104:107], a[136:139], v[96:99]
  ds_read_b64_tr_b16 a[150:151], v19 offset:18432
  buffer_load_dwordx4 v5, s[16:19], s37 offen offset:3072 nt lds
L_ws7:
  s_cbranch_execz L_wa_back
  v_mfma_f32_16x16x32_bf16 v[100:103], a[108:111], a[128:131], v[100:103]
  ds_read_b64_tr_b16 a[152:153], v20 offset:16384
  v_mfma_f32_16x16x32_bf16 v[104:107], a[108:111], a[132:135], v[104:107]
  ds_read_b64_tr_b16 a[154:155], v20 offset:18432
  v_mfma_f32_16x16x32_bf16 v[108:111], a[108:111], a[136:139], v[108:111]
  ds_read_b64_tr_b16 a[156:157], v21 offset:16384
  v_mfma_f32_16x16x32_bf16 v[112:115], a[112:115], a[128:131], v[112:115]
  ds_read_b64_tr_b16 a[158:159], v21 offset:18432
  v_mfma_f32_16x16x32_bf16 v[116:119], a[112:115], a[132:135], v[116:119]
  ds_read_b64_tr_b16 a[160:161], v22 offset:16384
  v_mfma_f32_16x16x32_bf16 v[120:123], a[112:115], a[136:139], v[120:123]
  ds_read_b64_tr_b16 a[162:163], v22 offset:18432
  v_mfma_f32_16x16x32_bf16 v[124:127], a[116:119], a[128:131], v[124:127]
  ds_read_b64_tr_b16 a[164:165], v23 offset:16384
  v_mfma_f32_16x16x32_bf16 v[128:131], a[116:119], a[132:135], v[128:131]
  ds_read_b64_tr_b16 a[166:167], v23 offset:18432
  v_mfma_f32_16x16x32_bf16 v[132:135], a[116:119], a[136:139], v[132:135]
  ds_read_b64_tr_b16 a[168:169], v24 offset:16384
  v_mfma_f32_16x16x32_bf16 v[136:139], a[120:123], a[128:131], v[136:139]
  ds_read_b64_tr_b16 a[170:171], v24 offset:18432
  v_mfma_f32_16x16x32_bf16 v[140:143], a[120:123], a[132:135], v[140:143]
  v_mfma_f32_16x16x32_bf16 v[144:147], a[120:123], a[136:139], v[144:147]
  v_mfma_f32_16x16x32_bf16 v[148:151], a[124:127], a[128:131], v[148:151]
  v_mfma_f32_16x16x32_bf16 v[152:155], a[124:127], a[132:135], v[152:155]
  v_mfma_f32_16x16x32_bf16 v[156:159], a[124:127], a[136:139], v[156:159]
  s_waitcnt vmcnt(8) lgkmcnt(0)
  s_barrier
  v_mfma_f32_16x16x32_bf16 v[64:67], a[140:143], a[172:175], v[64:67]
  ds_read_b128 a[128:131], v25 offset:12288
  s_add_u32 m0, s38, 81920
  s_add_u32 s37, s36, 81920
  buffer_load_dwordx4 v4, s[16:19], s37 offen offset:0 nt lds
  v_mfma_f32_16x16x32_bf16 v[68:71], a[140:143], a[176:179], v[68:71]
L_ws8:
  s_cbranch_execz L_wa_back
  ds_read_b128 a[132:135], v25 offset:14336
  v_mfma_f32_16x16x32_bf16 v[72:75], a[140:143], a[180:183], v[72:75]
  ds_read_b128 a[136:139], v25 offset:16384
  buffer_load_dwordx4 v5, s[16:19], s37 offen offset:1024 nt lds
  v_mfma_f32_16x16x32_bf16 v[76:79], a[144:147], a[172:175], v[76:79]
  ds_read_b64_tr_b16 a[96:97], v17 offset:32768
  v_mfma_f32_16x16x32_bf16 v[80:83], a[144:147], a[176:179], v[80:83]
  ds_read_b64_tr_b16 a[98:99], v17 offset:34816
  buffer_load_dwordx4 v4, s[16:19], s37 offen offset:2048 nt lds
  v_mfma_f32_16x16x32_bf16 v[84:87], a[144:147], a[180:183], v[84:87]
  ds_read_b64_tr_b16 a[100:101], v18 offset:32768
  v_mfma_f32_16x16x32_bf16 v[88:91], a[148:151], a[172:175], v[88:91]
  ds_read_b64_tr_b16 a[102:103], v18 offset:34816
  buffer_load_dwordx4 v5, s[16:19], s37 offen offset:3072 nt lds
  v_mfma_f32_16x16x32_bf16 v[92:95], a[148:151], a[176:179], v[92:95]
  ds_read_b64_tr_b16 a[104:105], v19 offset:32768
  v_mfma_f32_16x16x32_bf16 v[96:99], a[148:151], a[180:183], v[96:99]
  ds_read_b64_tr_b16 a[106:107], v19 offset:34816
  v_mfma_f32_16x16x32_bf16 v[100:103], a[152:155], a[172:175], v[100:103]
  ds_read_b64_tr_b16 a[108:109], v20 offset:32768
  v_mfma_f32_16x16x32_bf16 v[104:107], a[152:155], a[176:179], v[104:107]
  ds_read_b64_tr_b16 a[110:111], v20 offset:34816
  v_mfma_f32_16x16x32_bf16 v[108:111], a[152:155], a[180:183], v[108:111]
  ds_read_b64_tr_b16 a[112:113], v21 offset:32768
  v_mfma_f32_16x16x32_bf16 v[112:115], a[156:159], a[172:175], v[112:115]
  ds_read_b64_tr_b16 a[114:115], v21 offset:34816
  v_mfma_f32_16x16x32_bf16 v[116:119], a[156:159], a[176:179], v[116:119]
  ds_read_b64_tr_b16 a[116:117], v22 offset:32768
  v_mfma_f32_16x16x32_bf16 v[120:123], a[156:159], a[180:183], v[120:123]
  ds_read_b64_tr_b16 a[118:119], v22 offset:34816
  v_mfma_f32_16x16x32_bf16 v[124:127], a[160:163], a[172:175], v[124:127]
L_ws9:
  s_cbranch_execz L_wa_back
  ds_read_b64_tr_b16 a[120:121], v23 offset:32768
  v_mfma_f32_16x16x32_bf16 v[128:131], a[160:163], a[176:179], v[128:131]
  ds_read_b64_tr_b16 a[122:123], v23 offset:34816
  v_mfma_f32_16x16x32_bf16 v[132:135], a[160:163], a[180:183], v[132:135]
  ds_read_b64_tr_b16 a[124:125], v24 offset:32768
  v_mfma_f32_16x16x32_bf16 v[136:139], a[164:167], a[172:175], v[136:139]
  ds_read_b64_tr_b16 a[126:127], v24 offset:34816
  v_mfma_f32_16x16x32_bf16 v[140:143], a[164:167], a[176:179], v[140:143]
  v_mfma_f32_16x16x32_bf16 v[144:147], a[164:167], a[180:183], v[144:147]
  v_mfma_f32_16x16x32_bf16 v[148:151], a[168:171], a[172:175], v[148:151]
  v_mfma_f32_16x16x32_bf16 v[152:155], a[168:171], a[176:179], v[152:155]
  v_mfma_f32_16x16x32_bf16 v[156:159], a[168:171], a[180:183], v[156:159]
  s_waitcnt vmcnt(8) lgkmcnt(0)
  s_barrier
  v_mfma_f32_16x16x32_bf16 v[64:67], a[96:99], a[128:131], v[64:67]
  ds_read_b128 a[172:175], v26 offset:12288
  v_mfma_f32_16x16x32_bf16 v[68:71], a[96:99], a[132:135], v[68:71]
  ds_read_b128 a[176:179], v26 offset:14336
  v_mfma_f32_16x16x32_bf16 v[72:75], a[96:99], a[136:139], v[72:75]
  ds_read_b128 a[180:183], v26 offset:16384
  v_mfma_f32_16x16x32_bf16 v[76:79], a[100:103], a[128:131], v[76:79]
  ds_read_b64_tr_b16 a[140:141], v17 offset:49152
  v_mfma_f32_16x16x32_bf16 v[80:83], a[100:103], a[132:135], v[80:83]
  ds_read_b64_tr_b16 a[142:143], v17 offset:51200
  v_mfma_f32_16x16x32_bf16 v[84:87], a[100:103], a[136:139], v[84:87]
  ds_read_b64_tr_b16 a[144:145], v18 offset:49152
  v_mfma_f32_16x16x32_bf16 v[88:91], a[104:107], a[128:131], v[88:91]
  ds_read_b64_tr_b16 a[146:147], v18 offset:51200
  v_mfma_f32_16x16x32_bf16 v[92:95], a[104:107], a[132:135], v[92:95]
  ds_read_b64_tr_b16 a[148:149], v19 offset:49152
  v_mfma_f32_16x16x32_bf16 v[96:99], a[104:107], a[136:139], v[96:99]
  ds_read_b64_tr_b16 a[150:151], v19 offset:51200
  v_mfma_f32_16x16x32_bf16 v[100:103], a[108:111], a[128:131], v[100:103]
L_ws10:
  s_cbranch_execz L_wa_back
  ds_read_b64_tr_b16 a[152:153], v20 offset:49152
  v_mfma_f32_16x16x32_bf16 v[104:107], a[108:111], a[132:135], v[104:107]
  ds_read_b64_tr_b16 a[154:155], v20 offset:51200
  v_mfma_f32_16x16x32_bf16 v[108:111], a[108:111], a[136:139], v[108:111]
  ds_read_b64_tr_b16 a[156:157], v21 offset:49152
  v_mfma_f32_16x16x32_bf16 v[112:115], a[112:115], a[128:131], v[112:115]
  ds_read_b64_tr_b16 a[158:159], v21 offset:51200
  v_mfma_f32_16x16x32_bf16 v[116:119], a[112:115], a[132:135], v[116:119]
  ds_read_b64_tr_b16 a[160:161], v22 offset:49152
  v_mfma_f32_16x16x32_bf16 v[120:123], a[112:115], a[136:139], v[120:123]
  ds_read_b64_tr_b16 a[162:163], v22 offset:51200
  v_mfma_f32_16x16x32_bf16 v[124:127], a[116:119], a[128:131], v[124:127]
  ds_read_b64_tr_b16 a[164:165], v23 offset:49152
  v_mfma_f32_16x16x32_bf16 v[128:131], a[116:119], a[132:135], v[128:131]
  ds_read_b64_tr_b16 a[166:167], v23 offset:51200
  v_mfma_f32_16x16x32_bf16 v[132:135], a[116:119], a[136:139], v[132:135]
  ds_read_b64_tr_b16 a[168:169], v24 offset:49152
  v_mfma_f32_16x16x32_bf16 v[136:139], a[120:123], a[128:131], v[136:139]
  ds_read_b64_tr_b16 a[170:171], v24 offset:51200
  v_mfma_f32_16x16x32_bf16 v[140:143], a[120:123], a[132:135], v[140:143]
  v_mfma_f32_16x16x32_bf16 v[144:147], a[120:123], a[136:139], v[144:147]
  v_mfma_f32_16x16x32_bf16 v[148:151], a[124:127], a[128:131], v[148:151]
  v_mfma_f32_16x16x32_bf16 v[152:155], a[124:127], a[132:135], v[152:155]
  v_mfma_f32_16x16x32_bf16 v[156:159], a[124:127], a[136:139], v[156:159]
  s_waitcnt lgkmcnt(0)
  s_barrier
  s_buffer_load_dword s60, s[56:59], s43
  v_mfma_f32_16x16x32_bf16 v[64:67], a[140:143], a[172:175], v[64:67]
  v_lshl_add_u32 v58, v3, 2, v60
  v_mfma_f32_16x16x32_bf16 v[68:71], a[140:143], a[176:179], v[68:71]
  v_lshlrev_b32 v58, 8, v58
  v_mfma_f32_16x16x32_bf16 v[72:75], a[140:143], a[180:183], v[72:75]
  v_lshl_add_u32 v58, v62, 5, v58
L_ws11:
  s_cbranch_execz L_wa_back
  v_mfma_f32_16x16x32_bf16 v[76:79], a[144:147], a[172:175], v[76:79]
  v_lshl_add_u32 v58, v61, 3, v58
  s_lshl_b32 s3, s30, 13
  s_add_u32 m0, s38, 98304
  s_add_u32 s37, s36, 98304
  buffer_load_dwordx4 v4, s[16:19], s37 offen offset:0 nt lds
  v_mfma_f32_16x16x32_bf16 v[80:83], a[144:147], a[176:179], v[80:83]
  s_add_u32 s3, s3, 0
  v_add_u32 v58, s3, v58
  s_lshl_b32 s3, s30, 7
  v_mfma_f32_16x16x32_bf16 v[84:87], a[144:147], a[180:183], v[84:87]
  v_xor_b32 v17, s3, v58
  v_mfma_f32_16x16x32_bf16 v[88:91], a[148:151], a[172:175], v[88:91]
  v_xor_b32 v18, 32, v17
  v_mfma_f32_16x16x32_bf16 v[92:95], a[148:151], a[176:179], v[92:95]
  v_xor_b32 v19, 64, v17
  v_mfma_f32_16x16x32_bf16 v[96:99], a[148:151], a[180:183], v[96:99]
  v_xor_b32 v20, 96, v17
  v_mfma_f32_16x16x32_bf16 v[100:103], a[152:155], a[172:175], v[100:103]
  v_xor_b32 v21, 128, v17
  v_mfma_f32_16x16x32_bf16 v[104:107], a[152:155], a[176:179], v[104:107]
  v_xor_b32 v22, 160, v17
  v_mfma_f32_16x16x32_bf16 v[108:111], a[152:155], a[180:183], v[108:111]
  v_xor_b32 v23, 192, v17
  v_mfma_f32_16x16x32_bf16 v[112:115], a[156:159], a[172:175], v[112:115]
  v_xor_b32 v24, 224, v17
  v_mfma_f32_16x16x32_bf16 v[116:119], a[156:159], a[176:179], v[116:119]
  v_mov_b32 v6, v59
  v_mfma_f32_16x16x32_bf16 v[120:123], a[156:159], a[180:183], v[120:123]
  v_xor_b32 v7, 64, v59
  v_mfma_f32_16x16x32_bf16 v[124:127], a[160:163], a[172:175], v[124:127]
  v_xor_b32 v8, 128, v59
  v_mfma_f32_16x16x32_bf16 v[128:131], a[160:163], a[176:179], v[128:131]
  v_xor_b32 v9, 192, v59
  buffer_load_dwordx4 v5, s[16:19], s37 offen offset:1024 nt lds
  v_mfma_f32_16x16x32_bf16 v[132:135], a[160:163], a[180:183], v[132:135]
L_ws12:
  s_cbranch_execz L_wa_back
  v_lshlrev_b32 v59, 9, v1
  v_mfma_f32_16x16x32_bf16 v[136:139], a[164:167], a[172:175], v[136:139]
  v_mfma_f32_16x16x32_bf16 v[140:143], a[164:167], a[176:179], v[140:143]
  v_mfma_f32_16x16x32_bf16 v[144:147], a[164:167], a[180:183], v[144:147]
  v_mfma_f32_16x16x32_bf16 v[148:151], a[168:171], a[172:175], v[148:151]
  v_mfma_f32_16x16x32_bf16 v[152:155], a[168:171], a[176:179], v[152:155]
  v_mfma_f32_16x16x32_bf16 v[156:159], a[168:171], a[180:183], v[156:159]
  s_cmp_eq_u32 s30, 0
  s_cbranch_scc0 L_qpark
  v_cvt_pk_bf16_f32 v64, v64, v65
  v_cvt_pk_bf16_f32 v65, v66, v67
  ds_write_b64 v31, v[64:65] offset:0
  v_cvt_pk_bf16_f32 v68, v68, v69
  v_cvt_pk_bf16_f32 v69, v70, v71
  ds_write_b64 v31, v[68:69] offset:4096
  v_cvt_pk_bf16_f32 v72, v72, v73
  v_cvt_pk_bf16_f32 v73, v74, v75
  ds_write_b64 v31, v[72:73] offset:8192
  v_xor_b32 v58, 32, v31
  v_cvt_pk_bf16_f32 v76, v76, v77
  v_cvt_pk_bf16_f32 v77, v78, v79
  ds_write_b64 v58, v[76:77] offset:0
  v_cvt_pk_bf16_f32 v80, v80, v81
  v_cvt_pk_bf16_f32 v81, v82, v83
  ds_write_b64 v58, v[80:81] offset:4096
  v_cvt_pk_bf16_f32 v84, v84, v85
  v_cvt_pk_bf16_f32 v85, v86, v87
  ds_write_b64 v58, v[84:85] offset:8192
  v_xor_b32 v58, 64, v31
  v_cvt_pk_bf16_f32 v88, v88, v89
  v_cvt_pk_bf16_f32 v89, v90, v91
  ds_write_b64 v58, v[88:89] offset:0
  v_cvt_pk_bf16_f32 v92, v92, v93
  v_cvt_pk_bf16_f32 v93, v94, v95
L_ws13:
  s_cbranch_execz L_wa_back
  ds_write_b64 v58, v[92:93] offset:4096
  v_cvt_pk_bf16_f32 v96, v96, v97
  v_cvt_pk_bf16_f32 v97, v98, v99
  ds_write_b64 v58, v[96:97] offset:8192
  v_xor_b32 v58, 96, v31
  v_cvt_pk_bf16_f32 v100, v100, v101
  v_cvt_pk_bf16_f32 v101, v102, v103
  ds_write_b64 v58, v[100:101] offset:0
  v_cvt_pk_bf16_f32 v104, v104, v105
  v_cvt_pk_bf16_f32 v105, v106, v107
  ds_write_b64 v58, v[104:105] offset:4096
  v_cvt_pk_bf16_f32 v108, v108, v109
  v_cvt_pk_bf16_f32 v109, v110, v111
  ds_write_b64 v58, v[108:109] offset:8192
  v_xor_b32 v58, 128, v31
  v_cvt_pk_bf16_f32 v112, v112, v113
  v_cvt_pk_bf16_f32 v113, v114, v115
  ds_write_b64 v58, v[112:113] offset:0
  v_cvt_pk_bf16_f32 v116, v116, v117
  v_cvt_pk_bf16_f32 v117, v118, v119
  ds_write_b64 v58, v[116:117] offset:4096
  v_cvt_pk_bf16_f32 v120, v120, v121
  v_cvt_pk_bf16_f32 v121, v122, v123
  ds_write_b64 v58, v[120:121] offset:8192
  v_xor_b32 v58, 160, v31
  v_cvt_pk_bf16_f32 v124, v124, v125
  v_cvt_pk_bf16_f32 v125, v126, v127
  ds_write_b64 v58, v[124:125] offset:0
  v_cvt_pk_bf16_f32 v128, v128, v129
  v_cvt_pk_bf16_f32 v129, v130, v131
  ds_write_b64 v58, v[128:129] offset:4096
L_ws14:
  s_cbranch_execz L_wa_back
  v_cvt_pk_bf16_f32 v132, v132, v133
  v_cvt_pk_bf16_f32 v133, v134, v135
  ds_write_b64 v58, v[132:133] offset:8192
  v_xor_b32 v58, 192, v31
  v_cvt_pk_bf16_f32 v136, v136, v137
  v_cvt_pk_bf16_f32 v137, v138, v139
  ds_write_b64 v58, v[136:137] offset:0
  v_cvt_pk_bf16_f32 v140, v140, v141
  v_cvt_pk_bf16_f32 v141, v142, v143
  ds_write_b64 v58, v[140:141] offset:4096
  v_cvt_pk_bf16_f32 v144, v144, v145
  v_cvt_pk_bf16_f32 v145, v146, v147
  ds_write_b64 v58, v[144:145] offset:8192
  v_xor_b32 v58, 224, v31
  v_cvt_pk_bf16_f32 v148, v148, v149
  v_cvt_pk_bf16_f32 v149, v150, v151
  ds_write_b64 v58, v[148:149] offset:0
  v_cvt_pk_bf16_f32 v152, v152, v153
  v_cvt_pk_bf16_f32 v153, v154, v155
  ds_write_b64 v58, v[152:153] offset:4096
  v_cvt_pk_bf16_f32 v156, v156, v157
  v_cvt_pk_bf16_f32 v157, v158, v159
  ds_write_b64 v58, v[156:157] offset:8192
  s_branch L_qdone
L_qpark:
  v_cvt_pk_bf16_f32 v64, v64, v65
  v_cvt_pk_bf16_f32 v65, v66, v67
  v_cvt_pk_bf16_f32 v68, v68, v69
  v_cvt_pk_bf16_f32 v69, v70, v71
  v_accvgpr_write_b32 a48, v64
  v_accvgpr_write_b32 a49, v65
  v_cvt_pk_bf16_f32 v72, v72, v73
  v_cvt_pk_bf16_f32 v73, v74, v75
L_ws15:
  s_cbranch_execz L_wa_back
  v_accvgpr_write_b32 a50, v68
  v_accvgpr_write_b32 a51, v69
  v_cvt_pk_bf16_f32 v76, v76, v77
  v_cvt_pk_bf16_f32 v77, v78, v79
  v_accvgpr_write_b32 a52, v72
  v_accvgpr_write_b32 a53, v73
  v_cvt_pk_bf16_f32 v80, v80, v81
  v_cvt_pk_bf16_f32 v81, v82, v83
  v_accvgpr_write_b32 a54, v76
  v_accvgpr_write_b32 a55, v77
  v_cvt_pk_bf16_f32 v84, v84, v85
  v_cvt_pk_bf16_f32 v85, v86, v87
  v_accvgpr_write_b32 a56, v80
  v_accvgpr_write_b32 a57, v81
  v_cvt_pk_bf16_f32 v88, v88, v89
  v_cvt_pk_bf16_f32 v89, v90, v91
  v_accvgpr_write_b32 a58, v84
  v_accvgpr_write_b32 a59, v85
  v_cvt_pk_bf16_f32 v92, v92, v93
  v_cvt_pk_bf16_f32 v93, v94, v95
  v_accvgpr_write_b32 a60, v88
  v_accvgpr_write_b32 a61, v89
  v_cvt_pk_bf16_f32 v96, v96, v97
  v_cvt_pk_bf16_f32 v97, v98, v99
  v_accvgpr_write_b32 a62, v92
  v_accvgpr_write_b32 a63, v93
  v_cvt_pk_bf16_f32 v100, v100, v101
  v_cvt_pk_bf16_f32 v101, v102, v103
  v_accvgpr_write_b32 a64, v96
  v_accvgpr_write_b32 a65, v97
  v_cvt_pk_bf16_f32 v104, v104, v105
  v_cvt_pk_bf16_f32 v105, v106, v107
L_ws16:
  s_cbranch_execz L_wa_back
  v_accvgpr_write_b32 a66, v100
  v_accvgpr_write_b32 a67, v101
  v_cvt_pk_bf16_f32 v108, v108, v109
  v_cvt_pk_bf16_f32 v109, v110, v111
  v_accvgpr_write_b32 a68, v104
  v_accvgpr_write_b32 a69, v105
  v_cvt_pk_bf16_f32 v112, v112, v113
  v_cvt_pk_bf16_f32 v113, v114, v115
  v_accvgpr_write_b32 a70, v108
  v_accvgpr_write_b32 a71, v109
  v_cvt_pk_bf16_f32 v116, v116, v117
  v_cvt_pk_bf16_f32 v117, v118, v119
  v_accvgpr_write_b32 a72, v112
  v_accvgpr_write_b32 a73, v113
  v_cvt_pk_bf16_f32 v120, v120, v121
  v_cvt_pk_bf16_f32 v121, v122, v123
  v_accvgpr_write_b32 a74, v116
  v_accvgpr_write_b32 a75, v117
  v_cvt_pk_bf16_f32 v124, v124, v125
  v_cvt_pk_bf16_f32 v125, v126, v127
  v_accvgpr_write_b32 a76, v120
  v_accvgpr_write_b32 a77, v121
  v_cvt_pk_bf16_f32 v128, v128, v129
  v_cvt_pk_bf16_f32 v129, v130, v131
  v_accvgpr_write_b32 a78, v124
  v_accvgpr_write_b32 a79, v125
  v_cvt_pk_bf16_f32 v132, v132, v133
  v_cvt_pk_bf16_f32 v133, v134, v135
  v_accvgpr_write_b32 a80, v128
  v_accvgpr_write_b32 a81, v129
  v_cvt_pk_bf16_f32 v136, v136, v137
L_ws17:
  s_cbranch_execz L_wa_back
  v_cvt_pk_bf16_f32 v137, v138, v139
  v_accvgpr_write_b32 a82, v132
  v_accvgpr_write_b32 a83, v133
  v_cvt_pk_bf16_f32 v140, v140, v141
  v_cvt_pk_bf16_f32 v141, v142, v143
  v_accvgpr_write_b32 a84, v136
  v_accvgpr_write_b32 a85, v137
  v_cvt_pk_bf16_f32 v144, v144, v145
  v_cvt_pk_bf16_f32 v145, v146, v147
  v_accvgpr_write_b32 a86, v140
  v_accvgpr_write_b32 a87, v141
  v_cvt_pk_bf16_f32 v148, v148, v149
  v_cvt_pk_bf16_f32 v149, v150, v151
  v_accvgpr_write_b32 a88, v144
  v_accvgpr_write_b32 a89, v145
  v_cvt_pk_bf16_f32 v152, v152, v153
  v_cvt_pk_bf16_f32 v153, v154, v155
  v_accvgpr_write_b32 a90, v148
  v_accvgpr_write_b32 a91, v149
  v_cvt_pk_bf16_f32 v156, v156, v157
  v_cvt_pk_bf16_f32 v157, v158, v159
  v_accvgpr_write_b32 a92, v152
  v_accvgpr_write_b32 a93, v153
  v_accvgpr_write_b32 a94, v156
  v_accvgpr_write_b32 a95, v157
L_qdone:
  s_waitcnt lgkmcnt(0)
  s_cmp_eq_u32 s60, 0
  s_cbranch_scc1 L_slow_non
L_back_non:
  s_barrier
  ds_read_b128 a[0:3], v6 offset:0
  ds_read_b128 a[4:7], v6 offset:4096
  ds_read_b128 a[8:11], v6 offset:8192
  ds_read_b128 a[96:99], v13 offset:0
  buffer_load_dwordx4 v4, s[16:19], s37 offen offset:2048 nt lds
L_ws18:
  s_cbranch_execz L_wa_back
  ds_read_b128 a[12:15], v7 offset:0
  ds_read_b128 a[16:19], v7 offset:4096
  ds_read_b128 a[20:23], v7 offset:8192
  ds_read_b128 a[100:103], v14 offset:0
  buffer_load_dwordx4 v5, s[16:19], s37 offen offset:3072 nt lds
  ds_read_b128 a[24:27], v8 offset:0
  ds_read_b128 a[28:31], v8 offset:4096
  ds_read_b128 a[32:35], v8 offset:8192
  ds_read_b128 a[104:107], v15 offset:0
  s_add_u32 m0, s38, 114688
  s_add_u32 s37, s36, 114688
  buffer_load_dwordx4 v4, s[16:19], s37 offen offset:0 nt lds
  ds_read_b128 a[36:39], v9 offset:0
  ds_read_b128 a[40:43], v9 offset:4096
  ds_read_b128 a[44:47], v9 offset:8192
  ds_read_b128 a[108:111], v16 offset:0
  ds_read_b128 a[112:115], v13 offset:4096
  ds_read_b128 a[116:119], v14 offset:4096
  ds_read_b128 a[120:123], v15 offset:4096
  ds_read_b128 a[124:127], v16 offset:4096
  buffer_load_dwordx4 v5, s[16:19], s37 offen offset:1024 nt lds
  s_waitcnt lgkmcnt(0)
  s_barrier
  v_mfma_f32_16x16x32_bf16 v[64:67], a[96:99], a[0:3], 0
  ds_read_b128 a[128:131], v13 offset:16384
  v_mfma_f32_16x16x32_bf16 v[72:75], a[96:99], a[4:7], 0
  ds_read_b128 a[132:135], v14 offset:16384
  buffer_load_dwordx4 v4, s[16:19], s37 offen offset:2048 nt lds
  v_mfma_f32_16x16x32_bf16 v[80:83], a[96:99], a[8:11], 0
  ds_read_b128 a[136:139], v15 offset:16384
  v_mfma_f32_16x16x32_bf16 v[64:67], a[100:103], a[12:15], v[64:67]
  ds_read_b128 a[140:143], v16 offset:16384
L_ws19:
  s_cbranch_execz L_wa_back
  buffer_load_dwordx4 v5, s[16:19], s37 offen offset:3072 nt lds
  v_mfma_f32_16x16x32_bf16 v[72:75], a[100:103], a[16:19], v[72:75]
  ds_read_b128 a[144:147], v13 offset:20480
  v_mfma_f32_16x16x32_bf16 v[80:83], a[100:103], a[20:23], v[80:83]
  ds_read_b128 a[148:151], v14 offset:20480
  v_mfma_f32_16x16x32_bf16 v[64:67], a[104:107], a[24:27], v[64:67]
  ds_read_b128 a[152:155], v15 offset:20480
  v_mfma_f32_16x16x32_bf16 v[72:75], a[104:107], a[28:31], v[72:75]
  ds_read_b128 a[156:159], v16 offset:20480
  v_mfma_f32_16x16x32_bf16 v[80:83], a[104:107], a[32:35], v[80:83]
  v_mfma_f32_16x16x32_bf16 v[64:67], a[108:111], a[36:39], v[64:67]
  v_mfma_f32_16x16x32_bf16 v[72:75], a[108:111], a[40:43], v[72:75]
  v_mfma_f32_16x16x32_bf16 v[80:83], a[108:111], a[44:47], v[80:83]
  v_mfma_f32_16x16x32_bf16 v[68:71], a[112:115], a[0:3], 0
  v_mfma_f32_16x16x32_bf16 v[76:79], a[112:115], a[4:7], 0
  v_mfma_f32_16x16x32_bf16 v[84:87], a[112:115], a[8:11], 0
  s_add_u32 m0, s38, 0
  s_add_u32 s37, s36, 0
  buffer_load_dwordx4 v4, s[20:23], s37 offen offset:0 nt lds
  v_mfma_f32_16x16x32_bf16 v[68:71], a[116:119], a[12:15], v[68:71]
  v_mfma_f32_16x16x32_bf16 v[76:79], a[116:119], a[16:19], v[76:79]
  v_mfma_f32_16x16x32_bf16 v[84:87], a[116:119], a[20:23], v[84:87]
  v_mfma_f32_16x16x32_bf16 v[68:71], a[120:123], a[24:27], v[68:71]
  v_mfma_f32_16x16x32_bf16 v[76:79], a[120:123], a[28:31], v[76:79]
  v_mfma_f32_16x16x32_bf16 v[84:87], a[120:123], a[32:35], v[84:87]
  v_mfma_f32_16x16x32_bf16 v[68:71], a[124:127], a[36:39], v[68:71]
  v_mfma_f32_16x16x32_bf16 v[76:79], a[124:127], a[40:43], v[76:79]
  v_mfma_f32_16x16x32_bf16 v[84:87], a[124:127], a[44:47], v[84:87]
  s_waitcnt lgkmcnt(0)
  s_barrier
  v_mfma_f32_16x16x32_bf16 v[88:91], a[128:131], a[0:3], 0
  ds_read_b128 a[96:99], v13 offset:32768
  buffer_load_dwordx4 v5, s[20:23], s37 offen offset:1024 nt lds
  s_and_b32 s3, s2, 3
L_ws20:
  s_cbranch_execz L_wa_back
  s_add_u32 s3, s3, s43
  v_mfma_f32_16x16x32_bf16 v[96:99], a[128:131], a[4:7], 0
  ds_read_b128 a[100:103], v14 offset:32768
  s_bfe_u32 s4, s2, 0x20003
  s_mul_i32 s44, s3, 196608
  v_mfma_f32_16x16x32_bf16 v[104:107], a[128:131], a[8:11], 0
  ds_read_b128 a[104:107], v15 offset:32768
  s_mul_i32 s6, s29, 3072
  s_add_u32 s40, s44, s6
  v_mfma_f32_16x16x32_bf16 v[88:91], a[132:135], a[12:15], v[88:91]
  ds_read_b128 a[108:111], v16 offset:32768
  s_mul_i32 s6, s4, 24576
  s_add_u32 s40, s40, s6
  v_mfma_f32_16x16x32_bf16 v[96:99], a[132:135], a[16:19], v[96:99]
  ds_read_b128 a[112:115], v13 offset:36864
  s_mul_i32 s6, s30, 12288
  s_add_u32 s40, s40, s6
  v_mfma_f32_16x16x32_bf16 v[104:107], a[132:135], a[20:23], v[104:107]
  ds_read_b128 a[116:119], v14 offset:36864
  s_add_u32 s41, s40, 6144
  s_mul_i32 s6, s28, 3072
  v_mfma_f32_16x16x32_bf16 v[88:91], a[136:139], a[24:27], v[88:91]
  ds_read_b128 a[120:123], v15 offset:36864
  s_add_u32 s44, s44, s6
  s_mul_i32 s35, s28, 5120
  v_mfma_f32_16x16x32_bf16 v[96:99], a[136:139], a[28:31], v[96:99]
  ds_read_b128 a[124:127], v16 offset:36864
  s_lshr_b32 s5, s32, 1
  s_mov_b32 s45, 0x76543210
  v_mfma_f32_16x16x32_bf16 v[104:107], a[136:139], a[32:35], v[104:107]
  v_max3_f32 v32, v64, v65, v66
  s_cmp_eq_u32 s5, 1
  s_cselect_b32 s45, 0x32765410, s45
  s_cmp_eq_u32 s5, 2
  s_cselect_b32 s45, 0x54327610, s45
  v_mfma_f32_16x16x32_bf16 v[88:91], a[140:143], a[36:39], v[88:91]
L_ws21:
  s_cbranch_execz L_wa_back
  v_max_f32 v32, v32, v67
  s_mul_i32 s5, s4, 0x22222222
  s_add_u32 s45, s45, s5
  v_mfma_f32_16x16x32_bf16 v[96:99], a[140:143], a[40:43], v[96:99]
  v_max3_f32 v33, v72, v73, v74
  s_and_b32 s45, s45, 0x77777777
  s_and_b32 s5, s32, 1
  v_mfma_f32_16x16x32_bf16 v[104:107], a[140:143], a[44:47], v[104:107]
  v_max_f32 v33, v33, v75
  s_mul_i32 s5, s5, 0x11111111
  s_xor_b32 s45, s45, s5
  v_mfma_f32_16x16x32_bf16 v[92:95], a[144:147], a[0:3], 0
  v_max3_f32 v34, v80, v81, v82
  s_and_b32 s5, s2, 3
  s_mul_i32 s34, s5, 1310720
  v_mfma_f32_16x16x32_bf16 v[100:103], a[144:147], a[4:7], 0
  v_max_f32 v34, v34, v83
  s_mul_i32 s5, s4, 320
  s_add_u32 s34, s34, s5
  v_mfma_f32_16x16x32_bf16 v[108:111], a[144:147], a[8:11], 0
  v_max3_f32 v32, v32, v68, v69
  s_lshl_b32 s62, s3, 12
  s_lshl_b32 s5, s29, 8
  v_mfma_f32_16x16x32_bf16 v[92:95], a[148:151], a[12:15], v[92:95]
  v_max3_f32 v33, v33, v76, v77
  s_add_u32 s62, s62, s5
  s_add_u32 s62, s62, 17825792
  v_mfma_f32_16x16x32_bf16 v[100:103], a[148:151], a[16:19], v[100:103]
  v_max3_f32 v34, v34, v84, v85
  s_lshl_b32 s5, s4, 4
  s_add_u32 s5, s5, s30
  v_mfma_f32_16x16x32_bf16 v[108:111], a[148:151], a[20:23], v[108:111]
  v_max3_f32 v32, v32, v70, v71
  s_lshl_b32 s5, s5, 2
  s_add_u32 s63, s62, s5
  v_mfma_f32_16x16x32_bf16 v[92:95], a[152:155], a[24:27], v[92:95]
  v_max3_f32 v33, v33, v78, v79
  s_lshl_b32 s5, s4, 9
  s_add_u32 s62, s62, s5
  v_mfma_f32_16x16x32_bf16 v[100:103], a[152:155], a[28:31], v[100:103]
L_ws22:
  s_cbranch_execz L_wa_back
  v_max3_f32 v34, v34, v86, v87
  s_getreg_b32 s61, hwreg(HW_REG_XCC_ID, 0, 4)
  s_lshl_b32 s61, s61, 1
  v_mfma_f32_16x16x32_bf16 v[108:111], a[152:155], a[32:35], v[108:111]
  s_add_u32 s61, s61, s60
  s_lshl_b32 s3, s3, 11
  v_mfma_f32_16x16x32_bf16 v[92:95], a[156:159], a[36:39], v[92:95]
  s_add_u32 s3, s3, 18087936
  s_lshl_b32 s5, s4, 2
  v_mfma_f32_16x16x32_bf16 v[100:103], a[156:159], a[40:43], v[100:103]
  s_add_u32 s5, s5, s3
  s_lshl_b32 s43, s4, 9
  v_mfma_f32_16x16x32_bf16 v[108:111], a[156:159], a[44:47], v[108:111]
  s_add_u32 s43, s43, s3
  s_cmp_eq_u32 s28, 0
  s_cbranch_scc0 L_nofl0
  v_mov_b32 v58, s61
  s_mov_b64 exec, 15
  buffer_store_dword v58, v59, s[24:27], s5 offen sc1
  s_mov_b64 exec, -1
L_nofl0:
  s_waitcnt lgkmcnt(0)
  s_barrier
  v_mfma_f32_16x16x32_bf16 v[112:115], a[96:99], a[0:3], 0
  ds_read_b128 a[128:131], v13 offset:49152
  v_mfma_f32_16x16x32_bf16 v[120:123], a[96:99], a[4:7], 0
  ds_read_b128 a[132:135], v14 offset:49152
  v_mfma_f32_16x16x32_bf16 v[128:131], a[96:99], a[8:11], 0
  ds_read_b128 a[136:139], v15 offset:49152
  v_mfma_f32_16x16x32_bf16 v[112:115], a[100:103], a[12:15], v[112:115]
  ds_read_b128 a[140:143], v16 offset:49152
  v_mfma_f32_16x16x32_bf16 v[120:123], a[100:103], a[16:19], v[120:123]
  ds_read_b128 a[144:147], v13 offset:53248
  v_mfma_f32_16x16x32_bf16 v[128:131], a[100:103], a[20:23], v[128:131]
  ds_read_b128 a[148:151], v14 offset:53248
  v_mfma_f32_16x16x32_bf16 v[112:115], a[104:107], a[24:27], v[112:115]
  ds_read_b128 a[152:155], v15 offset:53248
  v_mfma_f32_16x16x32_bf16 v[120:123], a[104:107], a[28:31], v[120:123]
  ds_read_b128 a[156:159], v16 offset:53248
  v_mfma_f32_16x16x32_bf16 v[128:131], a[104:107], a[32:35], v[128:131]
L_ws23:
  s_cbranch_execz L_wa_back
  v_max3_f32 v32, v32, v88, v89
  v_mfma_f32_16x16x32_bf16 v[112:115], a[108:111], a[36:39], v[112:115]
  v_max3_f32 v33, v33, v96, v97
  v_mfma_f32_16x16x32_bf16 v[120:123], a[108:111], a[40:43], v[120:123]
  v_max3_f32 v34, v34, v104, v105
  v_mfma_f32_16x16x32_bf16 v[128:131], a[108:111], a[44:47], v[128:131]
  v_max3_f32 v32, v32, v90, v91
  v_mfma_f32_16x16x32_bf16 v[116:119], a[112:115], a[0:3], 0
  v_max3_f32 v33, v33, v98, v99
  v_mfma_f32_16x16x32_bf16 v[124:127], a[112:115], a[4:7], 0
  v_max3_f32 v34, v34, v106, v107
  v_mfma_f32_16x16x32_bf16 v[132:135], a[112:115], a[8:11], 0
  v_max3_f32 v32, v32, v92, v93
  v_mfma_f32_16x16x32_bf16 v[116:119], a[116:119], a[12:15], v[116:119]
  buffer_load_dwordx4 v4, s[20:23], s37 offen offset:2048 nt lds
  v_max3_f32 v33, v33, v100, v101
  v_mfma_f32_16x16x32_bf16 v[124:127], a[116:119], a[16:19], v[124:127]
  v_max3_f32 v34, v34, v108, v109
  v_mfma_f32_16x16x32_bf16 v[132:135], a[116:119], a[20:23], v[132:135]
  v_max3_f32 v32, v32, v94, v95
  v_mfma_f32_16x16x32_bf16 v[116:119], a[120:123], a[24:27], v[116:119]
  v_max3_f32 v33, v33, v102, v103
  v_mfma_f32_16x16x32_bf16 v[124:127], a[120:123], a[28:31], v[124:127]
  v_max3_f32 v34, v34, v110, v111
  v_mfma_f32_16x16x32_bf16 v[132:135], a[120:123], a[32:35], v[132:135]
  v_mfma_f32_16x16x32_bf16 v[116:119], a[124:127], a[36:39], v[116:119]
  v_mfma_f32_16x16x32_bf16 v[124:127], a[124:127], a[40:43], v[124:127]
  v_mfma_f32_16x16x32_bf16 v[132:135], a[124:127], a[44:47], v[132:135]
  s_waitcnt vmcnt(15) lgkmcnt(0)
  s_barrier
  v_add_u32 v13, 0x10000, v13
  v_add_u32 v14, 0x10000, v14
L_ws24:
  s_cbranch_execz L_wa_back
  v_add_u32 v15, 0x10000, v15
  v_add_u32 v16, 0x10000, v16
  v_mfma_f32_16x16x32_bf16 v[136:139], a[128:131], a[0:3], 0
  ds_read_b128 a[96:99], v13 offset:0
  buffer_load_dwordx4 v5, s[20:23], s37 offen offset:3072 nt lds
  s_lshl_b32 s3, s31, 3
  s_add_u32 s3, s3, s32
  v_mfma_f32_16x16x32_bf16 v[144:147], a[128:131], a[4:7], 0
  ds_read_b128 a[100:103], v14 offset:0
  s_lshl_b32 s3, s3, 2
  s_bfe_u32 s4, s2, 0x20003
  v_mfma_f32_16x16x32_bf16 v[152:155], a[128:131], a[8:11], 0
  ds_read_b128 a[104:107], v15 offset:0
  s_add_u32 s3, s3, s4
  s_lshl_b32 s85, s3, 9
  v_mfma_f32_16x16x32_bf16 v[136:139], a[132:135], a[12:15], v[136:139]
  ds_read_b128 a[108:111], v16 offset:0
  s_add_u32 s85, s85, 18350080
  s_mul_i32 s3, s3, 163840
  v_mfma_f32_16x16x32_bf16 v[144:147], a[132:135], a[16:19], v[144:147]
  ds_read_b128 a[112:115], v13 offset:4096
  s_add_u32 s3, s3, 18874368
  s_and_b32 s5, s2, 3
  v_mfma_f32_16x16x32_bf16 v[152:155], a[132:135], a[20:23], v[152:155]
  ds_read_b128 a[116:119], v14 offset:4096
  s_lshl_b32 s6, s28, 2
  s_add_u32 s6, s6, s5
  v_mfma_f32_16x16x32_bf16 v[136:139], a[136:139], a[24:27], v[136:139]
  ds_read_b128 a[120:123], v15 offset:4096
  s_mul_i32 s6, s6, 10240
  s_add_u32 s72, s3, s6
  v_mfma_f32_16x16x32_bf16 v[144:147], a[136:139], a[28:31], v[144:147]
  ds_read_b128 a[124:127], v16 offset:4096
  s_mul_i32 s6, s5, 40960
  s_add_u32 s3, s3, s6
  v_mfma_f32_16x16x32_bf16 v[152:155], a[136:139], a[32:35], v[152:155]
  v_max3_f32 v32, v32, v112, v113
L_ws25:
  s_cbranch_execz L_wa_back
  s_lshl_b32 s6, s28, 11
  s_add_u32 s73, s3, s6
  v_mfma_f32_16x16x32_bf16 v[136:139], a[140:143], a[36:39], v[136:139]
  v_max3_f32 v33, v33, v120, v121
  s_lshl_b32 s6, s29, 10
  s_add_u32 s74, s3, s6
  v_mfma_f32_16x16x32_bf16 v[144:147], a[140:143], a[40:43], v[144:147]
  v_max3_f32 v34, v34, v128, v129
  s_add_u32 s74, s74, 8192
  s_mul_i32 s3, s32, 245760
  v_mfma_f32_16x16x32_bf16 v[152:155], a[140:143], a[44:47], v[152:155]
  v_max3_f32 v32, v32, v114, v115
  s_and_b32 s6, s5, 1
  v_mfma_f32_16x16x32_bf16 v[140:143], a[144:147], a[0:3], 0
  v_max3_f32 v33, v33, v122, v123
  s_mul_i32 s6, s6, 122880
  s_add_u32 s3, s3, s6
  v_mfma_f32_16x16x32_bf16 v[148:151], a[144:147], a[4:7], 0
  v_max3_f32 v34, v34, v130, v131
  s_mul_i32 s6, s31, 1280
  s_add_u32 s3, s3, s6
  v_mfma_f32_16x16x32_bf16 v[156:159], a[144:147], a[8:11], 0
  s_add_u32 m0, s38, 16384
  s_add_u32 s37, s36, 16384
  buffer_load_dwordx4 v4, s[20:23], s37 offen offset:0 nt lds
  v_max3_f32 v32, v32, v116, v117
  s_mul_i32 s6, s4, 320
  s_add_u32 s3, s3, s6
  v_mfma_f32_16x16x32_bf16 v[140:143], a[148:151], a[12:15], v[140:143]
  v_max3_f32 v33, v33, v124, v125
  s_lshr_b32 s6, s5, 1
  s_mul_i32 s6, s6, 160
  v_mfma_f32_16x16x32_bf16 v[148:151], a[148:151], a[16:19], v[148:151]
  v_max3_f32 v34, v34, v132, v133
  s_add_u32 s3, s3, s6
  s_lshl_b32 s6, s28, 5
  v_mfma_f32_16x16x32_bf16 v[156:159], a[148:151], a[20:23], v[156:159]
L_ws26:
  s_cbranch_execz L_wa_back
  v_max3_f32 v32, v32, v118, v119
  s_add_u32 s75, s3, s6
  s_add_u32 s76, s75, 40960
  v_mfma_f32_16x16x32_bf16 v[140:143], a[152:155], a[24:27], v[140:143]
  v_max3_f32 v33, v33, v126, v127
  s_add_u32 s77, s75, 81920
  s_mul_i32 s6, s29, 81920
  v_mfma_f32_16x16x32_bf16 v[148:151], a[152:155], a[28:31], v[148:151]
  v_max3_f32 v34, v34, v134, v135
  s_add_u32 s78, s3, s6
  s_add_u32 s78, s78, 128
  v_mfma_f32_16x16x32_bf16 v[156:159], a[152:155], a[32:35], v[156:159]
  s_lshl_b32 s6, s29, 2
  s_add_u32 s79, s3, s6
  v_mfma_f32_16x16x32_bf16 v[140:143], a[156:159], a[36:39], v[140:143]
  s_add_u32 s79, s79, 41088
  s_mov_b32 s80, 0xffff
  v_mfma_f32_16x16x32_bf16 v[148:151], a[156:159], a[40:43], v[148:151]
  s_mov_b32 s81, 0x07060302
  s_mov_b32 s82, 0x3f80
  v_mfma_f32_16x16x32_bf16 v[156:159], a[156:159], a[44:47], v[156:159]
  s_mov_b32 s83, 0x3f800000
  s_waitcnt vmcnt(13) lgkmcnt(0)
  s_barrier
  v_mfma_f32_16x16x32_bf16 v[160:163], a[96:99], a[0:3], 0
  ds_read_b128 a[128:131], v13 offset:16384
  buffer_load_dwordx4 v5, s[20:23], s37 offen offset:1024 nt lds
  v_mfma_f32_16x16x32_bf16 v[168:171], a[96:99], a[4:7], 0
  ds_read_b128 a[132:135], v14 offset:16384
  v_mfma_f32_16x16x32_bf16 v[176:179], a[96:99], a[8:11], 0
  ds_read_b128 a[136:139], v15 offset:16384
  v_mfma_f32_16x16x32_bf16 v[160:163], a[100:103], a[12:15], v[160:163]
  ds_read_b128 a[140:143], v16 offset:16384
  v_mfma_f32_16x16x32_bf16 v[168:171], a[100:103], a[16:19], v[168:171]
  ds_read_b128 a[144:147], v13 offset:20480
L_ws27:
  s_cbranch_execz L_wa_back
  v_mfma_f32_16x16x32_bf16 v[176:179], a[100:103], a[20:23], v[176:179]
  ds_read_b128 a[148:151], v14 offset:20480
  v_mfma_f32_16x16x32_bf16 v[160:163], a[104:107], a[24:27], v[160:163]
  ds_read_b128 a[152:155], v15 offset:20480
  v_mfma_f32_16x16x32_bf16 v[168:171], a[104:107], a[28:31], v[168:171]
  ds_read_b128 a[156:159], v16 offset:20480
  v_mfma_f32_16x16x32_bf16 v[176:179], a[104:107], a[32:35], v[176:179]
  v_max3_f32 v32, v32, v136, v137
  v_mfma_f32_16x16x32_bf16 v[160:163], a[108:111], a[36:39], v[160:163]
  v_max3_f32 v33, v33, v144, v145
  v_mfma_f32_16x16x32_bf16 v[168:171], a[108:111], a[40:43], v[168:171]
  v_max3_f32 v34, v34, v152, v153
  v_mfma_f32_16x16x32_bf16 v[176:179], a[108:111], a[44:47], v[176:179]
  v_max3_f32 v32, v32, v138, v139
  v_mfma_f32_16x16x32_bf16 v[164:167], a[112:115], a[0:3], 0
  v_max3_f32 v33, v33, v146, v147
  v_mfma_f32_16x16x32_bf16 v[172:175], a[112:115], a[4:7], 0
  v_max3_f32 v34, v34, v154, v155
  v_mfma_f32_16x16x32_bf16 v[180:183], a[112:115], a[8:11], 0
  buffer_load_dwordx4 v4, s[20:23], s37 offen offset:2048 nt lds
  v_max3_f32 v32, v32, v140, v141
  v_mfma_f32_16x16x32_bf16 v[164:167], a[116:119], a[12:15], v[164:167]
  v_max3_f32 v33, v33, v148, v149
  v_mfma_f32_16x16x32_bf16 v[172:175], a[116:119], a[16:19], v[172:175]
  v_max3_f32 v34, v34, v156, v157
  v_mfma_f32_16x16x32_bf16 v[180:183], a[116:119], a[20:23], v[180:183]
  v_max3_f32 v32, v32, v142, v143
  v_mfma_f32_16x16x32_bf16 v[164:167], a[120:123], a[24:27], v[164:167]
  v_max3_f32 v33, v33, v150, v151
  v_mfma_f32_16x16x32_bf16 v[172:175], a[120:123], a[28:31], v[172:175]
  v_max3_f32 v34, v34, v158, v159
L_ws28:
  s_cbranch_execz L_wa_back
  v_mfma_f32_16x16x32_bf16 v[180:183], a[120:123], a[32:35], v[180:183]
  v_mfma_f32_16x16x32_bf16 v[164:167], a[124:127], a[36:39], v[164:167]
  v_mfma_f32_16x16x32_bf16 v[172:175], a[124:127], a[40:43], v[172:175]
  v_mfma_f32_16x16x32_bf16 v[180:183], a[124:127], a[44:47], v[180:183]
  s_waitcnt vmcnt(11) lgkmcnt(0)
  s_barrier
  v_mfma_f32_16x16x32_bf16 v[184:187], a[128:131], a[0:3], 0
  ds_read_b128 a[96:99], v13 offset:32768
  buffer_load_dwordx4 v5, s[20:23], s37 offen offset:3072 nt lds
  v_and_b32 v10, 7, v1
  v_mfma_f32_16x16x32_bf16 v[192:195], a[128:131], a[4:7], 0
  ds_read_b128 a[100:103], v14 offset:32768
  v_lshlrev_b32 v10, 6, v10
  v_mfma_f32_16x16x32_bf16 v[200:203], a[128:131], a[8:11], 0
  ds_read_b128 a[104:107], v15 offset:32768
  v_mfma_f32_16x16x32_bf16 v[184:187], a[132:135], a[12:15], v[184:187]
  ds_read_b128 a[108:111], v16 offset:32768
  v_min_u32 v10, 256, v10
  v_mfma_f32_16x16x32_bf16 v[192:195], a[132:135], a[16:19], v[192:195]
  ds_read_b128 a[112:115], v13 offset:36864
  v_mfma_f32_16x16x32_bf16 v[200:203], a[132:135], a[20:23], v[200:203]
  ds_read_b128 a[116:119], v14 offset:36864
  v_bfe_u32 v11, v1, 3, 2
  v_mfma_f32_16x16x32_bf16 v[184:187], a[136:139], a[24:27], v[184:187]
  ds_read_b128 a[120:123], v15 offset:36864
  v_mfma_f32_16x16x32_bf16 v[192:195], a[136:139], a[28:31], v[192:195]
  ds_read_b128 a[124:127], v16 offset:36864
  v_mul_u32_u24 v11, 1280, v11
  v_mfma_f32_16x16x32_bf16 v[200:203], a[136:139], a[32:35], v[200:203]
  v_max3_f32 v32, v32, v160, v161
  v_mfma_f32_16x16x32_bf16 v[184:187], a[140:143], a[36:39], v[184:187]
  v_max3_f32 v33, v33, v168, v169
  v_add_u32 v10, v10, v11
  v_mfma_f32_16x16x32_bf16 v[192:195], a[140:143], a[40:43], v[192:195]
L_ws29:
  s_cbranch_execz L_wa_back
  v_max3_f32 v34, v34, v176, v177
  v_mfma_f32_16x16x32_bf16 v[200:203], a[140:143], a[44:47], v[200:203]
  v_max3_f32 v32, v32, v162, v163
  s_lshr_b32 s3, s2, 3
  v_mfma_f32_16x16x32_bf16 v[188:191], a[144:147], a[0:3], 0
  v_max3_f32 v33, v33, v170, v171
  s_lshl_b32 s3, s3, 2
  v_mfma_f32_16x16x32_bf16 v[196:199], a[144:147], a[4:7], 0
  s_add_u32 m0, s38, 32768
  s_add_u32 s37, s36, 32768
  buffer_load_dwordx4 v4, s[20:23], s37 offen offset:0 nt lds
  v_max3_f32 v34, v34, v178, v179
  v_mfma_f32_16x16x32_bf16 v[204:207], a[144:147], a[8:11], 0
  v_max3_f32 v32, v32, v164, v165
  s_add_u32 s3, s3, s28
  v_mfma_f32_16x16x32_bf16 v[188:191], a[148:151], a[12:15], v[188:191]
  v_max3_f32 v33, v33, v172, v173
  v_mfma_f32_16x16x32_bf16 v[196:199], a[148:151], a[16:19], v[196:199]
  v_max3_f32 v34, v34, v180, v181
  s_mul_i32 s3, s3, 10240
  v_mfma_f32_16x16x32_bf16 v[204:207], a[148:151], a[20:23], v[204:207]
  v_max3_f32 v32, v32, v166, v167
  v_mfma_f32_16x16x32_bf16 v[188:191], a[152:155], a[24:27], v[188:191]
  v_max3_f32 v33, v33, v174, v175
  s_and_b32 s4, s2, 3
  v_mfma_f32_16x16x32_bf16 v[196:199], a[152:155], a[28:31], v[196:199]
  v_max3_f32 v34, v34, v182, v183
  v_mfma_f32_16x16x32_bf16 v[204:207], a[152:155], a[32:35], v[204:207]
  s_mul_i32 s4, s4, 1310720
  v_mfma_f32_16x16x32_bf16 v[188:191], a[156:159], a[36:39], v[188:191]
  v_mfma_f32_16x16x32_bf16 v[196:199], a[156:159], a[40:43], v[196:199]
  s_add_u32 s84, s3, s4
  v_mfma_f32_16x16x32_bf16 v[204:207], a[156:159], a[44:47], v[204:207]
  s_waitcnt vmcnt(9) lgkmcnt(0)
  s_barrier
L_ws30:
  s_cbranch_execz L_wa_back
  v_mfma_f32_16x16x32_bf16 v[208:211], a[96:99], a[0:3], 0
  ds_read_b128 a[128:131], v13 offset:49152
  buffer_load_dwordx4 v5, s[20:23], s37 offen offset:1024 nt lds
  v_mfma_f32_16x16x32_bf16 v[216:219], a[96:99], a[4:7], 0
  ds_read_b128 a[132:135], v14 offset:49152
  v_mfma_f32_16x16x32_bf16 v[224:227], a[96:99], a[8:11], 0
  ds_read_b128 a[136:139], v15 offset:49152
  v_mfma_f32_16x16x32_bf16 v[208:211], a[100:103], a[12:15], v[208:211]
  ds_read_b128 a[140:143], v16 offset:49152
  v_mfma_f32_16x16x32_bf16 v[216:219], a[100:103], a[16:19], v[216:219]
  ds_read_b128 a[144:147], v13 offset:53248
  v_mfma_f32_16x16x32_bf16 v[224:227], a[100:103], a[20:23], v[224:227]
  ds_read_b128 a[148:151], v14 offset:53248
  v_mfma_f32_16x16x32_bf16 v[208:211], a[104:107], a[24:27], v[208:211]
  ds_read_b128 a[152:155], v15 offset:53248
  v_mfma_f32_16x16x32_bf16 v[216:219], a[104:107], a[28:31], v[216:219]
  ds_read_b128 a[156:159], v16 offset:53248
  v_mfma_f32_16x16x32_bf16 v[224:227], a[104:107], a[32:35], v[224:227]
  v_max3_f32 v32, v32, v184, v185
  v_mfma_f32_16x16x32_bf16 v[208:211], a[108:111], a[36:39], v[208:211]
  v_max3_f32 v33, v33, v192, v193
  v_mfma_f32_16x16x32_bf16 v[216:219], a[108:111], a[40:43], v[216:219]
  v_max3_f32 v34, v34, v200, v201
  v_mfma_f32_16x16x32_bf16 v[224:227], a[108:111], a[44:47], v[224:227]
  v_max3_f32 v32, v32, v186, v187
  v_mfma_f32_16x16x32_bf16 v[212:215], a[112:115], a[0:3], 0
  v_max3_f32 v33, v33, v194, v195
  v_mfma_f32_16x16x32_bf16 v[220:223], a[112:115], a[4:7], 0
  buffer_load_dwordx4 v4, s[20:23], s37 offen offset:2048 nt lds
  v_max3_f32 v34, v34, v202, v203
  v_mfma_f32_16x16x32_bf16 v[228:231], a[112:115], a[8:11], 0
  v_max3_f32 v32, v32, v188, v189
L_ws31:
  s_cbranch_execz L_wa_back
  v_mfma_f32_16x16x32_bf16 v[212:215], a[116:119], a[12:15], v[212:215]
  v_max3_f32 v33, v33, v196, v197
  v_mfma_f32_16x16x32_bf16 v[220:223], a[116:119], a[16:19], v[220:223]
  v_max3_f32 v34, v34, v204, v205
  v_mfma_f32_16x16x32_bf16 v[228:231], a[116:119], a[20:23], v[228:231]
  v_max3_f32 v32, v32, v190, v191
  v_mfma_f32_16x16x32_bf16 v[212:215], a[120:123], a[24:27], v[212:215]
  v_max3_f32 v33, v33, v198, v199
  v_mfma_f32_16x16x32_bf16 v[220:223], a[120:123], a[28:31], v[220:223]
  v_max3_f32 v34, v34, v206, v207
  v_mfma_f32_16x16x32_bf16 v[228:231], a[120:123], a[32:35], v[228:231]
  v_mfma_f32_16x16x32_bf16 v[212:215], a[124:127], a[36:39], v[212:215]
  v_mfma_f32_16x16x32_bf16 v[220:223], a[124:127], a[40:43], v[220:223]
  v_mfma_f32_16x16x32_bf16 v[228:231], a[124:127], a[44:47], v[228:231]
  s_waitcnt lgkmcnt(0)
  s_barrier
  v_mfma_f32_16x16x32_bf16 v[232:235], a[128:131], a[0:3], 0
  buffer_load_dwordx4 v5, s[20:23], s37 offen offset:3072 nt lds
  v_mfma_f32_16x16x32_bf16 v[240:243], a[128:131], a[4:7], 0
  v_mfma_f32_16x16x32_bf16 v[248:251], a[128:131], a[8:11], 0
  v_mfma_f32_16x16x32_bf16 v[232:235], a[132:135], a[12:15], v[232:235]
  v_mfma_f32_16x16x32_bf16 v[240:243], a[132:135], a[16:19], v[240:243]
  v_mfma_f32_16x16x32_bf16 v[248:251], a[132:135], a[20:23], v[248:251]
  v_mfma_f32_16x16x32_bf16 v[232:235], a[136:139], a[24:27], v[232:235]
  v_mfma_f32_16x16x32_bf16 v[240:243], a[136:139], a[28:31], v[240:243]
  v_mfma_f32_16x16x32_bf16 v[248:251], a[136:139], a[32:35], v[248:251]
  v_max3_f32 v32, v32, v208, v209
  v_mfma_f32_16x16x32_bf16 v[232:235], a[140:143], a[36:39], v[232:235]
  v_max3_f32 v33, v33, v216, v217
  v_mfma_f32_16x16x32_bf16 v[240:243], a[140:143], a[40:43], v[240:243]
  v_max3_f32 v34, v34, v224, v225
  v_mfma_f32_16x16x32_bf16 v[248:251], a[140:143], a[44:47], v[248:251]
L_ws32:
  s_cbranch_execz L_wa_back
  v_max3_f32 v32, v32, v210, v211
  v_mfma_f32_16x16x32_bf16 v[236:239], a[144:147], a[0:3], 0
  s_add_u32 m0, s38, 49152
  s_add_u32 s37, s36, 49152
  buffer_load_dwordx4 v4, s[20:23], s37 offen offset:0 nt lds
  v_max3_f32 v33, v33, v218, v219
  v_mfma_f32_16x16x32_bf16 v[244:247], a[144:147], a[4:7], 0
  v_max3_f32 v34, v34, v226, v227
  v_mfma_f32_16x16x32_bf16 v[252:255], a[144:147], a[8:11], 0
  v_max3_f32 v32, v32, v212, v213
  v_mfma_f32_16x16x32_bf16 v[236:239], a[148:151], a[12:15], v[236:239]
  v_max3_f32 v33, v33, v220, v221
  v_mfma_f32_16x16x32_bf16 v[244:247], a[148:151], a[16:19], v[244:247]
  v_max3_f32 v34, v34, v228, v229
  v_mfma_f32_16x16x32_bf16 v[252:255], a[148:151], a[20:23], v[252:255]
  v_max3_f32 v32, v32, v214, v215
  v_mfma_f32_16x16x32_bf16 v[236:239], a[152:155], a[24:27], v[236:239]
  v_max3_f32 v33, v33, v222, v223
  v_mfma_f32_16x16x32_bf16 v[244:247], a[152:155], a[28:31], v[244:247]
  v_max3_f32 v34, v34, v230, v231
  v_mfma_f32_16x16x32_bf16 v[252:255], a[152:155], a[32:35], v[252:255]
  v_mfma_f32_16x16x32_bf16 v[236:239], a[156:159], a[36:39], v[236:239]
  v_mfma_f32_16x16x32_bf16 v[244:247], a[156:159], a[40:43], v[244:247]
  v_mfma_f32_16x16x32_bf16 v[252:255], a[156:159], a[44:47], v[252:255]
  s_buffer_load_dwordx4 s[4:7], s[24:27], s43
  s_nop 7
  v_max3_f32 v32, v32, v232, v233
  v_max3_f32 v33, v33, v240, v241
  v_max3_f32 v34, v34, v248, v249
  v_max3_f32 v32, v32, v234, v235
  v_max3_f32 v33, v33, v242, v243
  v_max3_f32 v34, v34, v250, v251
L_ws33:
  s_cbranch_execz L_wa_back
  v_max3_f32 v32, v32, v236, v237
  v_max3_f32 v33, v33, v244, v245
  v_max3_f32 v34, v34, v252, v253
  v_max3_f32 v32, v32, v238, v239
  v_max3_f32 v33, v33, v246, v247
  v_max3_f32 v34, v34, v254, v255
  v_mov_b32 v35, v32
  v_mov_b32 v36, v33
  v_mov_b32 v37, v34
  s_nop 1
  v_permlane32_swap_b32 v35, v32
  v_permlane32_swap_b32 v36, v33
  v_permlane32_swap_b32 v37, v34
  s_nop 1
  v_max_f32 v32, v32, v35
  v_max_f32 v33, v33, v36
  v_max_f32 v34, v34, v37
  v_mov_b32 v35, v32
  v_mov_b32 v36, v33
  v_mov_b32 v37, v34
  s_nop 1
  v_permlane16_swap_b32 v35, v32
  v_permlane16_swap_b32 v36, v33
  v_permlane16_swap_b32 v37, v34
  s_nop 1
  v_max_f32 v32, v32, v35
  v_max_f32 v33, v33, v36
  v_max_f32 v34, v34, v37
  v_mul_f32 v38, 0xbe0293ee, v32
  v_mov_b32 v46, 0
  v_mov_b32 v47, 0
  v_mul_f32 v40, 0xbe0293ee, v33
  v_mov_b32 v48, 0
  v_mov_b32 v49, 0
  v_mul_f32 v42, 0xbe0293ee, v34
  v_mov_b32 v50, 0
  v_mov_b32 v51, 0
  v_pk_fma_f32 v[64:65], v[64:65], v[44:45], v[38:39] op_sel_hi:[1,0,0]
  v_pk_fma_f32 v[66:67], v[66:67], v[44:45], v[38:39] op_sel_hi:[1,0,0]
  v_pk_fma_f32 v[68:69], v[68:69], v[44:45], v[38:39] op_sel_hi:[1,0,0]
  v_pk_fma_f32 v[70:71], v[70:71], v[44:45], v[38:39] op_sel_hi:[1,0,0]
  v_exp_f32 v64, v64
  v_exp_f32 v65, v65
  v_pk_fma_f32 v[72:73], v[72:73], v[44:45], v[40:41] op_sel_hi:[1,0,0]
  buffer_load_dwordx4 v5, s[20:23], s37 offen offset:1024 nt lds
  v_exp_f32 v66, v66
  v_exp_f32 v67, v67
  v_pk_fma_f32 v[74:75], v[74:75], v[44:45], v[40:41] op_sel_hi:[1,0,0]
L_ws34:
  s_cbranch_execz L_wa_back
  v_exp_f32 v68, v68
  v_exp_f32 v69, v69
  v_pk_fma_f32 v[76:77], v[76:77], v[44:45], v[40:41] op_sel_hi:[1,0,0]
  buffer_load_dwordx4 v4, s[20:23], s37 offen offset:2048 nt lds
  v_exp_f32 v70, v70
  v_exp_f32 v71, v71
  v_pk_fma_f32 v[78:79], v[78:79], v[44:45], v[40:41] op_sel_hi:[1,0,0]
  v_exp_f32 v72, v72
  v_pk_add_f32 v[46:47], v[46:47], v[64:65]
  v_exp_f32 v73, v73
  v_cvt_pk_bf16_f32 v64, v64, v65
  v_pk_fma_f32 v[80:81], v[80:81], v[44:45], v[42:43] op_sel_hi:[1,0,0]
  v_exp_f32 v74, v74
  v_pk_add_f32 v[46:47], v[46:47], v[66:67]
  v_exp_f32 v75, v75
  v_cvt_pk_bf16_f32 v65, v66, v67
  v_pk_fma_f32 v[82:83], v[82:83], v[44:45], v[42:43] op_sel_hi:[1,0,0]
  v_exp_f32 v76, v76
  v_pk_add_f32 v[46:47], v[46:47], v[68:69]
  v_exp_f32 v77, v77
  v_cvt_pk_bf16_f32 v66, v68, v69
  v_pk_fma_f32 v[84:85], v[84:85], v[44:45], v[42:43] op_sel_hi:[1,0,0]
  v_exp_f32 v78, v78
  v_pk_add_f32 v[46:47], v[46:47], v[70:71]
  v_exp_f32 v79, v79
  v_cvt_pk_bf16_f32 v67, v70, v71
  v_pk_fma_f32 v[86:87], v[86:87], v[44:45], v[42:43] op_sel_hi:[1,0,0]
  buffer_load_dwordx4 v5, s[20:23], s37 offen offset:3072 nt lds
  v_exp_f32 v80, v80
  v_pk_add_f32 v[48:49], v[48:49], v[72:73]
  v_exp_f32 v81, v81
  v_cvt_pk_bf16_f32 v68, v72, v73
  v_pk_fma_f32 v[88:89], v[88:89], v[44:45], v[38:39] op_sel_hi:[1,0,0]
  v_exp_f32 v82, v82
  v_pk_add_f32 v[48:49], v[48:49], v[74:75]
  v_exp_f32 v83, v83
  v_cvt_pk_bf16_f32 v69, v74, v75
  v_pk_fma_f32 v[90:91], v[90:91], v[44:45], v[38:39] op_sel_hi:[1,0,0]
  v_exp_f32 v84, v84
  v_pk_add_f32 v[48:49], v[48:49], v[76:77]
L_ws35:
  s_cbranch_execz L_wa_back
  v_exp_f32 v85, v85
  v_cvt_pk_bf16_f32 v70, v76, v77
  v_pk_fma_f32 v[92:93], v[92:93], v[44:45], v[38:39] op_sel_hi:[1,0,0]
  v_exp_f32 v86, v86
  v_pk_add_f32 v[48:49], v[48:49], v[78:79]
  v_exp_f32 v87, v87
  v_cvt_pk_bf16_f32 v71, v78, v79
  v_pk_fma_f32 v[94:95], v[94:95], v[44:45], v[38:39] op_sel_hi:[1,0,0]
  v_exp_f32 v88, v88
  v_pk_add_f32 v[50:51], v[50:51], v[80:81]
  v_exp_f32 v89, v89
  v_cvt_pk_bf16_f32 v72, v80, v81
  v_pk_fma_f32 v[96:97], v[96:97], v[44:45], v[40:41] op_sel_hi:[1,0,0]
  v_exp_f32 v90, v90
  v_pk_add_f32 v[50:51], v[50:51], v[82:83]
  v_exp_f32 v91, v91
  v_cvt_pk_bf16_f32 v73, v82, v83
  v_pk_fma_f32 v[98:99], v[98:99], v[44:45], v[40:41] op_sel_hi:[1,0,0]
  v_exp_f32 v92, v92
  v_pk_add_f32 v[50:51], v[50:51], v[84:85]
  v_exp_f32 v93, v93
  v_cvt_pk_bf16_f32 v74, v84, v85
  v_pk_fma_f32 v[100:101], v[100:101], v[44:45], v[40:41] op_sel_hi:[1,0,0]
  s_add_u32 m0, s38, 65536
  s_add_u32 s37, s36, 65536
  buffer_load_dwordx4 v4, s[20:23], s37 offen offset:0 nt lds
  v_exp_f32 v94, v94
  v_pk_add_f32 v[50:51], v[50:51], v[86:87]
  v_exp_f32 v95, v95
  v_cvt_pk_bf16_f32 v75, v86, v87
  v_pk_fma_f32 v[102:103], v[102:103], v[44:45], v[40:41] op_sel_hi:[1,0,0]
  v_exp_f32 v96, v96
  v_pk_add_f32 v[46:47], v[46:47], v[88:89]
  v_exp_f32 v97, v97
  v_cvt_pk_bf16_f32 v76, v88, v89
  v_pk_fma_f32 v[104:105], v[104:105], v[44:45], v[42:43] op_sel_hi:[1,0,0]
  v_exp_f32 v98, v98
  v_pk_add_f32 v[46:47], v[46:47], v[90:91]
L_ws36:
  s_cbranch_execz L_wa_back
  v_exp_f32 v99, v99
  v_cvt_pk_bf16_f32 v77, v90, v91
  v_pk_fma_f32 v[106:107], v[106:107], v[44:45], v[42:43] op_sel_hi:[1,0,0]
  v_exp_f32 v100, v100
  v_pk_add_f32 v[46:47], v[46:47], v[92:93]
  v_exp_f32 v101, v101
  v_cvt_pk_bf16_f32 v78, v92, v93
  v_pk_fma_f32 v[108:109], v[108:109], v[44:45], v[42:43] op_sel_hi:[1,0,0]
  v_exp_f32 v102, v102
  v_pk_add_f32 v[46:47], v[46:47], v[94:95]
  v_exp_f32 v103, v103
  v_cvt_pk_bf16_f32 v79, v94, v95
  v_pk_fma_f32 v[110:111], v[110:111], v[44:45], v[42:43] op_sel_hi:[1,0,0]
  v_exp_f32 v104, v104
  v_pk_add_f32 v[48:49], v[48:49], v[96:97]
  v_exp_f32 v105, v105
  v_cvt_pk_bf16_f32 v80, v96, v97
  v_pk_fma_f32 v[112:113], v[112:113], v[44:45], v[38:39] op_sel_hi:[1,0,0]
  v_exp_f32 v106, v106
  v_pk_add_f32 v[48:49], v[48:49], v[98:99]
  v_exp_f32 v107, v107
  v_cvt_pk_bf16_f32 v81, v98, v99
  v_pk_fma_f32 v[114:115], v[114:115], v[44:45], v[38:39] op_sel_hi:[1,0,0]
  v_exp_f32 v108, v108
  v_pk_add_f32 v[48:49], v[48:49], v[100:101]
  v_exp_f32 v109, v109
  v_cvt_pk_bf16_f32 v82, v100, v101
  v_pk_fma_f32 v[116:117], v[116:117], v[44:45], v[38:39] op_sel_hi:[1,0,0]
  buffer_load_dwordx4 v5, s[20:23], s37 offen offset:1024 nt lds
  v_exp_f32 v110, v110
  v_pk_add_f32 v[48:49], v[48:49], v[102:103]
  v_exp_f32 v111, v111
  v_cvt_pk_bf16_f32 v83, v102, v103
  v_pk_fma_f32 v[118:119], v[118:119], v[44:45], v[38:39] op_sel_hi:[1,0,0]
  v_exp_f32 v112, v112
  v_pk_add_f32 v[50:51], v[50:51], v[104:105]
  v_exp_f32 v113, v113
  v_cvt_pk_bf16_f32 v84, v104, v105
  v_pk_fma_f32 v[120:121], v[120:121], v[44:45], v[40:41] op_sel_hi:[1,0,0]
L_ws37:
  s_cbranch_execz L_wa_back
  v_exp_f32 v114, v114
  v_pk_add_f32 v[50:51], v[50:51], v[106:107]
  v_exp_f32 v115, v115
  v_cvt_pk_bf16_f32 v85, v106, v107
  v_pk_fma_f32 v[122:123], v[122:123], v[44:45], v[40:41] op_sel_hi:[1,0,0]
  v_exp_f32 v116, v116
  v_pk_add_f32 v[50:51], v[50:51], v[108:109]
  v_exp_f32 v117, v117
  v_cvt_pk_bf16_f32 v86, v108, v109
  v_pk_fma_f32 v[124:125], v[124:125], v[44:45], v[40:41] op_sel_hi:[1,0,0]
  v_exp_f32 v118, v118
  v_pk_add_f32 v[50:51], v[50:51], v[110:111]
  v_exp_f32 v119, v119
  v_cvt_pk_bf16_f32 v87, v110, v111
  v_pk_fma_f32 v[126:127], v[126:127], v[44:45], v[40:41] op_sel_hi:[1,0,0]
  v_exp_f32 v120, v120
  v_pk_add_f32 v[46:47], v[46:47], v[112:113]
  v_exp_f32 v121, v121
  v_cvt_pk_bf16_f32 v88, v112, v113
  v_pk_fma_f32 v[128:129], v[128:129], v[44:45], v[42:43] op_sel_hi:[1,0,0]
  v_exp_f32 v122, v122
  v_pk_add_f32 v[46:47], v[46:47], v[114:115]
  v_exp_f32 v123, v123
  v_cvt_pk_bf16_f32 v89, v114, v115
  v_pk_fma_f32 v[130:131], v[130:131], v[44:45], v[42:43] op_sel_hi:[1,0,0]
  v_exp_f32 v124, v124
  v_pk_add_f32 v[46:47], v[46:47], v[116:117]
  v_exp_f32 v125, v125
  v_cvt_pk_bf16_f32 v90, v116, v117
  v_pk_fma_f32 v[132:133], v[132:133], v[44:45], v[42:43] op_sel_hi:[1,0,0]
  buffer_load_dwordx4 v4, s[20:23], s37 offen offset:2048 nt lds
  v_exp_f32 v126, v126
  v_pk_add_f32 v[46:47], v[46:47], v[118:119]
  v_exp_f32 v127, v127
  v_cvt_pk_bf16_f32 v91, v118, v119
  v_pk_fma_f32 v[134:135], v[134:135], v[44:45], v[42:43] op_sel_hi:[1,0,0]
  s_waitcnt lgkmcnt(0)
  s_xor_b32 s4, s4, s61
  s_xor_b32 s5, s5, s61
  s_xor_b32 s6, s6, s61
  s_xor_b32 s7, s7, s61
L_ws38:
  s_cbranch_execz L_wa_back
  s_or_b32 s4, s4, s5
  s_or_b32 s6, s6, s7
  s_or_b32 s4, s4, s6
  s_cmp_eq_u32 s4, 0
  s_cselect_b32 s61, 1, 0
  v_exp_f32 v128, v128
  v_pk_add_f32 v[48:49], v[48:49], v[120:121]
  v_exp_f32 v129, v129
  v_cvt_pk_bf16_f32 v92, v120, v121
  v_pk_fma_f32 v[136:137], v[136:137], v[44:45], v[38:39] op_sel_hi:[1,0,0]
  v_exp_f32 v130, v130
  v_pk_add_f32 v[48:49], v[48:49], v[122:123]
  v_exp_f32 v131, v131
  v_cvt_pk_bf16_f32 v93, v122, v123
  v_pk_fma_f32 v[138:139], v[138:139], v[44:45], v[38:39] op_sel_hi:[1,0,0]
  v_exp_f32 v132, v132
  v_pk_add_f32 v[48:49], v[48:49], v[124:125]
  v_exp_f32 v133, v133
  v_cvt_pk_bf16_f32 v94, v124, v125
  v_pk_fma_f32 v[140:141], v[140:141], v[44:45], v[38:39] op_sel_hi:[1,0,0]
  v_exp_f32 v134, v134
  v_pk_add_f32 v[48:49], v[48:49], v[126:127]
  v_exp_f32 v135, v135
  v_cvt_pk_bf16_f32 v95, v126, v127
  v_pk_fma_f32 v[142:143], v[142:143], v[44:45], v[38:39] op_sel_hi:[1,0,0]
  v_exp_f32 v136, v136
  v_pk_add_f32 v[50:51], v[50:51], v[128:129]
  v_exp_f32 v137, v137
  v_cvt_pk_bf16_f32 v96, v128, v129
  v_pk_fma_f32 v[144:145], v[144:145], v[44:45], v[40:41] op_sel_hi:[1,0,0]
  v_exp_f32 v138, v138
  v_pk_add_f32 v[50:51], v[50:51], v[130:131]
  v_exp_f32 v139, v139
  v_cvt_pk_bf16_f32 v97, v130, v131
  v_pk_fma_f32 v[146:147], v[146:147], v[44:45], v[40:41] op_sel_hi:[1,0,0]
  buffer_load_dwordx4 v5, s[20:23], s37 offen offset:3072 nt lds
  v_exp_f32 v140, v140
  v_pk_add_f32 v[50:51], v[50:51], v[132:133]
  v_exp_f32 v141, v141
  v_cvt_pk_bf16_f32 v98, v132, v133
  v_pk_fma_f32 v[148:149], v[148:149], v[44:45], v[40:41] op_sel_hi:[1,0,0]
L_ws39:
  s_cbranch_execz L_wa_back
  v_exp_f32 v142, v142
  v_pk_add_f32 v[50:51], v[50:51], v[134:135]
  v_exp_f32 v143, v143
  v_cvt_pk_bf16_f32 v99, v134, v135
  v_pk_fma_f32 v[150:151], v[150:151], v[44:45], v[40:41] op_sel_hi:[1,0,0]
  v_exp_f32 v144, v144
  v_pk_add_f32 v[46:47], v[46:47], v[136:137]
  v_exp_f32 v145, v145
  v_cvt_pk_bf16_f32 v100, v136, v137
  v_pk_fma_f32 v[152:153], v[152:153], v[44:45], v[42:43] op_sel_hi:[1,0,0]
  v_exp_f32 v146, v146
  v_pk_add_f32 v[46:47], v[46:47], v[138:139]
  v_exp_f32 v147, v147
  v_cvt_pk_bf16_f32 v101, v138, v139
  v_pk_fma_f32 v[154:155], v[154:155], v[44:45], v[42:43] op_sel_hi:[1,0,0]
  v_exp_f32 v148, v148
  v_pk_add_f32 v[46:47], v[46:47], v[140:141]
  v_exp_f32 v149, v149
  v_cvt_pk_bf16_f32 v102, v140, v141
  v_pk_fma_f32 v[156:157], v[156:157], v[44:45], v[42:43] op_sel_hi:[1,0,0]
  v_exp_f32 v150, v150
  v_pk_add_f32 v[46:47], v[46:47], v[142:143]
  v_exp_f32 v151, v151
  v_cvt_pk_bf16_f32 v103, v142, v143
  v_pk_fma_f32 v[158:159], v[158:159], v[44:45], v[42:43] op_sel_hi:[1,0,0]
  v_exp_f32 v152, v152
  v_pk_add_f32 v[48:49], v[48:49], v[144:145]
  v_exp_f32 v153, v153
  v_cvt_pk_bf16_f32 v104, v144, v145
  v_pk_fma_f32 v[160:161], v[160:161], v[44:45], v[38:39] op_sel_hi:[1,0,0]
  v_exp_f32 v154, v154
  v_pk_add_f32 v[48:49], v[48:49], v[146:147]
  v_exp_f32 v155, v155
  v_cvt_pk_bf16_f32 v105, v146, v147
  v_pk_fma_f32 v[162:163], v[162:163], v[44:45], v[38:39] op_sel_hi:[1,0,0]
  s_add_u32 m0, s38, 81920
  s_add_u32 s37, s36, 81920
  buffer_load_dwordx4 v4, s[20:23], s37 offen offset:0 nt lds
  v_exp_f32 v156, v156
L_ws40:
  s_cbranch_execz L_wa_back
  v_pk_add_f32 v[48:49], v[48:49], v[148:149]
  v_exp_f32 v157, v157
  v_cvt_pk_bf16_f32 v106, v148, v149
  v_pk_fma_f32 v[164:165], v[164:165], v[44:45], v[38:39] op_sel_hi:[1,0,0]
  v_exp_f32 v158, v158
  v_pk_add_f32 v[48:49], v[48:49], v[150:151]
  v_exp_f32 v159, v159
  v_cvt_pk_bf16_f32 v107, v150, v151
  v_pk_fma_f32 v[166:167], v[166:167], v[44:45], v[38:39] op_sel_hi:[1,0,0]
  v_exp_f32 v160, v160
  v_pk_add_f32 v[50:51], v[50:51], v[152:153]
  v_exp_f32 v161, v161
  v_cvt_pk_bf16_f32 v108, v152, v153
  v_pk_fma_f32 v[168:169], v[168:169], v[44:45], v[40:41] op_sel_hi:[1,0,0]
  v_exp_f32 v162, v162
  v_pk_add_f32 v[50:51], v[50:51], v[154:155]
  v_exp_f32 v163, v163
  v_cvt_pk_bf16_f32 v109, v154, v155
  v_pk_fma_f32 v[170:171], v[170:171], v[44:45], v[40:41] op_sel_hi:[1,0,0]
  v_exp_f32 v164, v164
  v_pk_add_f32 v[50:51], v[50:51], v[156:157]
  v_exp_f32 v165, v165
  v_cvt_pk_bf16_f32 v110, v156, v157
  v_pk_fma_f32 v[172:173], v[172:173], v[44:45], v[40:41] op_sel_hi:[1,0,0]
  v_exp_f32 v166, v166
  v_pk_add_f32 v[50:51], v[50:51], v[158:159]
  v_exp_f32 v167, v167
  v_cvt_pk_bf16_f32 v111, v158, v159
  v_pk_fma_f32 v[174:175], v[174:175], v[44:45], v[40:41] op_sel_hi:[1,0,0]
  v_exp_f32 v168, v168
  v_pk_add_f32 v[46:47], v[46:47], v[160:161]
  v_exp_f32 v169, v169
  v_cvt_pk_bf16_f32 v112, v160, v161
  v_pk_fma_f32 v[176:177], v[176:177], v[44:45], v[42:43] op_sel_hi:[1,0,0]
  buffer_load_dwordx4 v5, s[20:23], s37 offen offset:1024 nt lds
  v_exp_f32 v170, v170
  v_pk_add_f32 v[46:47], v[46:47], v[162:163]
  v_exp_f32 v171, v171
  v_cvt_pk_bf16_f32 v113, v162, v163
L_ws41:
  s_cbranch_execz L_wa_back
  v_pk_fma_f32 v[178:179], v[178:179], v[44:45], v[42:43] op_sel_hi:[1,0,0]
  v_exp_f32 v172, v172
  v_pk_add_f32 v[46:47], v[46:47], v[164:165]
  v_exp_f32 v173, v173
  v_cvt_pk_bf16_f32 v114, v164, v165
  v_pk_fma_f32 v[180:181], v[180:181], v[44:45], v[42:43] op_sel_hi:[1,0,0]
  v_exp_f32 v174, v174
  v_pk_add_f32 v[46:47], v[46:47], v[166:167]
  v_exp_f32 v175, v175
  v_cvt_pk_bf16_f32 v115, v166, v167
  v_pk_fma_f32 v[182:183], v[182:183], v[44:45], v[42:43] op_sel_hi:[1,0,0]
  v_exp_f32 v176, v176
  v_pk_add_f32 v[48:49], v[48:49], v[168:169]
  v_exp_f32 v177, v177
  v_cvt_pk_bf16_f32 v116, v168, v169
  v_pk_fma_f32 v[184:185], v[184:185], v[44:45], v[38:39] op_sel_hi:[1,0,0]
  v_exp_f32 v178, v178
  v_pk_add_f32 v[48:49], v[48:49], v[170:171]
  v_exp_f32 v179, v179
  v_cvt_pk_bf16_f32 v117, v170, v171
  v_pk_fma_f32 v[186:187], v[186:187], v[44:45], v[38:39] op_sel_hi:[1,0,0]
  v_exp_f32 v180, v180
  v_pk_add_f32 v[48:49], v[48:49], v[172:173]
  v_exp_f32 v181, v181
  v_cvt_pk_bf16_f32 v118, v172, v173
  v_pk_fma_f32 v[188:189], v[188:189], v[44:45], v[38:39] op_sel_hi:[1,0,0]
  v_exp_f32 v182, v182
  v_pk_add_f32 v[48:49], v[48:49], v[174:175]
  v_exp_f32 v183, v183
  v_cvt_pk_bf16_f32 v119, v174, v175
  v_pk_fma_f32 v[190:191], v[190:191], v[44:45], v[38:39] op_sel_hi:[1,0,0]
  v_exp_f32 v184, v184
  v_pk_add_f32 v[50:51], v[50:51], v[176:177]
  v_exp_f32 v185, v185
  v_cvt_pk_bf16_f32 v120, v176, v177
  v_pk_fma_f32 v[192:193], v[192:193], v[44:45], v[40:41] op_sel_hi:[1,0,0]
  buffer_load_dwordx4 v4, s[20:23], s37 offen offset:2048 nt lds
  v_exp_f32 v186, v186
  v_pk_add_f32 v[50:51], v[50:51], v[178:179]
L_ws42:
  s_cbranch_execz L_wa_back
  v_exp_f32 v187, v187
  v_cvt_pk_bf16_f32 v121, v178, v179
  v_pk_fma_f32 v[194:195], v[194:195], v[44:45], v[40:41] op_sel_hi:[1,0,0]
  v_exp_f32 v188, v188
  v_pk_add_f32 v[50:51], v[50:51], v[180:181]
  v_exp_f32 v189, v189
  v_cvt_pk_bf16_f32 v122, v180, v181
  v_pk_fma_f32 v[196:197], v[196:197], v[44:45], v[40:41] op_sel_hi:[1,0,0]
  v_exp_f32 v190, v190
  v_pk_add_f32 v[50:51], v[50:51], v[182:183]
  v_exp_f32 v191, v191
  v_cvt_pk_bf16_f32 v123, v182, v183
  v_pk_fma_f32 v[198:199], v[198:199], v[44:45], v[40:41] op_sel_hi:[1,0,0]
  v_exp_f32 v192, v192
  v_pk_add_f32 v[46:47], v[46:47], v[184:185]
  v_exp_f32 v193, v193
  v_cvt_pk_bf16_f32 v124, v184, v185
  v_pk_fma_f32 v[200:201], v[200:201], v[44:45], v[42:43] op_sel_hi:[1,0,0]
  v_exp_f32 v194, v194
  v_pk_add_f32 v[46:47], v[46:47], v[186:187]
  v_exp_f32 v195, v195
  v_cvt_pk_bf16_f32 v125, v186, v187
  v_pk_fma_f32 v[202:203], v[202:203], v[44:45], v[42:43] op_sel_hi:[1,0,0]
  v_exp_f32 v196, v196
  v_pk_add_f32 v[46:47], v[46:47], v[188:189]
  v_exp_f32 v197, v197
  v_cvt_pk_bf16_f32 v126, v188, v189
  v_pk_fma_f32 v[204:205], v[204:205], v[44:45], v[42:43] op_sel_hi:[1,0,0]
  v_exp_f32 v198, v198
  v_pk_add_f32 v[46:47], v[46:47], v[190:191]
  v_exp_f32 v199, v199
  v_cvt_pk_bf16_f32 v127, v190, v191
  v_pk_fma_f32 v[206:207], v[206:207], v[44:45], v[42:43] op_sel_hi:[1,0,0]
  buffer_load_dwordx4 v5, s[20:23], s37 offen offset:3072 nt lds
  v_exp_f32 v200, v200
  v_pk_add_f32 v[48:49], v[48:49], v[192:193]
  v_exp_f32 v201, v201
  v_cvt_pk_bf16_f32 v128, v192, v193
  v_pk_fma_f32 v[208:209], v[208:209], v[44:45], v[38:39] op_sel_hi:[1,0,0]
L_ws43:
  s_cbranch_execz L_wa_back
  v_exp_f32 v202, v202
  v_pk_add_f32 v[48:49], v[48:49], v[194:195]
  v_exp_f32 v203, v203
  v_cvt_pk_bf16_f32 v129, v194, v195
  v_pk_fma_f32 v[210:211], v[210:211], v[44:45], v[38:39] op_sel_hi:[1,0,0]
  v_exp_f32 v204, v204
  v_pk_add_f32 v[48:49], v[48:49], v[196:197]
  v_exp_f32 v205, v205
  v_cvt_pk_bf16_f32 v130, v196, v197
  v_pk_fma_f32 v[212:213], v[212:213], v[44:45], v[38:39] op_sel_hi:[1,0,0]
  v_exp_f32 v206, v206
  v_pk_add_f32 v[48:49], v[48:49], v[198:199]
  v_exp_f32 v207, v207
  v_cvt_pk_bf16_f32 v131, v198, v199
  v_pk_fma_f32 v[214:215], v[214:215], v[44:45], v[38:39] op_sel_hi:[1,0,0]
  v_exp_f32 v208, v208
  v_pk_add_f32 v[50:51], v[50:51], v[200:201]
  v_exp_f32 v209, v209
  v_cvt_pk_bf16_f32 v132, v200, v201
  v_pk_fma_f32 v[216:217], v[216:217], v[44:45], v[40:41] op_sel_hi:[1,0,0]
  v_exp_f32 v210, v210
  v_pk_add_f32 v[50:51], v[50:51], v[202:203]
  v_exp_f32 v211, v211
  v_cvt_pk_bf16_f32 v133, v202, v203
  v_pk_fma_f32 v[218:219], v[218:219], v[44:45], v[40:41] op_sel_hi:[1,0,0]
  v_exp_f32 v212, v212
  v_pk_add_f32 v[50:51], v[50:51], v[204:205]
  v_exp_f32 v213, v213
  v_cvt_pk_bf16_f32 v134, v204, v205
  v_pk_fma_f32 v[220:221], v[220:221], v[44:45], v[40:41] op_sel_hi:[1,0,0]
  v_exp_f32 v214, v214
  v_pk_add_f32 v[50:51], v[50:51], v[206:207]
  v_exp_f32 v215, v215
  v_cvt_pk_bf16_f32 v135, v206, v207
  v_pk_fma_f32 v[222:223], v[222:223], v[44:45], v[40:41] op_sel_hi:[1,0,0]
  s_add_u32 m0, s38, 98304
  s_add_u32 s37, s36, 98304
  buffer_load_dwordx4 v4, s[20:23], s37 offen offset:0 nt lds
  v_exp_f32 v216, v216
L_ws44:
  s_cbranch_execz L_wa_back
  v_pk_add_f32 v[46:47], v[46:47], v[208:209]
  v_exp_f32 v217, v217
  v_cvt_pk_bf16_f32 v136, v208, v209
  v_pk_fma_f32 v[224:225], v[224:225], v[44:45], v[42:43] op_sel_hi:[1,0,0]
  v_exp_f32 v218, v218
  v_pk_add_f32 v[46:47], v[46:47], v[210:211]
  v_exp_f32 v219, v219
  v_cvt_pk_bf16_f32 v137, v210, v211
  v_pk_fma_f32 v[226:227], v[226:227], v[44:45], v[42:43] op_sel_hi:[1,0,0]
  v_exp_f32 v220, v220
  v_pk_add_f32 v[46:47], v[46:47], v[212:213]
  v_exp_f32 v221, v221
  v_cvt_pk_bf16_f32 v138, v212, v213
  v_pk_fma_f32 v[228:229], v[228:229], v[44:45], v[42:43] op_sel_hi:[1,0,0]
  v_exp_f32 v222, v222
  v_pk_add_f32 v[46:47], v[46:47], v[214:215]
  v_exp_f32 v223, v223
  v_cvt_pk_bf16_f32 v139, v214, v215
  v_pk_fma_f32 v[230:231], v[230:231], v[44:45], v[42:43] op_sel_hi:[1,0,0]
  v_exp_f32 v224, v224
  v_pk_add_f32 v[48:49], v[48:49], v[216:217]
  v_exp_f32 v225, v225
  v_cvt_pk_bf16_f32 v140, v216, v217
  v_pk_fma_f32 v[232:233], v[232:233], v[44:45], v[38:39] op_sel_hi:[1,0,0]
  v_exp_f32 v226, v226
  v_pk_add_f32 v[48:49], v[48:49], v[218:219]
  v_exp_f32 v227, v227
  v_cvt_pk_bf16_f32 v141, v218, v219
  v_pk_fma_f32 v[234:235], v[234:235], v[44:45], v[38:39] op_sel_hi:[1,0,0]
  v_exp_f32 v228, v228
  v_pk_add_f32 v[48:49], v[48:49], v[220:221]
  v_exp_f32 v229, v229
  v_cvt_pk_bf16_f32 v142, v220, v221
  v_pk_fma_f32 v[236:237], v[236:237], v[44:45], v[38:39] op_sel_hi:[1,0,0]
  buffer_load_dwordx4 v5, s[20:23], s37 offen offset:1024 nt lds
  v_exp_f32 v230, v230
  v_pk_add_f32 v[48:49], v[48:49], v[222:223]
  v_exp_f32 v231, v231
  v_cvt_pk_bf16_f32 v143, v222, v223
L_ws45:
  s_cbranch_execz L_wa_back
  v_pk_fma_f32 v[238:239], v[238:239], v[44:45], v[38:39] op_sel_hi:[1,0,0]
  v_exp_f32 v232, v232
  v_pk_add_f32 v[50:51], v[50:51], v[224:225]
  v_exp_f32 v233, v233
  v_cvt_pk_bf16_f32 v144, v224, v225
  v_pk_fma_f32 v[240:241], v[240:241], v[44:45], v[40:41] op_sel_hi:[1,0,0]
  v_exp_f32 v234, v234
  v_pk_add_f32 v[50:51], v[50:51], v[226:227]
  v_exp_f32 v235, v235
  v_cvt_pk_bf16_f32 v145, v226, v227
  v_pk_fma_f32 v[242:243], v[242:243], v[44:45], v[40:41] op_sel_hi:[1,0,0]
  v_exp_f32 v236, v236
  v_pk_add_f32 v[50:51], v[50:51], v[228:229]
  v_exp_f32 v237, v237
  v_cvt_pk_bf16_f32 v146, v228, v229
  v_pk_fma_f32 v[244:245], v[244:245], v[44:45], v[40:41] op_sel_hi:[1,0,0]
  v_exp_f32 v238, v238
  v_pk_add_f32 v[50:51], v[50:51], v[230:231]
  v_exp_f32 v239, v239
  v_cvt_pk_bf16_f32 v147, v230, v231
  v_pk_fma_f32 v[246:247], v[246:247], v[44:45], v[40:41] op_sel_hi:[1,0,0]
  v_exp_f32 v240, v240
  v_pk_add_f32 v[46:47], v[46:47], v[232:233]
  v_exp_f32 v241, v241
  v_cvt_pk_bf16_f32 v148, v232, v233
  v_pk_fma_f32 v[248:249], v[248:249], v[44:45], v[42:43] op_sel_hi:[1,0,0]
  v_exp_f32 v242, v242
  v_pk_add_f32 v[46:47], v[46:47], v[234:235]
  v_exp_f32 v243, v243
  v_cvt_pk_bf16_f32 v149, v234, v235
  v_pk_fma_f32 v[250:251], v[250:251], v[44:45], v[42:43] op_sel_hi:[1,0,0]
  v_exp_f32 v244, v244
  v_pk_add_f32 v[46:47], v[46:47], v[236:237]
  v_exp_f32 v245, v245
  v_cvt_pk_bf16_f32 v150, v236, v237
  v_pk_fma_f32 v[252:253], v[252:253], v[44:45], v[42:43] op_sel_hi:[1,0,0]
  buffer_load_dwordx4 v4, s[20:23], s37 offen offset:2048 nt lds
  v_exp_f32 v246, v246
  v_pk_add_f32 v[46:47], v[46:47], v[238:239]
L_ws46:
  s_cbranch_execz L_wa_back
  v_exp_f32 v247, v247
  v_cvt_pk_bf16_f32 v151, v238, v239
  v_pk_fma_f32 v[254:255], v[254:255], v[44:45], v[42:43] op_sel_hi:[1,0,0]
  v_exp_f32 v248, v248
  v_pk_add_f32 v[48:49], v[48:49], v[240:241]
  v_exp_f32 v249, v249
  v_cvt_pk_bf16_f32 v152, v240, v241
  v_exp_f32 v250, v250
  v_pk_add_f32 v[48:49], v[48:49], v[242:243]
  v_exp_f32 v251, v251
  v_cvt_pk_bf16_f32 v153, v242, v243
  v_exp_f32 v252, v252
  v_pk_add_f32 v[48:49], v[48:49], v[244:245]
  v_exp_f32 v253, v253
  v_cvt_pk_bf16_f32 v154, v244, v245
  v_exp_f32 v254, v254
  v_pk_add_f32 v[48:49], v[48:49], v[246:247]
  v_exp_f32 v255, v255
  v_cvt_pk_bf16_f32 v155, v246, v247
  s_waitcnt vmcnt(23) lgkmcnt(0)
  s_barrier
  ds_read_b64_tr_b16 a[96:97], v17 offset:0
  ds_read_b64_tr_b16 a[98:99], v17 offset:4096
  ds_read_b64_tr_b16 a[100:101], v18 offset:0
  ds_read_b64_tr_b16 a[102:103], v18 offset:4096
  ds_read_b64_tr_b16 a[104:105], v19 offset:0
  ds_read_b64_tr_b16 a[106:107], v19 offset:4096
  ds_read_b64_tr_b16 a[108:109], v20 offset:0
  ds_read_b64_tr_b16 a[110:111], v20 offset:4096
  ds_read_b64_tr_b16 a[112:113], v21 offset:0
  ds_read_b64_tr_b16 a[114:115], v21 offset:4096
  ds_read_b64_tr_b16 a[116:117], v22 offset:0
  ds_read_b64_tr_b16 a[118:119], v22 offset:4096
  ds_read_b64_tr_b16 a[120:121], v23 offset:0
  ds_read_b64_tr_b16 a[122:123], v23 offset:4096
  ds_read_b64_tr_b16 a[124:125], v24 offset:0
  ds_read_b64_tr_b16 a[126:127], v24 offset:4096
L_ws47:
  s_cbranch_execz L_wa_back
  v_pk_add_f32 v[50:51], v[50:51], v[248:249]
  v_cvt_pk_bf16_f32 v156, v248, v249
  v_pk_add_f32 v[50:51], v[50:51], v[250:251]
  v_cvt_pk_bf16_f32 v157, v250, v251
  v_pk_add_f32 v[50:51], v[50:51], v[252:253]
  v_cvt_pk_bf16_f32 v158, v252, v253
  v_pk_add_f32 v[50:51], v[50:51], v[254:255]
  v_cvt_pk_bf16_f32 v159, v254, v255
  buffer_load_dwordx4 v5, s[20:23], s37 offen offset:3072 nt lds
  v_add_f32 v46, v46, v47
  v_add_f32 v48, v48, v49
  v_add_f32 v50, v50, v51
  v_mov_b32 v35, v46
  v_mov_b32 v36, v48
  v_mov_b32 v37, v50
  s_nop 1
  v_permlane32_swap_b32 v35, v46
  v_permlane32_swap_b32 v36, v48
  v_permlane32_swap_b32 v37, v50
  s_nop 1
  v_add_f32 v46, v46, v35
  v_add_f32 v48, v48, v36
  v_add_f32 v50, v50, v37
  v_mov_b32 v35, v46
  v_mov_b32 v36, v48
  v_mov_b32 v37, v50
  s_nop 1
  v_permlane16_swap_b32 v35, v46
  v_permlane16_swap_b32 v36, v48
  v_permlane16_swap_b32 v37, v50
  s_nop 1
  v_add_f32 v46, v46, v35
  v_add_f32 v48, v48, v36
  v_add_f32 v50, v50, v37
  v_mov_b32 v52, v32
  v_mov_b32 v55, v46
  v_mov_b32 v53, v33
  v_mov_b32 v56, v48
  v_mov_b32 v54, v34
  v_mov_b32 v57, v50
  s_add_u32 m0, s38, 114688
  s_add_u32 s37, s36, 114688
  buffer_load_dwordx4 v4, s[20:23], s37 offen offset:0 nt lds
  ds_write_b128 v30, v[52:55]
  ds_write_b64 v30, v[56:57] offset:1024
  s_cmp_eq_u32 s30, 0
  s_cbranch_scc1 L_q1skip
  ds_write_b64 v31, a[48:49] offset:0
L_ws48:
  s_cbranch_execz L_wa_back
  ds_write_b64 v31, a[50:51] offset:4096
  ds_write_b64 v31, a[52:53] offset:8192
  v_xor_b32 v58, 32, v31
  ds_write_b64 v58, a[54:55] offset:0
  ds_write_b64 v58, a[56:57] offset:4096
  ds_write_b64 v58, a[58:59] offset:8192
  v_xor_b32 v58, 64, v31
  ds_write_b64 v58, a[60:61] offset:0
  ds_write_b64 v58, a[62:63] offset:4096
  ds_write_b64 v58, a[64:65] offset:8192
  v_xor_b32 v58, 96, v31
  ds_write_b64 v58, a[66:67] offset:0
  ds_write_b64 v58, a[68:69] offset:4096
  ds_write_b64 v58, a[70:71] offset:8192
  v_xor_b32 v58, 128, v31
  ds_write_b64 v58, a[72:73] offset:0
  ds_write_b64 v58, a[74:75] offset:4096
  ds_write_b64 v58, a[76:77] offset:8192
  v_xor_b32 v58, 160, v31
  ds_write_b64 v58, a[78:79] offset:0
  ds_write_b64 v58, a[80:81] offset:4096
  ds_write_b64 v58, a[82:83] offset:8192
  v_xor_b32 v58, 192, v31
  ds_write_b64 v58, a[84:85] offset:0
  ds_write_b64 v58, a[86:87] offset:4096
  ds_write_b64 v58, a[88:89] offset:8192
  v_xor_b32 v58, 224, v31
  ds_write_b64 v58, a[90:91] offset:0
  ds_write_b64 v58, a[92:93] offset:4096
  ds_write_b64 v58, a[94:95] offset:8192
L_q1skip:
  s_waitcnt vmcnt(21) lgkmcnt(0)
  s_barrier
  v_mfma_f32_16x16x32_bf16 v[160:163], a[96:99], v[64:67], 0
  ds_read_b64_tr_b16 a[128:129], v17 offset:16384
L_ws49:
  s_cbranch_execz L_wa_back
  v_mfma_f32_16x16x32_bf16 v[164:167], a[96:99], v[68:71], 0
  ds_read_b64_tr_b16 a[130:131], v17 offset:20480
  buffer_load_dwordx4 v5, s[20:23], s37 offen offset:1024 nt lds
  v_mfma_f32_16x16x32_bf16 v[168:171], a[96:99], v[72:75], 0
  ds_read_b64_tr_b16 a[132:133], v18 offset:16384
  v_mfma_f32_16x16x32_bf16 v[172:175], a[100:103], v[64:67], 0
  ds_read_b64_tr_b16 a[134:135], v18 offset:20480
  buffer_load_dwordx4 v4, s[20:23], s37 offen offset:2048 nt lds
  v_mfma_f32_16x16x32_bf16 v[176:179], a[100:103], v[68:71], 0
  ds_read_b64_tr_b16 a[136:137], v19 offset:16384
  v_mfma_f32_16x16x32_bf16 v[180:183], a[100:103], v[72:75], 0
  ds_read_b64_tr_b16 a[138:139], v19 offset:20480
  buffer_load_dwordx4 v5, s[20:23], s37 offen offset:3072 nt lds
  v_mfma_f32_16x16x32_bf16 v[184:187], a[104:107], v[64:67], 0
  ds_read_b64_tr_b16 a[140:141], v20 offset:16384
  v_mfma_f32_16x16x32_bf16 v[188:191], a[104:107], v[68:71], 0
  ds_read_b64_tr_b16 a[142:143], v20 offset:20480
  s_add_u32 m0, s38, 0
  s_add_u32 s37, s36, 131072
  buffer_load_dwordx4 v4, s[16:19], s37 offen offset:0 nt lds
  v_mfma_f32_16x16x32_bf16 v[192:195], a[104:107], v[72:75], 0
  ds_read_b64_tr_b16 a[144:145], v21 offset:16384
  v_mfma_f32_16x16x32_bf16 v[196:199], a[108:111], v[64:67], 0
  ds_read_b64_tr_b16 a[146:147], v21 offset:20480
  v_mfma_f32_16x16x32_bf16 v[200:203], a[108:111], v[68:71], 0
  ds_read_b64_tr_b16 a[148:149], v22 offset:16384
  v_mfma_f32_16x16x32_bf16 v[204:207], a[108:111], v[72:75], 0
  ds_read_b64_tr_b16 a[150:151], v22 offset:20480
  v_mfma_f32_16x16x32_bf16 v[208:211], a[112:115], v[64:67], 0
  ds_read_b64_tr_b16 a[152:153], v23 offset:16384
  v_mfma_f32_16x16x32_bf16 v[212:215], a[112:115], v[68:71], 0
  ds_read_b64_tr_b16 a[154:155], v23 offset:20480
L_ws50:
  s_cbranch_execz L_wa_back
  v_mfma_f32_16x16x32_bf16 v[216:219], a[112:115], v[72:75], 0
  ds_read_b64_tr_b16 a[156:157], v24 offset:16384
  v_mfma_f32_16x16x32_bf16 v[220:223], a[116:119], v[64:67], 0
  ds_read_b64_tr_b16 a[158:159], v24 offset:20480
  v_mfma_f32_16x16x32_bf16 v[224:227], a[116:119], v[68:71], 0
  v_xor_b32 v58, 4096, v30
  v_mfma_f32_16x16x32_bf16 v[228:231], a[116:119], v[72:75], 0
  buffer_load_dwordx4 v5, s[16:19], s37 offen offset:1024 nt lds
  ds_read_b128 v[52:55], v58
  v_mfma_f32_16x16x32_bf16 v[232:235], a[120:123], v[64:67], 0
  ds_read_b64 v[56:57], v58 offset:1024
  v_mfma_f32_16x16x32_bf16 v[236:239], a[120:123], v[68:71], 0
  v_mfma_f32_16x16x32_bf16 v[240:243], a[120:123], v[72:75], 0
  v_mfma_f32_16x16x32_bf16 v[244:247], a[124:127], v[64:67], 0
  v_mfma_f32_16x16x32_bf16 v[248:251], a[124:127], v[68:71], 0
  v_mfma_f32_16x16x32_bf16 v[252:255], a[124:127], v[72:75], 0
  s_waitcnt vmcnt(22) lgkmcnt(0)
  s_barrier
  v_mfma_f32_16x16x32_bf16 v[160:163], a[128:131], v[76:79], v[160:163]
  ds_read_b64_tr_b16 a[96:97], v17 offset:32768
  v_max_f32 v35, v32, v52
  v_mfma_f32_16x16x32_bf16 v[164:167], a[128:131], v[80:83], v[164:167]
  ds_read_b64_tr_b16 a[98:99], v17 offset:36864
  v_max_f32 v36, v33, v53
  v_mfma_f32_16x16x32_bf16 v[168:171], a[128:131], v[84:87], v[168:171]
  ds_read_b64_tr_b16 a[100:101], v18 offset:32768
  buffer_load_dwordx4 v4, s[16:19], s37 offen offset:2048 nt lds
  v_max_f32 v37, v34, v54
  v_mfma_f32_16x16x32_bf16 v[172:175], a[132:135], v[76:79], v[172:175]
  ds_read_b64_tr_b16 a[102:103], v18 offset:36864
  v_sub_f32 v32, v32, v35
  v_sub_f32 v52, v52, v35
  v_mfma_f32_16x16x32_bf16 v[176:179], a[132:135], v[80:83], v[176:179]
  ds_read_b64_tr_b16 a[104:105], v19 offset:32768
  v_sub_f32 v33, v33, v36
L_ws51:
  s_cbranch_execz L_wa_back
  v_sub_f32 v53, v53, v36
  v_mfma_f32_16x16x32_bf16 v[180:183], a[132:135], v[84:87], v[180:183]
  ds_read_b64_tr_b16 a[106:107], v19 offset:36864
  v_sub_f32 v34, v34, v37
  v_sub_f32 v54, v54, v37
  v_mfma_f32_16x16x32_bf16 v[184:187], a[136:139], v[76:79], v[184:187]
  ds_read_b64_tr_b16 a[108:109], v20 offset:32768
  v_mul_f32 v32, v44, v32
  v_mul_f32 v52, v44, v52
  v_mfma_f32_16x16x32_bf16 v[188:191], a[136:139], v[80:83], v[188:191]
  ds_read_b64_tr_b16 a[110:111], v20 offset:36864
  v_mul_f32 v33, v44, v33
  v_mul_f32 v53, v44, v53
  v_mfma_f32_16x16x32_bf16 v[192:195], a[136:139], v[84:87], v[192:195]
  ds_read_b64_tr_b16 a[112:113], v21 offset:32768
  v_mul_f32 v34, v44, v34
  v_mul_f32 v54, v44, v54
  v_mfma_f32_16x16x32_bf16 v[196:199], a[140:143], v[76:79], v[196:199]
  ds_read_b64_tr_b16 a[114:115], v21 offset:36864
  v_exp_f32 v32, v32
  v_exp_f32 v52, v52
  v_mfma_f32_16x16x32_bf16 v[200:203], a[140:143], v[80:83], v[200:203]
  ds_read_b64_tr_b16 a[116:117], v22 offset:32768
  v_exp_f32 v33, v33
  v_exp_f32 v53, v53
  v_mfma_f32_16x16x32_bf16 v[204:207], a[140:143], v[84:87], v[204:207]
  ds_read_b64_tr_b16 a[118:119], v22 offset:36864
  v_exp_f32 v34, v34
  v_exp_f32 v54, v54
  v_mfma_f32_16x16x32_bf16 v[208:211], a[144:147], v[76:79], v[208:211]
  ds_read_b64_tr_b16 a[120:121], v23 offset:32768
  v_mul_f32 v46, v46, v32
  v_mfma_f32_16x16x32_bf16 v[212:215], a[144:147], v[80:83], v[212:215]
  ds_read_b64_tr_b16 a[122:123], v23 offset:36864
  v_mul_f32 v48, v48, v33
  v_mfma_f32_16x16x32_bf16 v[216:219], a[144:147], v[84:87], v[216:219]
  ds_read_b64_tr_b16 a[124:125], v24 offset:32768
  v_mul_f32 v50, v50, v34
  v_mfma_f32_16x16x32_bf16 v[220:223], a[148:151], v[76:79], v[220:223]
  ds_read_b64_tr_b16 a[126:127], v24 offset:36864
  v_fma_f32 v46, v55, v52, v46
L_ws52:
  s_cbranch_execz L_wa_back
  v_mfma_f32_16x16x32_bf16 v[224:227], a[148:151], v[80:83], v[224:227]
  buffer_load_dwordx4 v5, s[16:19], s37 offen offset:3072 nt lds
  v_fma_f32 v48, v56, v53, v48
  v_mfma_f32_16x16x32_bf16 v[228:231], a[148:151], v[84:87], v[228:231]
  v_fma_f32 v50, v57, v54, v50
  v_mfma_f32_16x16x32_bf16 v[232:235], a[152:155], v[76:79], v[232:235]
  v_rcp_f32 v46, v46
  v_mfma_f32_16x16x32_bf16 v[236:239], a[152:155], v[80:83], v[236:239]
  v_rcp_f32 v48, v48
  v_mfma_f32_16x16x32_bf16 v[240:243], a[152:155], v[84:87], v[240:243]
  v_rcp_f32 v50, v50
  v_mfma_f32_16x16x32_bf16 v[244:247], a[156:159], v[76:79], v[244:247]
  v_mul_f32 v38, v46, v32
  v_mul_f32 v39, v46, v52
  v_mfma_f32_16x16x32_bf16 v[248:251], a[156:159], v[80:83], v[248:251]
  v_mul_f32 v40, v48, v33
  v_mul_f32 v41, v48, v53
  v_mfma_f32_16x16x32_bf16 v[252:255], a[156:159], v[84:87], v[252:255]
  v_mul_f32 v42, v50, v34
  v_mul_f32 v43, v50, v54
  s_waitcnt vmcnt(20) lgkmcnt(0)
  s_barrier
  v_mfma_f32_16x16x32_bf16 v[160:163], a[96:99], v[88:91], v[160:163]
  ds_read_b64_tr_b16 a[128:129], v17 offset:49152
  v_mfma_f32_16x16x32_bf16 v[164:167], a[96:99], v[92:95], v[164:167]
  ds_read_b64_tr_b16 a[130:131], v17 offset:53248
  s_add_u32 m0, s38, 16384
  s_add_u32 s37, s36, 147456
  buffer_load_dwordx4 v4, s[16:19], s37 offen offset:0 nt lds
  v_mfma_f32_16x16x32_bf16 v[168:171], a[96:99], v[96:99], v[168:171]
  ds_read_b64_tr_b16 a[132:133], v18 offset:49152
  v_mfma_f32_16x16x32_bf16 v[172:175], a[100:103], v[88:91], v[172:175]
  ds_read_b64_tr_b16 a[134:135], v18 offset:53248
  v_mfma_f32_16x16x32_bf16 v[176:179], a[100:103], v[92:95], v[176:179]
  ds_read_b64_tr_b16 a[136:137], v19 offset:49152
  v_mfma_f32_16x16x32_bf16 v[180:183], a[100:103], v[96:99], v[180:183]
  ds_read_b64_tr_b16 a[138:139], v19 offset:53248
L_ws53:
  s_cbranch_execz L_wa_back
  v_mfma_f32_16x16x32_bf16 v[184:187], a[104:107], v[88:91], v[184:187]
  ds_read_b64_tr_b16 a[140:141], v20 offset:49152
  v_mfma_f32_16x16x32_bf16 v[188:191], a[104:107], v[92:95], v[188:191]
  ds_read_b64_tr_b16 a[142:143], v20 offset:53248
  v_mfma_f32_16x16x32_bf16 v[192:195], a[104:107], v[96:99], v[192:195]
  ds_read_b64_tr_b16 a[144:145], v21 offset:49152
  v_mfma_f32_16x16x32_bf16 v[196:199], a[108:111], v[88:91], v[196:199]
  ds_read_b64_tr_b16 a[146:147], v21 offset:53248
  v_mfma_f32_16x16x32_bf16 v[200:203], a[108:111], v[92:95], v[200:203]
  ds_read_b64_tr_b16 a[148:149], v22 offset:49152
  v_mfma_f32_16x16x32_bf16 v[204:207], a[108:111], v[96:99], v[204:207]
  ds_read_b64_tr_b16 a[150:151], v22 offset:53248
  v_mfma_f32_16x16x32_bf16 v[208:211], a[112:115], v[88:91], v[208:211]
  ds_read_b64_tr_b16 a[152:153], v23 offset:49152
  ds_read_b128 a[48:51], v6 offset:0
  v_mfma_f32_16x16x32_bf16 v[212:215], a[112:115], v[92:95], v[212:215]
  ds_read_b64_tr_b16 a[154:155], v23 offset:53248
  ds_read_b128 a[52:55], v6 offset:4096
  v_mfma_f32_16x16x32_bf16 v[216:219], a[112:115], v[96:99], v[216:219]
  ds_read_b64_tr_b16 a[156:157], v24 offset:49152
  ds_read_b128 a[56:59], v6 offset:8192
  v_mfma_f32_16x16x32_bf16 v[220:223], a[116:119], v[88:91], v[220:223]
  ds_read_b64_tr_b16 a[158:159], v24 offset:53248
  ds_read_b128 a[60:63], v7 offset:0
  v_mfma_f32_16x16x32_bf16 v[224:227], a[116:119], v[92:95], v[224:227]
  ds_read_b128 a[64:67], v7 offset:4096
  v_mfma_f32_16x16x32_bf16 v[228:231], a[116:119], v[96:99], v[228:231]
  ds_read_b128 a[68:71], v7 offset:8192
  v_mfma_f32_16x16x32_bf16 v[232:235], a[120:123], v[88:91], v[232:235]
  ds_read_b128 a[72:75], v8 offset:0
  v_mfma_f32_16x16x32_bf16 v[236:239], a[120:123], v[92:95], v[236:239]
L_ws54:
  s_cbranch_execz L_wa_back
  ds_read_b128 a[76:79], v8 offset:4096
  v_mfma_f32_16x16x32_bf16 v[240:243], a[120:123], v[96:99], v[240:243]
  ds_read_b128 a[80:83], v8 offset:8192
  v_mfma_f32_16x16x32_bf16 v[244:247], a[124:127], v[88:91], v[244:247]
  ds_read_b128 a[84:87], v9 offset:0
  v_mfma_f32_16x16x32_bf16 v[248:251], a[124:127], v[92:95], v[248:251]
  ds_read_b128 a[88:91], v9 offset:4096
  v_mfma_f32_16x16x32_bf16 v[252:255], a[124:127], v[96:99], v[252:255]
  ds_read_b128 a[92:95], v9 offset:8192
  s_waitcnt vmcnt(17) lgkmcnt(0)
  s_barrier
  v_add_u32 v17, 0x10000, v17
  v_add_u32 v18, 0x10000, v18
  v_add_u32 v19, 0x10000, v19
  v_add_u32 v20, 0x10000, v20
  v_add_u32 v21, 0x10000, v21
  v_add_u32 v22, 0x10000, v22
  v_add_u32 v23, 0x10000, v23
  v_add_u32 v24, 0x10000, v24
  v_mfma_f32_16x16x32_bf16 v[160:163], a[128:131], v[100:103], v[160:163]
  ds_read_b64_tr_b16 a[96:97], v17 offset:0
  v_add_u32 v58, 0, v1
  v_mul_u32_u24 v63, 3277, v58
  v_mfma_f32_16x16x32_bf16 v[164:167], a[128:131], v[104:107], v[164:167]
  ds_read_b64_tr_b16 a[98:99], v17 offset:4096
  v_lshrrev_b32 v63, 16, v63
  v_mfma_f32_16x16x32_bf16 v[168:171], a[128:131], v[108:111], v[168:171]
  ds_read_b64_tr_b16 a[100:101], v18 offset:0
  v_mul_u32_u24 v10, 20, v63
  v_mfma_f32_16x16x32_bf16 v[172:175], a[132:135], v[100:103], v[172:175]
  ds_read_b64_tr_b16 a[102:103], v18 offset:4096
  v_sub_u32 v58, v58, v10
  v_mfma_f32_16x16x32_bf16 v[176:179], a[132:135], v[104:107], v[176:179]
  ds_read_b64_tr_b16 a[104:105], v19 offset:0
  v_lshrrev_b32 v10, 1, v63
L_ws55:
  s_cbranch_execz L_wa_back
  v_mfma_f32_16x16x32_bf16 v[180:183], a[132:135], v[108:111], v[180:183]
  ds_read_b64_tr_b16 a[106:107], v19 offset:4096
  buffer_load_dwordx4 v5, s[16:19], s37 offen offset:1024 nt lds
  v_and_b32 v10, 2, v10
  v_mfma_f32_16x16x32_bf16 v[184:187], a[136:139], v[100:103], v[184:187]
  ds_read_b64_tr_b16 a[108:109], v20 offset:0
  v_xor_b32 v58, v58, v10
  v_mfma_f32_16x16x32_bf16 v[188:191], a[136:139], v[104:107], v[188:191]
  ds_read_b64_tr_b16 a[110:111], v20 offset:4096
  v_mul_u32_u24 v63, 1280, v63
  v_mfma_f32_16x16x32_bf16 v[192:195], a[136:139], v[108:111], v[192:195]
  ds_read_b64_tr_b16 a[112:113], v21 offset:0
  v_lshl_add_u32 v58, v58, 4, v63
  v_mfma_f32_16x16x32_bf16 v[196:199], a[140:143], v[100:103], v[196:199]
  ds_read_b64_tr_b16 a[114:115], v21 offset:4096
  s_mul_i32 s3, s28, 20480
  v_mfma_f32_16x16x32_bf16 v[200:203], a[140:143], v[104:107], v[200:203]
  ds_read_b64_tr_b16 a[116:117], v22 offset:0
  s_add_u32 s3, s3, 0x0
  v_mfma_f32_16x16x32_bf16 v[204:207], a[140:143], v[108:111], v[204:207]
  ds_read_b64_tr_b16 a[118:119], v22 offset:4096
  v_add_u32 v10, s3, v58
  v_mfma_f32_16x16x32_bf16 v[208:211], a[144:147], v[100:103], v[208:211]
  ds_read_b64_tr_b16 a[120:121], v23 offset:0
  v_add_u32 v58, 64, v1
  v_mul_u32_u24 v63, 3277, v58
  v_mfma_f32_16x16x32_bf16 v[212:215], a[144:147], v[104:107], v[212:215]
  ds_read_b64_tr_b16 a[122:123], v23 offset:4096
  v_lshrrev_b32 v63, 16, v63
  v_mfma_f32_16x16x32_bf16 v[216:219], a[144:147], v[108:111], v[216:219]
  ds_read_b64_tr_b16 a[124:125], v24 offset:0
  v_mul_u32_u24 v11, 20, v63
  v_mfma_f32_16x16x32_bf16 v[220:223], a[148:151], v[100:103], v[220:223]
  ds_read_b64_tr_b16 a[126:127], v24 offset:4096
  v_sub_u32 v58, v58, v11
  v_mfma_f32_16x16x32_bf16 v[224:227], a[148:151], v[104:107], v[224:227]
L_ws56:
  s_cbranch_execz L_wa_back
  v_lshrrev_b32 v11, 1, v63
  v_mfma_f32_16x16x32_bf16 v[228:231], a[148:151], v[108:111], v[228:231]
  v_and_b32 v11, 2, v11
  v_mfma_f32_16x16x32_bf16 v[232:235], a[152:155], v[100:103], v[232:235]
  v_xor_b32 v58, v58, v11
  v_mfma_f32_16x16x32_bf16 v[236:239], a[152:155], v[104:107], v[236:239]
  buffer_load_dwordx4 v4, s[16:19], s37 offen offset:2048 nt lds
  v_mul_u32_u24 v63, 1280, v63
  v_mfma_f32_16x16x32_bf16 v[240:243], a[152:155], v[108:111], v[240:243]
  v_lshl_add_u32 v58, v58, 4, v63
  v_mfma_f32_16x16x32_bf16 v[244:247], a[156:159], v[100:103], v[244:247]
  s_mul_i32 s3, s28, 20480
  v_mfma_f32_16x16x32_bf16 v[248:251], a[156:159], v[104:107], v[248:251]
  s_add_u32 s3, s3, 0xfffffc00
  v_mfma_f32_16x16x32_bf16 v[252:255], a[156:159], v[108:111], v[252:255]
  v_add_u32 v11, s3, v58
  s_waitcnt vmcnt(15) lgkmcnt(0)
  s_barrier
  v_mfma_f32_16x16x32_bf16 v[160:163], a[96:99], v[112:115], v[160:163]
  ds_read_b64_tr_b16 a[128:129], v17 offset:16384
  v_add_u32 v58, 128, v1
  v_mul_u32_u24 v63, 3277, v58
  v_mfma_f32_16x16x32_bf16 v[164:167], a[96:99], v[116:119], v[164:167]
  ds_read_b64_tr_b16 a[130:131], v17 offset:20480
  v_lshrrev_b32 v63, 16, v63
  v_mfma_f32_16x16x32_bf16 v[168:171], a[96:99], v[120:123], v[168:171]
  ds_read_b64_tr_b16 a[132:133], v18 offset:16384
  v_mul_u32_u24 v12, 20, v63
  v_mfma_f32_16x16x32_bf16 v[172:175], a[100:103], v[112:115], v[172:175]
  ds_read_b64_tr_b16 a[134:135], v18 offset:20480
  v_sub_u32 v58, v58, v12
  v_mfma_f32_16x16x32_bf16 v[176:179], a[100:103], v[116:119], v[176:179]
  ds_read_b64_tr_b16 a[136:137], v19 offset:16384
  v_lshrrev_b32 v12, 1, v63
  v_mfma_f32_16x16x32_bf16 v[180:183], a[100:103], v[120:123], v[180:183]
  ds_read_b64_tr_b16 a[138:139], v19 offset:20480
L_ws57:
  s_cbranch_execz L_wa_back
  buffer_load_dwordx4 v5, s[16:19], s37 offen offset:3072 nt lds
  v_and_b32 v12, 2, v12
  v_mfma_f32_16x16x32_bf16 v[184:187], a[104:107], v[112:115], v[184:187]
  ds_read_b64_tr_b16 a[140:141], v20 offset:16384
  v_xor_b32 v58, v58, v12
  v_mfma_f32_16x16x32_bf16 v[188:191], a[104:107], v[116:119], v[188:191]
  ds_read_b64_tr_b16 a[142:143], v20 offset:20480
  v_mul_u32_u24 v63, 1280, v63
  v_mfma_f32_16x16x32_bf16 v[192:195], a[104:107], v[120:123], v[192:195]
  ds_read_b64_tr_b16 a[144:145], v21 offset:16384
  v_lshl_add_u32 v58, v58, 4, v63
  v_mfma_f32_16x16x32_bf16 v[196:199], a[108:111], v[112:115], v[196:199]
  ds_read_b64_tr_b16 a[146:147], v21 offset:20480
  s_mul_i32 s3, s28, 20480
  v_mfma_f32_16x16x32_bf16 v[200:203], a[108:111], v[116:119], v[200:203]
  ds_read_b64_tr_b16 a[148:149], v22 offset:16384
  s_add_u32 s3, s3, 0xfffff800
  v_mfma_f32_16x16x32_bf16 v[204:207], a[108:111], v[120:123], v[204:207]
  ds_read_b64_tr_b16 a[150:151], v22 offset:20480
  v_add_u32 v12, s3, v58
  v_mfma_f32_16x16x32_bf16 v[208:211], a[112:115], v[112:115], v[208:211]
  ds_read_b64_tr_b16 a[152:153], v23 offset:16384
  v_add_u32 v58, 192, v1
  v_mul_u32_u24 v63, 3277, v58
  v_mfma_f32_16x16x32_bf16 v[212:215], a[112:115], v[116:119], v[212:215]
  ds_read_b64_tr_b16 a[154:155], v23 offset:20480
  v_lshrrev_b32 v63, 16, v63
  v_mfma_f32_16x16x32_bf16 v[216:219], a[112:115], v[120:123], v[216:219]
  ds_read_b64_tr_b16 a[156:157], v24 offset:16384
  v_mul_u32_u24 v25, 20, v63
  v_mfma_f32_16x16x32_bf16 v[220:223], a[116:119], v[112:115], v[220:223]
  ds_read_b64_tr_b16 a[158:159], v24 offset:20480
  v_sub_u32 v58, v58, v25
  v_mfma_f32_16x16x32_bf16 v[224:227], a[116:119], v[116:119], v[224:227]
  v_lshrrev_b32 v25, 1, v63
L_ws58:
  s_cbranch_execz L_wa_back
  v_mfma_f32_16x16x32_bf16 v[228:231], a[116:119], v[120:123], v[228:231]
  v_and_b32 v25, 2, v25
  v_mfma_f32_16x16x32_bf16 v[232:235], a[120:123], v[112:115], v[232:235]
  v_xor_b32 v58, v58, v25
  v_mfma_f32_16x16x32_bf16 v[236:239], a[120:123], v[116:119], v[236:239]
  s_add_u32 m0, s38, 32768
  s_add_u32 s37, s36, 163840
  buffer_load_dwordx4 v4, s[16:19], s37 offen offset:0 nt lds
  v_mul_u32_u24 v63, 1280, v63
  v_mfma_f32_16x16x32_bf16 v[240:243], a[120:123], v[120:123], v[240:243]
  v_lshl_add_u32 v58, v58, 4, v63
  v_mfma_f32_16x16x32_bf16 v[244:247], a[124:127], v[112:115], v[244:247]
  s_mul_i32 s3, s28, 20480
  v_mfma_f32_16x16x32_bf16 v[248:251], a[124:127], v[116:119], v[248:251]
  s_add_u32 s3, s3, 0xfffff400
  v_mfma_f32_16x16x32_bf16 v[252:255], a[124:127], v[120:123], v[252:255]
  v_add_u32 v25, s3, v58
  s_waitcnt vmcnt(13) lgkmcnt(0)
  s_barrier
  v_mfma_f32_16x16x32_bf16 v[160:163], a[128:131], v[124:127], v[160:163]
  ds_read_b64_tr_b16 a[96:97], v17 offset:32768
  v_add_u32 v58, 256, v1
  v_mfma_f32_16x16x32_bf16 v[164:167], a[128:131], v[128:131], v[164:167]
  ds_read_b64_tr_b16 a[98:99], v17 offset:36864
  v_mul_u32_u24 v63, 3277, v58
  v_mfma_f32_16x16x32_bf16 v[168:171], a[128:131], v[132:135], v[168:171]
  ds_read_b64_tr_b16 a[100:101], v18 offset:32768
  v_mfma_f32_16x16x32_bf16 v[172:175], a[132:135], v[124:127], v[172:175]
  ds_read_b64_tr_b16 a[102:103], v18 offset:36864
  v_lshrrev_b32 v63, 16, v63
  v_mfma_f32_16x16x32_bf16 v[176:179], a[132:135], v[128:131], v[176:179]
  ds_read_b64_tr_b16 a[104:105], v19 offset:32768
  buffer_load_dwordx4 v5, s[16:19], s37 offen offset:1024 nt lds
  v_mfma_f32_16x16x32_bf16 v[180:183], a[132:135], v[132:135], v[180:183]
  ds_read_b64_tr_b16 a[106:107], v19 offset:36864
L_ws59:
  s_cbranch_execz L_wa_back
  v_mul_u32_u24 v26, 20, v63
  v_mfma_f32_16x16x32_bf16 v[184:187], a[136:139], v[124:127], v[184:187]
  ds_read_b64_tr_b16 a[108:109], v20 offset:32768
  v_mfma_f32_16x16x32_bf16 v[188:191], a[136:139], v[128:131], v[188:191]
  ds_read_b64_tr_b16 a[110:111], v20 offset:36864
  v_sub_u32 v58, v58, v26
  v_mfma_f32_16x16x32_bf16 v[192:195], a[136:139], v[132:135], v[192:195]
  ds_read_b64_tr_b16 a[112:113], v21 offset:32768
  v_mfma_f32_16x16x32_bf16 v[196:199], a[140:143], v[124:127], v[196:199]
  ds_read_b64_tr_b16 a[114:115], v21 offset:36864
  v_lshrrev_b32 v26, 1, v63
  v_mfma_f32_16x16x32_bf16 v[200:203], a[140:143], v[128:131], v[200:203]
  ds_read_b64_tr_b16 a[116:117], v22 offset:32768
  v_mfma_f32_16x16x32_bf16 v[204:207], a[140:143], v[132:135], v[204:207]
  ds_read_b64_tr_b16 a[118:119], v22 offset:36864
  v_and_b32 v26, 2, v26
  v_mfma_f32_16x16x32_bf16 v[208:211], a[144:147], v[124:127], v[208:211]
  ds_read_b64_tr_b16 a[120:121], v23 offset:32768
  v_xor_b32 v58, v58, v26
  v_mfma_f32_16x16x32_bf16 v[212:215], a[144:147], v[128:131], v[212:215]
  ds_read_b64_tr_b16 a[122:123], v23 offset:36864
  v_mfma_f32_16x16x32_bf16 v[216:219], a[144:147], v[132:135], v[216:219]
  ds_read_b64_tr_b16 a[124:125], v24 offset:32768
  v_mul_u32_u24 v63, 1280, v63
  v_mfma_f32_16x16x32_bf16 v[220:223], a[148:151], v[124:127], v[220:223]
  ds_read_b64_tr_b16 a[126:127], v24 offset:36864
  v_mfma_f32_16x16x32_bf16 v[224:227], a[148:151], v[128:131], v[224:227]
  v_lshl_add_u32 v58, v58, 4, v63
  v_mfma_f32_16x16x32_bf16 v[228:231], a[148:151], v[132:135], v[228:231]
  v_mfma_f32_16x16x32_bf16 v[232:235], a[152:155], v[124:127], v[232:235]
  buffer_load_dwordx4 v4, s[16:19], s37 offen offset:2048 nt lds
  s_mul_i32 s3, s28, 20480
  v_mfma_f32_16x16x32_bf16 v[236:239], a[152:155], v[128:131], v[236:239]
  v_mfma_f32_16x16x32_bf16 v[240:243], a[152:155], v[132:135], v[240:243]
L_ws60:
  s_cbranch_execz L_wa_back
  s_add_u32 s3, s3, 0x0
  v_mfma_f32_16x16x32_bf16 v[244:247], a[156:159], v[124:127], v[244:247]
  v_mfma_f32_16x16x32_bf16 v[248:251], a[156:159], v[128:131], v[248:251]
  v_add_u32 v26, s3, v58
  v_mfma_f32_16x16x32_bf16 v[252:255], a[156:159], v[132:135], v[252:255]
  s_waitcnt vmcnt(11) lgkmcnt(0)
  s_barrier
  v_mfma_f32_16x16x32_bf16 v[160:163], a[96:99], v[136:139], v[160:163]
  ds_read_b64_tr_b16 a[144:145], v21 offset:49152
  v_lshl_add_u32 v58, v3, 2, v60
  v_mfma_f32_16x16x32_bf16 v[164:167], a[96:99], v[140:143], v[164:167]
  ds_read_b64_tr_b16 a[146:147], v21 offset:53248
  v_mul_u32_u24 v58, 320, v58
  v_mfma_f32_16x16x32_bf16 v[168:171], a[96:99], v[144:147], v[168:171]
  ds_read_b64_tr_b16 a[148:149], v22 offset:49152
  v_lshl_add_u32 v58, v61, 3, v58
  v_mfma_f32_16x16x32_bf16 v[172:175], a[100:103], v[136:139], v[172:175]
  ds_read_b64_tr_b16 a[150:151], v22 offset:53248
  s_lshl_b32 s3, s30, 6
  v_mfma_f32_16x16x32_bf16 v[176:179], a[100:103], v[140:143], v[176:179]
  ds_read_b64_tr_b16 a[152:153], v23 offset:49152
  buffer_load_dwordx4 v5, s[16:19], s37 offen offset:3072 nt lds
  s_sub_u32 s3, 32, s3
  v_mfma_f32_16x16x32_bf16 v[180:183], a[100:103], v[144:147], v[180:183]
  ds_read_b64_tr_b16 a[154:155], v23 offset:53248
  v_and_b32 v63, 1, v3
  v_mfma_f32_16x16x32_bf16 v[184:187], a[104:107], v[136:139], v[184:187]
  ds_read_b64_tr_b16 a[156:157], v24 offset:49152
  v_mul_i32_i24 v63, s3, v63
  v_mfma_f32_16x16x32_bf16 v[188:191], a[104:107], v[140:143], v[188:191]
  ds_read_b64_tr_b16 a[158:159], v24 offset:53248
  v_mfma_f32_16x16x32_bf16 v[192:195], a[104:107], v[144:147], v[192:195]
  ds_read_b64_tr_b16 a[128:129], v17 offset:49152
  s_mul_i32 s3, s30, 160
  v_mfma_f32_16x16x32_bf16 v[196:199], a[108:111], v[136:139], v[196:199]
L_ws61:
  s_cbranch_execz L_wa_back
  ds_read_b64_tr_b16 a[130:131], v17 offset:53248
  s_add_u32 s3, s3, 73728
  v_mfma_f32_16x16x32_bf16 v[200:203], a[108:111], v[140:143], v[200:203]
  ds_read_b64_tr_b16 a[132:133], v18 offset:49152
  v_add3_u32 v6, v58, v63, s3
  v_mfma_f32_16x16x32_bf16 v[204:207], a[108:111], v[144:147], v[204:207]
  ds_read_b64_tr_b16 a[134:135], v18 offset:53248
  v_sub_u32 v58, v58, v63
  v_mfma_f32_16x16x32_bf16 v[208:211], a[112:115], v[136:139], v[208:211]
  ds_read_b64_tr_b16 a[136:137], v19 offset:49152
  v_add_u32 v7, s3, v58
  v_mfma_f32_16x16x32_bf16 v[212:215], a[112:115], v[140:143], v[212:215]
  ds_read_b64_tr_b16 a[138:139], v19 offset:53248
  s_mul_i32 s3, s29, 3072
  v_mfma_f32_16x16x32_bf16 v[216:219], a[112:115], v[144:147], v[216:219]
  ds_read_b64_tr_b16 a[140:141], v20 offset:49152
  s_add_u32 s3, s3, 81920
  v_mfma_f32_16x16x32_bf16 v[220:223], a[116:119], v[136:139], v[220:223]
  ds_read_b64_tr_b16 a[142:143], v20 offset:53248
  v_mfma_f32_16x16x32_bf16 v[224:227], a[116:119], v[140:143], v[224:227]
  v_add_u32 v8, s3, v27
  v_mfma_f32_16x16x32_bf16 v[228:231], a[116:119], v[144:147], v[228:231]
  v_mul_u32_u24 v9, 2560, v2
  v_mfma_f32_16x16x32_bf16 v[232:235], a[120:123], v[136:139], v[232:235]
  s_add_u32 m0, s35, 94208
  s_bfe_u32 s37, s45, 0x20001
  s_mul_i32 s37, s37, 327680
  s_bfe_u32 s47, s45, 0x10000
  s_mul_i32 s47, s47, 81920
  s_add_u32 s37, s37, s47
  s_add_u32 s37, s37, s34
  buffer_load_dwordx4 v10, s[48:51], s37 offen offset:0 lds
  v_lshl_add_u32 v9, v3, 3, v9
  v_mfma_f32_16x16x32_bf16 v[236:239], a[120:123], v[140:143], v[236:239]
L_ws62:
  s_cbranch_execz L_wa_back
  v_mov_b32 v31, s60
  v_mfma_f32_16x16x32_bf16 v[240:243], a[120:123], v[144:147], v[240:243]
  v_and_b32 v61, 1, v1
  v_mfma_f32_16x16x32_bf16 v[244:247], a[124:127], v[136:139], v[244:247]
  v_lshlrev_b32 v61, 2, v61
  v_mfma_f32_16x16x32_bf16 v[248:251], a[124:127], v[140:143], v[248:251]
  v_lshlrev_b32 v3, 7, v1
  v_mfma_f32_16x16x32_bf16 v[252:255], a[124:127], v[144:147], v[252:255]
  s_waitcnt lgkmcnt(0)
  s_barrier
  v_mfma_f32_16x16x32_bf16 v[208:211], a[144:147], v[148:151], v[208:211]
  v_mfma_f32_16x16x32_bf16 v[212:215], a[144:147], v[152:155], v[212:215]
  v_mfma_f32_16x16x32_bf16 v[216:219], a[144:147], v[156:159], v[216:219]
  buffer_load_dwordx4 v11, s[48:51], s37 offen offset:1024 lds
  v_mfma_f32_16x16x32_bf16 v[220:223], a[148:151], v[148:151], v[220:223]
  v_mfma_f32_16x16x32_bf16 v[224:227], a[148:151], v[152:155], v[224:227]
  v_mfma_f32_16x16x32_bf16 v[228:231], a[148:151], v[156:159], v[228:231]
  v_mfma_f32_16x16x32_bf16 v[232:235], a[152:155], v[148:151], v[232:235]
  v_mfma_f32_16x16x32_bf16 v[236:239], a[152:155], v[152:155], v[236:239]
  v_mfma_f32_16x16x32_bf16 v[240:243], a[152:155], v[156:159], v[240:243]
  v_mfma_f32_16x16x32_bf16 v[244:247], a[156:159], v[148:151], v[244:247]
  v_mfma_f32_16x16x32_bf16 v[248:251], a[156:159], v[152:155], v[248:251]
  ds_write_b128 v28, v[208:211] offset:0
  v_mfma_f32_16x16x32_bf16 v[252:255], a[156:159], v[156:159], v[252:255]
  buffer_load_dwordx4 v12, s[48:51], s37 offen offset:2048 lds
  ds_write_b128 v28, v[212:215] offset:1024
  v_mfma_f32_16x16x32_bf16 v[160:163], a[128:131], v[148:151], v[160:163]
  ds_write_b128 v28, v[216:219] offset:2048
  v_mfma_f32_16x16x32_bf16 v[164:167], a[128:131], v[152:155], v[164:167]
  ds_write_b128 v28, v[220:223] offset:3072
  v_mfma_f32_16x16x32_bf16 v[168:171], a[128:131], v[156:159], v[168:171]
  ds_write_b128 v28, v[224:227] offset:4096
  v_mfma_f32_16x16x32_bf16 v[172:175], a[132:135], v[148:151], v[172:175]
  ds_write_b128 v28, v[228:231] offset:5120
  v_mfma_f32_16x16x32_bf16 v[176:179], a[132:135], v[152:155], v[176:179]
L_ws63:
  s_cbranch_execz L_wa_back
  ds_write_b128 v28, v[232:235] offset:6144
  v_mfma_f32_16x16x32_bf16 v[180:183], a[132:135], v[156:159], v[180:183]
  ds_write_b128 v28, v[236:239] offset:7168
  v_mfma_f32_16x16x32_bf16 v[184:187], a[136:139], v[148:151], v[184:187]
  ds_write_b128 v28, v[240:243] offset:8192
  v_mfma_f32_16x16x32_bf16 v[188:191], a[136:139], v[152:155], v[188:191]
  ds_write_b128 v28, v[244:247] offset:9216
  v_mfma_f32_16x16x32_bf16 v[192:195], a[136:139], v[156:159], v[192:195]
  buffer_load_dwordx4 v25, s[48:51], s37 offen offset:3072 lds
  ds_write_b128 v28, v[248:251] offset:10240
  v_mfma_f32_16x16x32_bf16 v[196:199], a[140:143], v[148:151], v[196:199]
  ds_write_b128 v28, v[252:255] offset:11264
  v_mfma_f32_16x16x32_bf16 v[200:203], a[140:143], v[152:155], v[200:203]
  v_mfma_f32_16x16x32_bf16 v[204:207], a[140:143], v[156:159], v[204:207]
  v_pk_mul_f32 v[160:161], v[160:161], v[38:39] op_sel_hi:[1,0]
  v_pk_mul_f32 v[162:163], v[162:163], v[38:39] op_sel_hi:[1,0]
  v_pk_mul_f32 v[164:165], v[164:165], v[40:41] op_sel_hi:[1,0]
  v_pk_mul_f32 v[166:167], v[166:167], v[40:41] op_sel_hi:[1,0]
  v_pk_mul_f32 v[168:169], v[168:169], v[42:43] op_sel_hi:[1,0]
  v_pk_mul_f32 v[170:171], v[170:171], v[42:43] op_sel_hi:[1,0]
  v_pk_mul_f32 v[172:173], v[172:173], v[38:39] op_sel_hi:[1,0]
  v_pk_mul_f32 v[174:175], v[174:175], v[38:39] op_sel_hi:[1,0]
  v_pk_mul_f32 v[176:177], v[176:177], v[40:41] op_sel_hi:[1,0]
  v_pk_mul_f32 v[178:179], v[178:179], v[40:41] op_sel_hi:[1,0]
  v_pk_mul_f32 v[180:181], v[180:181], v[42:43] op_sel_hi:[1,0]
  v_pk_mul_f32 v[182:183], v[182:183], v[42:43] op_sel_hi:[1,0]
  v_pk_mul_f32 v[184:185], v[184:185], v[38:39] op_sel_hi:[1,0]
  v_pk_mul_f32 v[186:187], v[186:187], v[38:39] op_sel_hi:[1,0]
  v_pk_mul_f32 v[188:189], v[188:189], v[40:41] op_sel_hi:[1,0]
  v_pk_mul_f32 v[190:191], v[190:191], v[40:41] op_sel_hi:[1,0]
  v_pk_mul_f32 v[192:193], v[192:193], v[42:43] op_sel_hi:[1,0]
L_ws64:
  s_cbranch_execz L_wa_back
  v_pk_mul_f32 v[194:195], v[194:195], v[42:43] op_sel_hi:[1,0]
  v_pk_mul_f32 v[196:197], v[196:197], v[38:39] op_sel_hi:[1,0]
  v_pk_mul_f32 v[198:199], v[198:199], v[38:39] op_sel_hi:[1,0]
  v_pk_mul_f32 v[200:201], v[200:201], v[40:41] op_sel_hi:[1,0]
  v_pk_mul_f32 v[202:203], v[202:203], v[40:41] op_sel_hi:[1,0]
  v_pk_mul_f32 v[204:205], v[204:205], v[42:43] op_sel_hi:[1,0]
  v_pk_mul_f32 v[206:207], v[206:207], v[42:43] op_sel_hi:[1,0]
  s_and_b32 s3, s45, 1
  s_mul_i32 s3, s3, 24576
  s_mul_i32 s4, s29, 12288
  s_add_u32 s4, s4, 114688
  s_add_u32 s5, s4, s3
  s_sub_u32 s4, s4, s3
  s_add_u32 s4, s4, 24576
  v_add_u32 v56, s4, v27
  v_add_u32 v57, s5, v27
  s_add_u32 m0, m0, 4096
  s_nop 0
  buffer_load_dwordx4 v26, s[48:51], s37 offen offset:0 lds
  s_waitcnt vmcnt(13) lgkmcnt(0)
  s_barrier
  ds_read_b128 v[64:67], v29 offset:0
  ds_read_b128 v[68:71], v29 offset:1024
  ds_read_b128 v[72:75], v29 offset:2048
  ds_read_b128 v[76:79], v29 offset:3072
  ds_read_b128 v[80:83], v29 offset:4096
  ds_read_b128 v[84:87], v29 offset:5120
  ds_read_b128 v[88:91], v29 offset:6144
  ds_read_b128 v[92:95], v29 offset:7168
  ds_read_b128 v[96:99], v29 offset:8192
  ds_read_b128 v[100:103], v29 offset:9216
  ds_read_b128 v[104:107], v29 offset:10240
  ds_read_b128 v[108:111], v29 offset:11264
  v_add_u32 v13, 0xffff0000, v13
  v_add_u32 v14, 0xffff0000, v14
  v_add_u32 v15, 0xffff0000, v15
L_ws65:
  s_cbranch_execz L_wa_back
  v_add_u32 v16, 0xffff0000, v16
  ds_read_b128 a[96:99], v13 offset:0
  ds_read_b128 a[100:103], v14 offset:0
  ds_read_b128 a[104:107], v15 offset:0
  ds_read_b128 a[108:111], v16 offset:0
  ds_read_b128 a[112:115], v13 offset:4096
  ds_read_b128 a[116:119], v14 offset:4096
  ds_read_b128 a[120:123], v15 offset:4096
  ds_read_b128 a[124:127], v16 offset:4096
  s_waitcnt lgkmcnt(15)
  v_pk_fma_f32 v[160:161], v[64:65], v[38:39], v[160:161] op_sel:[0,1,0] op_sel_hi:[1,1,1]
  v_pk_fma_f32 v[162:163], v[66:67], v[38:39], v[162:163] op_sel:[0,1,0] op_sel_hi:[1,1,1]
  v_pk_fma_f32 v[172:173], v[76:77], v[38:39], v[172:173] op_sel:[0,1,0] op_sel_hi:[1,1,1]
  v_pk_fma_f32 v[174:175], v[78:79], v[38:39], v[174:175] op_sel:[0,1,0] op_sel_hi:[1,1,1]
  v_cvt_pk_bf16_f32 v112, v160, v161
  v_cvt_pk_bf16_f32 v113, v162, v163
  v_cvt_pk_bf16_f32 v114, v172, v173
  v_cvt_pk_bf16_f32 v115, v174, v175
  buffer_store_dwordx4 v[112:115], v27, s[24:27], s40 offen offset:0 sc1
  ds_write_b128 v29, v[112:115] offset:0
  s_add_u32 m0, s38, 49152
  s_add_u32 s37, s36, 180224
  buffer_load_dwordx4 v4, s[16:19], s37 offen offset:0 nt lds
  s_waitcnt lgkmcnt(15)
  v_pk_fma_f32 v[164:165], v[68:69], v[40:41], v[164:165] op_sel:[0,1,0] op_sel_hi:[1,1,1]
  v_pk_fma_f32 v[166:167], v[70:71], v[40:41], v[166:167] op_sel:[0,1,0] op_sel_hi:[1,1,1]
  v_pk_fma_f32 v[176:177], v[80:81], v[40:41], v[176:177] op_sel:[0,1,0] op_sel_hi:[1,1,1]
  v_pk_fma_f32 v[178:179], v[82:83], v[40:41], v[178:179] op_sel:[0,1,0] op_sel_hi:[1,1,1]
  v_cvt_pk_bf16_f32 v116, v164, v165
  v_cvt_pk_bf16_f32 v117, v166, v167
  v_cvt_pk_bf16_f32 v118, v176, v177
  v_cvt_pk_bf16_f32 v119, v178, v179
L_ws66:
  s_cbranch_execz L_wa_back
  buffer_store_dwordx4 v[116:119], v27, s[24:27], s40 offen offset:1024 sc1
  ds_write_b128 v29, v[116:119] offset:1024
  buffer_load_dwordx4 v5, s[16:19], s37 offen offset:1024 nt lds
  s_waitcnt lgkmcnt(15)
  v_pk_fma_f32 v[168:169], v[72:73], v[42:43], v[168:169] op_sel:[0,1,0] op_sel_hi:[1,1,1]
  v_pk_fma_f32 v[170:171], v[74:75], v[42:43], v[170:171] op_sel:[0,1,0] op_sel_hi:[1,1,1]
  v_pk_fma_f32 v[180:181], v[84:85], v[42:43], v[180:181] op_sel:[0,1,0] op_sel_hi:[1,1,1]
  v_pk_fma_f32 v[182:183], v[86:87], v[42:43], v[182:183] op_sel:[0,1,0] op_sel_hi:[1,1,1]
  v_cvt_pk_bf16_f32 v120, v168, v169
  v_cvt_pk_bf16_f32 v121, v170, v171
  v_cvt_pk_bf16_f32 v122, v180, v181
  v_cvt_pk_bf16_f32 v123, v182, v183
  buffer_store_dwordx4 v[120:123], v27, s[24:27], s40 offen offset:2048 sc1
  ds_write_b128 v29, v[120:123] offset:2048
  buffer_load_dwordx4 v4, s[16:19], s37 offen offset:2048 nt lds
  s_waitcnt lgkmcnt(13)
  v_pk_fma_f32 v[184:185], v[88:89], v[38:39], v[184:185] op_sel:[0,1,0] op_sel_hi:[1,1,1]
  v_pk_fma_f32 v[186:187], v[90:91], v[38:39], v[186:187] op_sel:[0,1,0] op_sel_hi:[1,1,1]
  v_pk_fma_f32 v[196:197], v[100:101], v[38:39], v[196:197] op_sel:[0,1,0] op_sel_hi:[1,1,1]
  v_pk_fma_f32 v[198:199], v[102:103], v[38:39], v[198:199] op_sel:[0,1,0] op_sel_hi:[1,1,1]
  v_cvt_pk_bf16_f32 v124, v184, v185
  v_cvt_pk_bf16_f32 v125, v186, v187
  v_cvt_pk_bf16_f32 v126, v196, v197
  v_cvt_pk_bf16_f32 v127, v198, v199
  buffer_store_dwordx4 v[124:127], v27, s[24:27], s41 offen offset:0 sc1
  ds_write_b128 v29, v[124:127] offset:6144
  buffer_load_dwordx4 v5, s[16:19], s37 offen offset:3072 nt lds
  s_waitcnt lgkmcnt(13)
  v_pk_fma_f32 v[188:189], v[92:93], v[40:41], v[188:189] op_sel:[0,1,0] op_sel_hi:[1,1,1]
  v_pk_fma_f32 v[190:191], v[94:95], v[40:41], v[190:191] op_sel:[0,1,0] op_sel_hi:[1,1,1]
  v_pk_fma_f32 v[200:201], v[104:105], v[40:41], v[200:201] op_sel:[0,1,0] op_sel_hi:[1,1,1]
  v_pk_fma_f32 v[202:203], v[106:107], v[40:41], v[202:203] op_sel:[0,1,0] op_sel_hi:[1,1,1]
  v_cvt_pk_bf16_f32 v128, v188, v189
L_ws67:
  s_cbranch_execz L_wa_back
  v_cvt_pk_bf16_f32 v129, v190, v191
  v_cvt_pk_bf16_f32 v130, v200, v201
  v_cvt_pk_bf16_f32 v131, v202, v203
  buffer_store_dwordx4 v[128:131], v27, s[24:27], s41 offen offset:1024 sc1
  ds_write_b128 v29, v[128:131] offset:7168
  s_add_u32 m0, s35, 73728
  s_bfe_u32 s37, s45, 0x20005
  s_mul_i32 s37, s37, 327680
  s_bfe_u32 s47, s45, 0x10004
  s_mul_i32 s47, s47, 81920
  s_add_u32 s37, s37, s47
  s_add_u32 s37, s37, s34
  buffer_load_dwordx4 v10, s[48:51], s37 offen offset:0 lds
  s_waitcnt lgkmcnt(13)
  v_pk_fma_f32 v[192:193], v[96:97], v[42:43], v[192:193] op_sel:[0,1,0] op_sel_hi:[1,1,1]
  v_pk_fma_f32 v[194:195], v[98:99], v[42:43], v[194:195] op_sel:[0,1,0] op_sel_hi:[1,1,1]
  v_pk_fma_f32 v[204:205], v[108:109], v[42:43], v[204:205] op_sel:[0,1,0] op_sel_hi:[1,1,1]
  v_pk_fma_f32 v[206:207], v[110:111], v[42:43], v[206:207] op_sel:[0,1,0] op_sel_hi:[1,1,1]
  v_cvt_pk_bf16_f32 v132, v192, v193
  v_cvt_pk_bf16_f32 v133, v194, v195
  v_cvt_pk_bf16_f32 v134, v204, v205
  v_cvt_pk_bf16_f32 v135, v206, v207
  buffer_store_dwordx4 v[132:135], v27, s[24:27], s41 offen offset:2048 sc1
  ds_write_b128 v29, v[132:135] offset:8192
  buffer_load_dwordx4 v11, s[48:51], s37 offen offset:1024 lds
  s_add_u32 s40, s40, 98304
  s_add_u32 s41, s41, 98304
  s_waitcnt vmcnt(21) lgkmcnt(0)
  s_barrier
  v_mfma_f32_16x16x32_bf16 v[64:67], a[96:99], a[48:51], 0
  ds_read_b128 a[128:131], v13 offset:16384
  v_mfma_f32_16x16x32_bf16 v[72:75], a[96:99], a[52:55], 0
  ds_read_b128 a[132:135], v14 offset:16384
  buffer_load_dwordx4 v12, s[48:51], s37 offen offset:2048 lds
L_ws68:
  s_cbranch_execz L_wa_back
  v_mfma_f32_16x16x32_bf16 v[80:83], a[96:99], a[56:59], 0
  ds_read_b128 a[136:139], v15 offset:16384
  v_mfma_f32_16x16x32_bf16 v[64:67], a[100:103], a[60:63], v[64:67]
  ds_read_b128 a[140:143], v16 offset:16384
  buffer_load_dwordx4 v25, s[48:51], s37 offen offset:3072 lds
  v_mfma_f32_16x16x32_bf16 v[72:75], a[100:103], a[64:67], v[72:75]
  ds_read_b128 a[144:147], v13 offset:20480
  v_mfma_f32_16x16x32_bf16 v[80:83], a[100:103], a[68:71], v[80:83]
  ds_read_b128 a[148:151], v14 offset:20480
  v_mfma_f32_16x16x32_bf16 v[64:67], a[104:107], a[72:75], v[64:67]
  ds_read_b128 a[152:155], v15 offset:20480
  v_mfma_f32_16x16x32_bf16 v[72:75], a[104:107], a[76:79], v[72:75]
  ds_read_b128 a[156:159], v16 offset:20480
  v_mfma_f32_16x16x32_bf16 v[80:83], a[104:107], a[80:83], v[80:83]
  v_mfma_f32_16x16x32_bf16 v[64:67], a[108:111], a[84:87], v[64:67]
  v_mfma_f32_16x16x32_bf16 v[72:75], a[108:111], a[88:91], v[72:75]
  v_mfma_f32_16x16x32_bf16 v[80:83], a[108:111], a[92:95], v[80:83]
  v_mfma_f32_16x16x32_bf16 v[68:71], a[112:115], a[48:51], 0
  v_mfma_f32_16x16x32_bf16 v[76:79], a[112:115], a[52:55], 0
  v_mfma_f32_16x16x32_bf16 v[84:87], a[112:115], a[56:59], 0
  v_mfma_f32_16x16x32_bf16 v[68:71], a[116:119], a[60:63], v[68:71]
  v_mfma_f32_16x16x32_bf16 v[76:79], a[116:119], a[64:67], v[76:79]
  v_add_u32 v28, 0x0, v28
  v_mfma_f32_16x16x32_bf16 v[84:87], a[116:119], a[68:71], v[84:87]
  v_add_u32 v29, 0x0, v29
  v_mfma_f32_16x16x32_bf16 v[68:71], a[120:123], a[72:75], v[68:71]
  v_add_u32 v30, 0x0, v30
  v_mfma_f32_16x16x32_bf16 v[76:79], a[120:123], a[76:79], v[76:79]
  v_mfma_f32_16x16x32_bf16 v[84:87], a[120:123], a[80:83], v[84:87]
  v_mfma_f32_16x16x32_bf16 v[68:71], a[124:127], a[84:87], v[68:71]
  v_mfma_f32_16x16x32_bf16 v[76:79], a[124:127], a[88:91], v[76:79]
  v_mfma_f32_16x16x32_bf16 v[84:87], a[124:127], a[92:95], v[84:87]
  s_waitcnt vmcnt(14) lgkmcnt(0)
  s_barrier
L_ws69:
  s_cbranch_execz L_wa_back
  v_mfma_f32_16x16x32_bf16 v[88:91], a[128:131], a[48:51], 0
  ds_read_b128 a[212:215], v56 offset:0
  ds_read_b128 a[216:219], v56 offset:1024
  v_mfma_f32_16x16x32_bf16 v[96:99], a[128:131], a[52:55], 0
  ds_read_b128 a[220:223], v56 offset:2048
  v_mfma_f32_16x16x32_bf16 v[104:107], a[128:131], a[56:59], 0
  ds_read_b64_tr_b16 a[172:173], v6 offset:20480
  v_mfma_f32_16x16x32_bf16 v[88:91], a[132:135], a[60:63], v[88:91]
  ds_read_b64_tr_b16 a[174:175], v6 offset:25600
  ds_read_b64_tr_b16 a[176:177], v7 offset:20512
  v_mfma_f32_16x16x32_bf16 v[96:99], a[132:135], a[64:67], v[96:99]
  ds_read_b64_tr_b16 a[178:179], v7 offset:25632
  v_mfma_f32_16x16x32_bf16 v[104:107], a[132:135], a[68:71], v[104:107]
  ds_read_b64_tr_b16 a[180:181], v6 offset:20544
  v_mfma_f32_16x16x32_bf16 v[88:91], a[136:139], a[72:75], v[88:91]
  ds_read_b64_tr_b16 a[182:183], v6 offset:25664
  ds_read_b64_tr_b16 a[184:185], v7 offset:20576
  v_mfma_f32_16x16x32_bf16 v[96:99], a[136:139], a[76:79], v[96:99]
  ds_read_b64_tr_b16 a[186:187], v7 offset:25696
  v_mfma_f32_16x16x32_bf16 v[104:107], a[136:139], a[80:83], v[104:107]
  ds_read_b64_tr_b16 a[188:189], v6 offset:20608
  v_max3_f32 v32, v64, v65, v66
  v_mfma_f32_16x16x32_bf16 v[88:91], a[140:143], a[84:87], v[88:91]
  ds_read_b64_tr_b16 a[190:191], v6 offset:25728
  v_max_f32 v32, v32, v67
  v_mfma_f32_16x16x32_bf16 v[96:99], a[140:143], a[88:91], v[96:99]
  ds_read_b128 a[224:227], v56 offset:6144
  ds_read_b128 a[228:231], v56 offset:7168
  v_max3_f32 v33, v72, v73, v74
  v_mfma_f32_16x16x32_bf16 v[104:107], a[140:143], a[92:95], v[104:107]
  ds_read_b128 a[232:235], v56 offset:8192
  v_max_f32 v33, v33, v75
  v_mfma_f32_16x16x32_bf16 v[92:95], a[144:147], a[48:51], 0
L_ws70:
  s_cbranch_execz L_wa_back
  ds_read_b64_tr_b16 a[192:193], v6 offset:30720
  v_max3_f32 v34, v80, v81, v82
  v_mfma_f32_16x16x32_bf16 v[100:103], a[144:147], a[52:55], 0
  ds_read_b64_tr_b16 a[194:195], v6 offset:35840
  ds_read_b64_tr_b16 a[196:197], v7 offset:30752
  s_add_u32 m0, m0, 4096
  s_nop 0
  buffer_load_dwordx4 v26, s[48:51], s37 offen offset:0 lds
  v_max_f32 v34, v34, v83
  v_mfma_f32_16x16x32_bf16 v[108:111], a[144:147], a[56:59], 0
  ds_read_b64_tr_b16 a[198:199], v7 offset:35872
  v_max3_f32 v32, v32, v68, v69
  v_mfma_f32_16x16x32_bf16 v[92:95], a[148:151], a[60:63], v[92:95]
  ds_read_b64_tr_b16 a[200:201], v6 offset:30784
  v_max3_f32 v33, v33, v76, v77
  v_mfma_f32_16x16x32_bf16 v[100:103], a[148:151], a[64:67], v[100:103]
  ds_read_b64_tr_b16 a[202:203], v6 offset:35904
  ds_read_b64_tr_b16 a[204:205], v7 offset:30816
  v_max3_f32 v34, v34, v84, v85
  v_mfma_f32_16x16x32_bf16 v[108:111], a[148:151], a[68:71], v[108:111]
  ds_read_b64_tr_b16 a[206:207], v7 offset:35936
  v_max3_f32 v32, v32, v70, v71
  v_mfma_f32_16x16x32_bf16 v[92:95], a[152:155], a[72:75], v[92:95]
  ds_read_b64_tr_b16 a[208:209], v6 offset:30848
  v_max3_f32 v33, v33, v78, v79
  v_mfma_f32_16x16x32_bf16 v[100:103], a[152:155], a[76:79], v[100:103]
  ds_read_b64_tr_b16 a[210:211], v6 offset:35968
  v_max3_f32 v34, v34, v86, v87
  v_mfma_f32_16x16x32_bf16 v[108:111], a[152:155], a[80:83], v[108:111]
  v_mfma_f32_16x16x32_bf16 v[92:95], a[156:159], a[84:87], v[92:95]
  v_mfma_f32_16x16x32_bf16 v[100:103], a[156:159], a[88:91], v[100:103]
  v_mfma_f32_16x16x32_bf16 v[108:111], a[156:159], a[92:95], v[108:111]
L_ws71:
  s_cbranch_execz L_wa_back
  s_waitcnt lgkmcnt(0)
  s_barrier
  v_mfma_f32_16x16x32_bf16 a[0:3], a[172:175], a[212:215], 0
  ds_read_b128 a[96:99], v13 offset:32768
  s_add_u32 m0, s38, 0
  s_add_u32 s37, s36, 196608
  buffer_load_dwordx4 v4, s[16:19], s37 offen offset:0 nt lds
  v_mfma_f32_16x16x32_bf16 a[4:7], a[172:175], a[216:219], 0
  ds_read_b128 a[100:103], v14 offset:32768
  v_mfma_f32_16x16x32_bf16 a[8:11], a[172:175], a[220:223], 0
  ds_read_b128 a[104:107], v15 offset:32768
  v_mfma_f32_16x16x32_bf16 a[12:15], a[176:179], a[212:215], 0
  ds_read_b128 a[108:111], v16 offset:32768
  v_mfma_f32_16x16x32_bf16 a[16:19], a[176:179], a[216:219], 0
  ds_read_b128 a[112:115], v13 offset:36864
  v_mfma_f32_16x16x32_bf16 a[20:23], a[176:179], a[220:223], 0
  ds_read_b128 a[116:119], v14 offset:36864
  v_mfma_f32_16x16x32_bf16 a[24:27], a[180:183], a[212:215], 0
  ds_read_b128 a[120:123], v15 offset:36864
  v_mfma_f32_16x16x32_bf16 a[28:31], a[180:183], a[216:219], 0
  ds_read_b128 a[124:127], v16 offset:36864
  v_mfma_f32_16x16x32_bf16 a[32:35], a[180:183], a[220:223], 0
  v_mfma_f32_16x16x32_bf16 a[36:39], a[184:187], a[212:215], 0
  v_mfma_f32_16x16x32_bf16 a[40:43], a[184:187], a[216:219], 0
  v_mfma_f32_16x16x32_bf16 a[44:47], a[184:187], a[220:223], 0
  v_mfma_f32_16x16x32_bf16 a[160:163], a[188:191], a[212:215], 0
  v_mfma_f32_16x16x32_bf16 a[164:167], a[188:191], a[216:219], 0
  buffer_load_dwordx4 v5, s[16:19], s37 offen offset:1024 nt lds
  v_mfma_f32_16x16x32_bf16 a[168:171], a[188:191], a[220:223], 0
  v_mfma_f32_16x16x32_bf16 a[0:3], a[192:195], a[224:227], a[0:3]
  v_mfma_f32_16x16x32_bf16 a[4:7], a[192:195], a[228:231], a[4:7]
  v_mfma_f32_16x16x32_bf16 a[8:11], a[192:195], a[232:235], a[8:11]
  v_mfma_f32_16x16x32_bf16 a[12:15], a[196:199], a[224:227], a[12:15]
L_ws72:
  s_cbranch_execz L_wa_back
  v_mfma_f32_16x16x32_bf16 a[16:19], a[196:199], a[228:231], a[16:19]
  v_mfma_f32_16x16x32_bf16 a[20:23], a[196:199], a[232:235], a[20:23]
  v_mfma_f32_16x16x32_bf16 a[24:27], a[200:203], a[224:227], a[24:27]
  v_mfma_f32_16x16x32_bf16 a[28:31], a[200:203], a[228:231], a[28:31]
  v_mfma_f32_16x16x32_bf16 a[32:35], a[200:203], a[232:235], a[32:35]
  v_mfma_f32_16x16x32_bf16 a[36:39], a[204:207], a[224:227], a[36:39]
  v_mfma_f32_16x16x32_bf16 a[40:43], a[204:207], a[228:231], a[40:43]
  v_mfma_f32_16x16x32_bf16 a[44:47], a[204:207], a[232:235], a[44:47]
  v_mfma_f32_16x16x32_bf16 a[160:163], a[208:211], a[224:227], a[160:163]
  buffer_load_dwordx4 v4, s[16:19], s37 offen offset:2048 nt lds
  v_mfma_f32_16x16x32_bf16 a[164:167], a[208:211], a[228:231], a[164:167]
  v_mfma_f32_16x16x32_bf16 a[168:171], a[208:211], a[232:235], a[168:171]
  s_waitcnt vmcnt(10) lgkmcnt(0)
  s_barrier
  v_mfma_f32_16x16x32_bf16 v[112:115], a[96:99], a[48:51], 0
  ds_read_b128 a[128:131], v13 offset:49152
  buffer_load_dwordx4 v5, s[16:19], s37 offen offset:3072 nt lds
  v_mfma_f32_16x16x32_bf16 v[120:123], a[96:99], a[52:55], 0
  ds_read_b128 a[132:135], v14 offset:49152
  v_mfma_f32_16x16x32_bf16 v[128:131], a[96:99], a[56:59], 0
  ds_read_b128 a[136:139], v15 offset:49152
  s_add_u32 m0, s38, 16384
  s_add_u32 s37, s36, 212992
  buffer_load_dwordx4 v4, s[16:19], s37 offen offset:0 nt lds
  v_mfma_f32_16x16x32_bf16 v[112:115], a[100:103], a[60:63], v[112:115]
  ds_read_b128 a[140:143], v16 offset:49152
  v_mfma_f32_16x16x32_bf16 v[120:123], a[100:103], a[64:67], v[120:123]
  ds_read_b128 a[144:147], v13 offset:53248
  buffer_load_dwordx4 v5, s[16:19], s37 offen offset:1024 nt lds
  v_mfma_f32_16x16x32_bf16 v[128:131], a[100:103], a[68:71], v[128:131]
  ds_read_b128 a[148:151], v14 offset:53248
  v_mfma_f32_16x16x32_bf16 v[112:115], a[104:107], a[72:75], v[112:115]
  ds_read_b128 a[152:155], v15 offset:53248
L_ws73:
  s_cbranch_execz L_wa_back
  v_mfma_f32_16x16x32_bf16 v[120:123], a[104:107], a[76:79], v[120:123]
  ds_read_b128 a[156:159], v16 offset:53248
  v_mfma_f32_16x16x32_bf16 v[128:131], a[104:107], a[80:83], v[128:131]
  buffer_load_dwordx4 v4, s[16:19], s37 offen offset:2048 nt lds
  v_max3_f32 v32, v32, v88, v89
  v_mfma_f32_16x16x32_bf16 v[112:115], a[108:111], a[84:87], v[112:115]
  v_max3_f32 v33, v33, v96, v97
  v_mfma_f32_16x16x32_bf16 v[120:123], a[108:111], a[88:91], v[120:123]
  v_max3_f32 v34, v34, v104, v105
  v_mfma_f32_16x16x32_bf16 v[128:131], a[108:111], a[92:95], v[128:131]
  v_max3_f32 v32, v32, v90, v91
  v_mfma_f32_16x16x32_bf16 v[116:119], a[112:115], a[48:51], 0
  buffer_load_dwordx4 v5, s[16:19], s37 offen offset:3072 nt lds
  v_max3_f32 v33, v33, v98, v99
  v_mfma_f32_16x16x32_bf16 v[124:127], a[112:115], a[52:55], 0
  v_max3_f32 v34, v34, v106, v107
  v_mfma_f32_16x16x32_bf16 v[132:135], a[112:115], a[56:59], 0
  v_max3_f32 v32, v32, v92, v93
  v_mfma_f32_16x16x32_bf16 v[116:119], a[116:119], a[60:63], v[116:119]
  v_max3_f32 v33, v33, v100, v101
  v_mfma_f32_16x16x32_bf16 v[124:127], a[116:119], a[64:67], v[124:127]
  v_max3_f32 v34, v34, v108, v109
  v_mfma_f32_16x16x32_bf16 v[132:135], a[116:119], a[68:71], v[132:135]
  v_max3_f32 v32, v32, v94, v95
  v_mfma_f32_16x16x32_bf16 v[116:119], a[120:123], a[72:75], v[116:119]
  v_max3_f32 v33, v33, v102, v103
  v_mfma_f32_16x16x32_bf16 v[124:127], a[120:123], a[76:79], v[124:127]
  v_max3_f32 v34, v34, v110, v111
  v_mfma_f32_16x16x32_bf16 v[132:135], a[120:123], a[80:83], v[132:135]
  v_mfma_f32_16x16x32_bf16 v[116:119], a[124:127], a[84:87], v[116:119]
  v_mfma_f32_16x16x32_bf16 v[124:127], a[124:127], a[88:91], v[124:127]
L_ws74:
  s_cbranch_execz L_wa_back
  v_mfma_f32_16x16x32_bf16 v[132:135], a[124:127], a[92:95], v[132:135]
  s_waitcnt vmcnt(8) lgkmcnt(0)
  s_barrier
  v_mfma_f32_16x16x32_bf16 v[136:139], a[128:131], a[48:51], 0
  ds_read_b128 a[212:215], v57 offset:0
  ds_read_b128 a[216:219], v57 offset:1024
  v_mfma_f32_16x16x32_bf16 v[144:147], a[128:131], a[52:55], 0
  ds_read_b128 a[220:223], v57 offset:2048
  v_mfma_f32_16x16x32_bf16 v[152:155], a[128:131], a[56:59], 0
  ds_read_b64_tr_b16 a[172:173], v6 offset:0
  v_mfma_f32_16x16x32_bf16 v[136:139], a[132:135], a[60:63], v[136:139]
  ds_read_b64_tr_b16 a[174:175], v6 offset:5120
  ds_read_b64_tr_b16 a[176:177], v7 offset:32
  v_mfma_f32_16x16x32_bf16 v[144:147], a[132:135], a[64:67], v[144:147]
  ds_read_b64_tr_b16 a[178:179], v7 offset:5152
  v_mfma_f32_16x16x32_bf16 v[152:155], a[132:135], a[68:71], v[152:155]
  ds_read_b64_tr_b16 a[180:181], v6 offset:64
  v_mfma_f32_16x16x32_bf16 v[136:139], a[136:139], a[72:75], v[136:139]
  ds_read_b64_tr_b16 a[182:183], v6 offset:5184
  ds_read_b64_tr_b16 a[184:185], v7 offset:96
  v_mfma_f32_16x16x32_bf16 v[144:147], a[136:139], a[76:79], v[144:147]
  ds_read_b64_tr_b16 a[186:187], v7 offset:5216
  v_mfma_f32_16x16x32_bf16 v[152:155], a[136:139], a[80:83], v[152:155]
  ds_read_b64_tr_b16 a[188:189], v6 offset:128
  v_max3_f32 v32, v32, v112, v113
  v_mfma_f32_16x16x32_bf16 v[136:139], a[140:143], a[84:87], v[136:139]
  ds_read_b64_tr_b16 a[190:191], v6 offset:5248
  v_max3_f32 v33, v33, v120, v121
  v_mfma_f32_16x16x32_bf16 v[144:147], a[140:143], a[88:91], v[144:147]
  ds_read_b128 a[224:227], v57 offset:6144
  ds_read_b128 a[228:231], v57 offset:7168
  v_max3_f32 v34, v34, v128, v129
  v_mfma_f32_16x16x32_bf16 v[152:155], a[140:143], a[92:95], v[152:155]
L_ws75:
  s_cbranch_execz L_wa_back
  ds_read_b128 a[232:235], v57 offset:8192
  v_max3_f32 v32, v32, v114, v115
  v_mfma_f32_16x16x32_bf16 v[140:143], a[144:147], a[48:51], 0
  ds_read_b64_tr_b16 a[192:193], v6 offset:10240
  v_max3_f32 v33, v33, v122, v123
  v_mfma_f32_16x16x32_bf16 v[148:151], a[144:147], a[52:55], 0
  ds_read_b64_tr_b16 a[194:195], v6 offset:15360
  ds_read_b64_tr_b16 a[196:197], v7 offset:10272
  v_max3_f32 v34, v34, v130, v131
  v_mfma_f32_16x16x32_bf16 v[156:159], a[144:147], a[56:59], 0
  ds_read_b64_tr_b16 a[198:199], v7 offset:15392
  v_max3_f32 v32, v32, v116, v117
  v_mfma_f32_16x16x32_bf16 v[140:143], a[148:151], a[60:63], v[140:143]
  ds_read_b64_tr_b16 a[200:201], v6 offset:10304
  v_max3_f32 v33, v33, v124, v125
  v_mfma_f32_16x16x32_bf16 v[148:151], a[148:151], a[64:67], v[148:151]
  ds_read_b64_tr_b16 a[202:203], v6 offset:15424
  ds_read_b64_tr_b16 a[204:205], v7 offset:10336
  v_max3_f32 v34, v34, v132, v133
  v_mfma_f32_16x16x32_bf16 v[156:159], a[148:151], a[68:71], v[156:159]
  ds_read_b64_tr_b16 a[206:207], v7 offset:15456
  v_max3_f32 v32, v32, v118, v119
  v_mfma_f32_16x16x32_bf16 v[140:143], a[152:155], a[72:75], v[140:143]
  ds_read_b64_tr_b16 a[208:209], v6 offset:10368
  v_max3_f32 v33, v33, v126, v127
  v_mfma_f32_16x16x32_bf16 v[148:151], a[152:155], a[76:79], v[148:151]
  ds_read_b64_tr_b16 a[210:211], v6 offset:15488
  v_max3_f32 v34, v34, v134, v135
  v_mfma_f32_16x16x32_bf16 v[156:159], a[152:155], a[80:83], v[156:159]
  v_mfma_f32_16x16x32_bf16 v[140:143], a[156:159], a[84:87], v[140:143]
  v_mfma_f32_16x16x32_bf16 v[148:151], a[156:159], a[88:91], v[148:151]
L_ws76:
  s_cbranch_execz L_wa_back
  v_mfma_f32_16x16x32_bf16 v[156:159], a[156:159], a[92:95], v[156:159]
  s_add_u32 m0, s38, 32768
  s_add_u32 s37, s36, 229376
  buffer_load_dwordx4 v4, s[16:19], s37 offen offset:0 nt lds
  buffer_load_dwordx4 v5, s[16:19], s37 offen offset:1024 nt lds
  buffer_load_dwordx4 v4, s[16:19], s37 offen offset:2048 nt lds
  buffer_load_dwordx4 v5, s[16:19], s37 offen offset:3072 nt lds
  s_waitcnt vmcnt(8) lgkmcnt(0)
  s_barrier
  v_mfma_f32_16x16x32_bf16 a[0:3], a[172:175], a[212:215], a[0:3]
  ds_read_b128 a[96:99], v13 offset:0
  v_mfma_f32_16x16x32_bf16 a[4:7], a[172:175], a[216:219], a[4:7]
  ds_read_b128 a[100:103], v14 offset:0
  v_mfma_f32_16x16x32_bf16 a[8:11], a[172:175], a[220:223], a[8:11]
  ds_read_b128 a[104:107], v15 offset:0
  v_mfma_f32_16x16x32_bf16 a[12:15], a[176:179], a[212:215], a[12:15]
  ds_read_b128 a[108:111], v16 offset:0
  v_mfma_f32_16x16x32_bf16 a[16:19], a[176:179], a[216:219], a[16:19]
  ds_read_b128 a[112:115], v13 offset:4096
  v_mfma_f32_16x16x32_bf16 a[20:23], a[176:179], a[220:223], a[20:23]
  ds_read_b128 a[116:119], v14 offset:4096
  v_mfma_f32_16x16x32_bf16 a[24:27], a[180:183], a[212:215], a[24:27]
  ds_read_b128 a[120:123], v15 offset:4096
  v_mfma_f32_16x16x32_bf16 a[28:31], a[180:183], a[216:219], a[28:31]
  ds_read_b128 a[124:127], v16 offset:4096
  v_mfma_f32_16x16x32_bf16 a[32:35], a[180:183], a[220:223], a[32:35]
  v_mfma_f32_16x16x32_bf16 a[36:39], a[184:187], a[212:215], a[36:39]
  s_add_u32 m0, s38, 49152
  s_add_u32 s37, s36, 245760
  buffer_load_dwordx4 v4, s[16:19], s37 offen offset:0 nt lds
  v_mfma_f32_16x16x32_bf16 a[40:43], a[184:187], a[216:219], a[40:43]
  v_mfma_f32_16x16x32_bf16 a[44:47], a[184:187], a[220:223], a[44:47]
  v_mfma_f32_16x16x32_bf16 a[160:163], a[188:191], a[212:215], a[160:163]
L_ws77:
  s_cbranch_execz L_wa_back
  v_mfma_f32_16x16x32_bf16 a[164:167], a[188:191], a[216:219], a[164:167]
  v_mfma_f32_16x16x32_bf16 a[168:171], a[188:191], a[220:223], a[168:171]
  v_mfma_f32_16x16x32_bf16 a[0:3], a[192:195], a[224:227], a[0:3]
  v_mfma_f32_16x16x32_bf16 a[4:7], a[192:195], a[228:231], a[4:7]
  v_mfma_f32_16x16x32_bf16 a[8:11], a[192:195], a[232:235], a[8:11]
  v_mfma_f32_16x16x32_bf16 a[12:15], a[196:199], a[224:227], a[12:15]
  v_mfma_f32_16x16x32_bf16 a[16:19], a[196:199], a[228:231], a[16:19]
  v_mfma_f32_16x16x32_bf16 a[20:23], a[196:199], a[232:235], a[20:23]
  v_mfma_f32_16x16x32_bf16 a[24:27], a[200:203], a[224:227], a[24:27]
  v_mfma_f32_16x16x32_bf16 a[28:31], a[200:203], a[228:231], a[28:31]
  v_mfma_f32_16x16x32_bf16 a[32:35], a[200:203], a[232:235], a[32:35]
  buffer_load_dwordx4 v5, s[16:19], s37 offen offset:1024 nt lds
  v_mfma_f32_16x16x32_bf16 a[36:39], a[204:207], a[224:227], a[36:39]
  v_mfma_f32_16x16x32_bf16 a[40:43], a[204:207], a[228:231], a[40:43]
  v_mfma_f32_16x16x32_bf16 a[44:47], a[204:207], a[232:235], a[44:47]
  v_mfma_f32_16x16x32_bf16 a[160:163], a[208:211], a[224:227], a[160:163]
  v_mfma_f32_16x16x32_bf16 a[164:167], a[208:211], a[228:231], a[164:167]
  v_mfma_f32_16x16x32_bf16 a[168:171], a[208:211], a[232:235], a[168:171]
  buffer_load_dwordx4 v4, s[16:19], s37 offen offset:2048 nt lds
  buffer_load_dwordx4 v5, s[16:19], s37 offen offset:3072 nt lds
  s_waitcnt vmcnt(8) lgkmcnt(0)
  s_barrier
  v_mfma_f32_16x16x32_bf16 v[160:163], a[96:99], a[48:51], 0
  ds_read_b128 a[128:131], v13 offset:16384
  v_mfma_f32_16x16x32_bf16 v[168:171], a[96:99], a[52:55], 0
  ds_read_b128 a[132:135], v14 offset:16384
  v_mfma_f32_16x16x32_bf16 v[176:179], a[96:99], a[56:59], 0
  ds_read_b128 a[136:139], v15 offset:16384
  v_mfma_f32_16x16x32_bf16 v[160:163], a[100:103], a[60:63], v[160:163]
  ds_read_b128 a[140:143], v16 offset:16384
  v_mfma_f32_16x16x32_bf16 v[168:171], a[100:103], a[64:67], v[168:171]
  ds_read_b128 a[144:147], v13 offset:20480
L_ws78:
  s_cbranch_execz L_wa_back
  v_mfma_f32_16x16x32_bf16 v[176:179], a[100:103], a[68:71], v[176:179]
  ds_read_b128 a[148:151], v14 offset:20480
  v_mfma_f32_16x16x32_bf16 v[160:163], a[104:107], a[72:75], v[160:163]
  ds_read_b128 a[152:155], v15 offset:20480
  v_mfma_f32_16x16x32_bf16 v[168:171], a[104:107], a[76:79], v[168:171]
  ds_read_b128 a[156:159], v16 offset:20480
  v_mfma_f32_16x16x32_bf16 v[176:179], a[104:107], a[80:83], v[176:179]
  v_max3_f32 v32, v32, v136, v137
  v_mfma_f32_16x16x32_bf16 v[160:163], a[108:111], a[84:87], v[160:163]
  s_add_u32 m0, s38, 0
  s_add_u32 s37, s36, 131072
  buffer_load_dwordx4 v4, s[20:23], s37 offen offset:0 nt lds
  v_max3_f32 v33, v33, v144, v145
  v_mfma_f32_16x16x32_bf16 v[168:171], a[108:111], a[88:91], v[168:171]
  v_max3_f32 v34, v34, v152, v153
  v_mfma_f32_16x16x32_bf16 v[176:179], a[108:111], a[92:95], v[176:179]
  v_max3_f32 v32, v32, v138, v139
  v_mfma_f32_16x16x32_bf16 v[164:167], a[112:115], a[48:51], 0
  v_max3_f32 v33, v33, v146, v147
  v_mfma_f32_16x16x32_bf16 v[172:175], a[112:115], a[52:55], 0
  v_max3_f32 v34, v34, v154, v155
  v_mfma_f32_16x16x32_bf16 v[180:183], a[112:115], a[56:59], 0
  v_max3_f32 v32, v32, v140, v141
  v_mfma_f32_16x16x32_bf16 v[164:167], a[116:119], a[60:63], v[164:167]
  v_max3_f32 v33, v33, v148, v149
  v_mfma_f32_16x16x32_bf16 v[172:175], a[116:119], a[64:67], v[172:175]
  v_max3_f32 v34, v34, v156, v157
  v_mfma_f32_16x16x32_bf16 v[180:183], a[116:119], a[68:71], v[180:183]
  v_max3_f32 v32, v32, v142, v143
  v_mfma_f32_16x16x32_bf16 v[164:167], a[120:123], a[72:75], v[164:167]
  v_max3_f32 v33, v33, v150, v151
  v_mfma_f32_16x16x32_bf16 v[172:175], a[120:123], a[76:79], v[172:175]
L_ws79:
  s_cbranch_execz L_wa_back
  v_max3_f32 v34, v34, v158, v159
  v_mfma_f32_16x16x32_bf16 v[180:183], a[120:123], a[80:83], v[180:183]
  v_mfma_f32_16x16x32_bf16 v[164:167], a[124:127], a[84:87], v[164:167]
  v_mfma_f32_16x16x32_bf16 v[172:175], a[124:127], a[88:91], v[172:175]
  v_mfma_f32_16x16x32_bf16 v[180:183], a[124:127], a[92:95], v[180:183]
  buffer_load_dwordx4 v5, s[20:23], s37 offen offset:1024 nt lds
  buffer_load_dwordx4 v4, s[20:23], s37 offen offset:2048 nt lds
  buffer_load_dwordx4 v5, s[20:23], s37 offen offset:3072 nt lds
  s_waitcnt vmcnt(8) lgkmcnt(0)
  s_barrier
  v_mfma_f32_16x16x32_bf16 v[184:187], a[128:131], a[48:51], 0
  ds_read_b128 a[96:99], v13 offset:32768
  v_mfma_f32_16x16x32_bf16 v[192:195], a[128:131], a[52:55], 0
  ds_read_b128 a[100:103], v14 offset:32768
  v_mfma_f32_16x16x32_bf16 v[200:203], a[128:131], a[56:59], 0
  ds_read_b128 a[104:107], v15 offset:32768
  v_mfma_f32_16x16x32_bf16 v[184:187], a[132:135], a[60:63], v[184:187]
  ds_read_b128 a[108:111], v16 offset:32768
  v_mfma_f32_16x16x32_bf16 v[192:195], a[132:135], a[64:67], v[192:195]
  ds_read_b128 a[112:115], v13 offset:36864
  v_mfma_f32_16x16x32_bf16 v[200:203], a[132:135], a[68:71], v[200:203]
  ds_read_b128 a[116:119], v14 offset:36864
  v_mfma_f32_16x16x32_bf16 v[184:187], a[136:139], a[72:75], v[184:187]
  ds_read_b128 a[120:123], v15 offset:36864
  v_mfma_f32_16x16x32_bf16 v[192:195], a[136:139], a[76:79], v[192:195]
  ds_read_b128 a[124:127], v16 offset:36864
  v_mfma_f32_16x16x32_bf16 v[200:203], a[136:139], a[80:83], v[200:203]
  v_max3_f32 v32, v32, v160, v161
  v_mov_b32 v58, s60
  s_mov_b64 exec, 15
  s_cmp_eq_u32 s61, 0
  s_cbranch_scc1 L_fl0a
  buffer_store_dword v58, v59, s[24:27], s63 offen
  s_branch L_fl0b
L_fl0a:
  buffer_store_dword v58, v59, s[24:27], s63 offen sc1
L_fl0b:
L_ws80:
  s_cbranch_execz L_wa_back
  s_mov_b64 exec, -1
  s_add_u32 s63, s63, 2048
  v_mfma_f32_16x16x32_bf16 v[184:187], a[140:143], a[84:87], v[184:187]
  s_add_u32 m0, s38, 16384
  s_add_u32 s37, s36, 147456
  buffer_load_dwordx4 v4, s[20:23], s37 offen offset:0 nt lds
  v_max3_f32 v33, v33, v168, v169
  v_mfma_f32_16x16x32_bf16 v[192:195], a[140:143], a[88:91], v[192:195]
  v_max3_f32 v34, v34, v176, v177
  v_mfma_f32_16x16x32_bf16 v[200:203], a[140:143], a[92:95], v[200:203]
  v_max3_f32 v32, v32, v162, v163
  v_mfma_f32_16x16x32_bf16 v[188:191], a[144:147], a[48:51], 0
  v_max3_f32 v33, v33, v170, v171
  v_mfma_f32_16x16x32_bf16 v[196:199], a[144:147], a[52:55], 0
  v_max3_f32 v34, v34, v178, v179
  v_mfma_f32_16x16x32_bf16 v[204:207], a[144:147], a[56:59], 0
  v_max3_f32 v32, v32, v164, v165
  v_mfma_f32_16x16x32_bf16 v[188:191], a[148:151], a[60:63], v[188:191]
  v_max3_f32 v33, v33, v172, v173
  v_mfma_f32_16x16x32_bf16 v[196:199], a[148:151], a[64:67], v[196:199]
  v_max3_f32 v34, v34, v180, v181
  v_mfma_f32_16x16x32_bf16 v[204:207], a[148:151], a[68:71], v[204:207]
  v_max3_f32 v32, v32, v166, v167
  v_mfma_f32_16x16x32_bf16 v[188:191], a[152:155], a[72:75], v[188:191]
  v_max3_f32 v33, v33, v174, v175
  v_mfma_f32_16x16x32_bf16 v[196:199], a[152:155], a[76:79], v[196:199]
  v_max3_f32 v34, v34, v182, v183
  v_mfma_f32_16x16x32_bf16 v[204:207], a[152:155], a[80:83], v[204:207]
  v_mfma_f32_16x16x32_bf16 v[188:191], a[156:159], a[84:87], v[188:191]
  v_mfma_f32_16x16x32_bf16 v[196:199], a[156:159], a[88:91], v[196:199]
  v_mfma_f32_16x16x32_bf16 v[204:207], a[156:159], a[92:95], v[204:207]
  buffer_load_dwordx4 v5, s[20:23], s37 offen offset:1024 nt lds
L_ws81:
  s_cbranch_execz L_wa_back
  buffer_load_dwordx4 v4, s[20:23], s37 offen offset:2048 nt lds
  buffer_load_dwordx4 v5, s[20:23], s37 offen offset:3072 nt lds
  s_waitcnt vmcnt(9) lgkmcnt(0)
  s_barrier
  v_mfma_f32_16x16x32_bf16 v[208:211], a[96:99], a[48:51], 0
  ds_read_b128 a[128:131], v13 offset:49152
  v_mfma_f32_16x16x32_bf16 v[216:219], a[96:99], a[52:55], 0
  ds_read_b128 a[132:135], v14 offset:49152
  v_mfma_f32_16x16x32_bf16 v[224:227], a[96:99], a[56:59], 0
  ds_read_b128 a[136:139], v15 offset:49152
  v_mfma_f32_16x16x32_bf16 v[208:211], a[100:103], a[60:63], v[208:211]
  ds_read_b128 a[140:143], v16 offset:49152
  v_mfma_f32_16x16x32_bf16 v[216:219], a[100:103], a[64:67], v[216:219]
  ds_read_b128 a[144:147], v13 offset:53248
  v_mfma_f32_16x16x32_bf16 v[224:227], a[100:103], a[68:71], v[224:227]
  ds_read_b128 a[148:151], v14 offset:53248
  v_mfma_f32_16x16x32_bf16 v[208:211], a[104:107], a[72:75], v[208:211]
  ds_read_b128 a[152:155], v15 offset:53248
  v_mfma_f32_16x16x32_bf16 v[216:219], a[104:107], a[76:79], v[216:219]
  ds_read_b128 a[156:159], v16 offset:53248
  v_mfma_f32_16x16x32_bf16 v[224:227], a[104:107], a[80:83], v[224:227]
  v_max3_f32 v32, v32, v184, v185
  v_mfma_f32_16x16x32_bf16 v[208:211], a[108:111], a[84:87], v[208:211]
  s_add_u32 m0, s38, 32768
  s_add_u32 s37, s36, 163840
  buffer_load_dwordx4 v4, s[20:23], s37 offen offset:0 nt lds
  v_max3_f32 v33, v33, v192, v193
  v_mfma_f32_16x16x32_bf16 v[216:219], a[108:111], a[88:91], v[216:219]
  v_max3_f32 v34, v34, v200, v201
  v_mfma_f32_16x16x32_bf16 v[224:227], a[108:111], a[92:95], v[224:227]
  v_max3_f32 v32, v32, v186, v187
  v_mfma_f32_16x16x32_bf16 v[212:215], a[112:115], a[48:51], 0
  v_max3_f32 v33, v33, v194, v195
L_ws82:
  s_cbranch_execz L_wa_back
  v_mfma_f32_16x16x32_bf16 v[220:223], a[112:115], a[52:55], 0
  v_max3_f32 v34, v34, v202, v203
  v_mfma_f32_16x16x32_bf16 v[228:231], a[112:115], a[56:59], 0
  v_max3_f32 v32, v32, v188, v189
  v_mfma_f32_16x16x32_bf16 v[212:215], a[116:119], a[60:63], v[212:215]
  v_max3_f32 v33, v33, v196, v197
  v_mfma_f32_16x16x32_bf16 v[220:223], a[116:119], a[64:67], v[220:223]
  v_max3_f32 v34, v34, v204, v205
  v_mfma_f32_16x16x32_bf16 v[228:231], a[116:119], a[68:71], v[228:231]
  v_max3_f32 v32, v32, v190, v191
  v_mfma_f32_16x16x32_bf16 v[212:215], a[120:123], a[72:75], v[212:215]
  v_max3_f32 v33, v33, v198, v199
  v_mfma_f32_16x16x32_bf16 v[220:223], a[120:123], a[76:79], v[220:223]
  v_max3_f32 v34, v34, v206, v207
  v_mfma_f32_16x16x32_bf16 v[228:231], a[120:123], a[80:83], v[228:231]
  v_mfma_f32_16x16x32_bf16 v[212:215], a[124:127], a[84:87], v[212:215]
  v_mfma_f32_16x16x32_bf16 v[220:223], a[124:127], a[88:91], v[220:223]
  v_mfma_f32_16x16x32_bf16 v[228:231], a[124:127], a[92:95], v[228:231]
  buffer_load_dwordx4 v5, s[20:23], s37 offen offset:1024 nt lds
  s_waitcnt lgkmcnt(0)
  s_barrier
  v_mfma_f32_16x16x32_bf16 v[232:235], a[128:131], a[48:51], 0
  v_mfma_f32_16x16x32_bf16 v[240:243], a[128:131], a[52:55], 0
  v_mfma_f32_16x16x32_bf16 v[248:251], a[128:131], a[56:59], 0
  v_mfma_f32_16x16x32_bf16 v[232:235], a[132:135], a[60:63], v[232:235]
  v_mfma_f32_16x16x32_bf16 v[240:243], a[132:135], a[64:67], v[240:243]
  v_mfma_f32_16x16x32_bf16 v[248:251], a[132:135], a[68:71], v[248:251]
  v_mfma_f32_16x16x32_bf16 v[232:235], a[136:139], a[72:75], v[232:235]
  v_mfma_f32_16x16x32_bf16 v[240:243], a[136:139], a[76:79], v[240:243]
  v_mfma_f32_16x16x32_bf16 v[248:251], a[136:139], a[80:83], v[248:251]
  buffer_load_dwordx4 v4, s[20:23], s37 offen offset:2048 nt lds
  v_max3_f32 v32, v32, v208, v209
L_ws83:
  s_cbranch_execz L_wa_back
  v_mfma_f32_16x16x32_bf16 v[232:235], a[140:143], a[84:87], v[232:235]
  v_max3_f32 v33, v33, v216, v217
  v_mfma_f32_16x16x32_bf16 v[240:243], a[140:143], a[88:91], v[240:243]
  v_max3_f32 v34, v34, v224, v225
  v_mfma_f32_16x16x32_bf16 v[248:251], a[140:143], a[92:95], v[248:251]
  v_max3_f32 v32, v32, v210, v211
  v_mfma_f32_16x16x32_bf16 v[236:239], a[144:147], a[48:51], 0
  v_max3_f32 v33, v33, v218, v219
  v_mfma_f32_16x16x32_bf16 v[244:247], a[144:147], a[52:55], 0
  v_max3_f32 v34, v34, v226, v227
  v_mfma_f32_16x16x32_bf16 v[252:255], a[144:147], a[56:59], 0
  v_max3_f32 v32, v32, v212, v213
  v_mfma_f32_16x16x32_bf16 v[236:239], a[148:151], a[60:63], v[236:239]
  v_max3_f32 v33, v33, v220, v221
  v_mfma_f32_16x16x32_bf16 v[244:247], a[148:151], a[64:67], v[244:247]
  v_max3_f32 v34, v34, v228, v229
  v_mfma_f32_16x16x32_bf16 v[252:255], a[148:151], a[68:71], v[252:255]
  v_max3_f32 v32, v32, v214, v215
  v_mfma_f32_16x16x32_bf16 v[236:239], a[152:155], a[72:75], v[236:239]
  v_max3_f32 v33, v33, v222, v223
  v_mfma_f32_16x16x32_bf16 v[244:247], a[152:155], a[76:79], v[244:247]
  v_max3_f32 v34, v34, v230, v231
  v_mfma_f32_16x16x32_bf16 v[252:255], a[152:155], a[80:83], v[252:255]
  v_mfma_f32_16x16x32_bf16 v[236:239], a[156:159], a[84:87], v[236:239]
  v_mfma_f32_16x16x32_bf16 v[244:247], a[156:159], a[88:91], v[244:247]
  buffer_load_dwordx4 v5, s[20:23], s37 offen offset:3072 nt lds
  v_mfma_f32_16x16x32_bf16 v[252:255], a[156:159], a[92:95], v[252:255]
  s_nop 7
  v_max3_f32 v32, v32, v232, v233
  v_max3_f32 v33, v33, v240, v241
  v_max3_f32 v34, v34, v248, v249
  v_max3_f32 v32, v32, v234, v235
L_ws84:
  s_cbranch_execz L_wa_back
  v_max3_f32 v33, v33, v242, v243
  v_max3_f32 v34, v34, v250, v251
  v_max3_f32 v32, v32, v236, v237
  v_max3_f32 v33, v33, v244, v245
  v_max3_f32 v34, v34, v252, v253
  v_max3_f32 v32, v32, v238, v239
  v_max3_f32 v33, v33, v246, v247
  v_max3_f32 v34, v34, v254, v255
  v_mov_b32 v35, v32
  v_mov_b32 v36, v33
  v_mov_b32 v37, v34
  s_nop 1
  v_permlane32_swap_b32 v35, v32
  v_permlane32_swap_b32 v36, v33
  v_permlane32_swap_b32 v37, v34
  s_nop 1
  v_max_f32 v32, v32, v35
  v_max_f32 v33, v33, v36
  v_max_f32 v34, v34, v37
  v_mov_b32 v35, v32
  v_mov_b32 v36, v33
  v_mov_b32 v37, v34
  s_nop 1
  v_permlane16_swap_b32 v35, v32
  v_permlane16_swap_b32 v36, v33
  v_permlane16_swap_b32 v37, v34
  s_nop 1
  v_max_f32 v32, v32, v35
  v_max_f32 v33, v33, v36
  v_max_f32 v34, v34, v37
  v_mul_f32 v38, 0xbe0293ee, v32
  v_mov_b32 v46, 0
  v_mov_b32 v47, 0
  v_mul_f32 v40, 0xbe0293ee, v33
  v_mov_b32 v48, 0
  v_mov_b32 v49, 0
  v_mul_f32 v42, 0xbe0293ee, v34
  v_mov_b32 v50, 0
  v_mov_b32 v51, 0
  v_pk_fma_f32 v[64:65], v[64:65], v[44:45], v[38:39] op_sel_hi:[1,0,0]
  v_pk_fma_f32 v[66:67], v[66:67], v[44:45], v[38:39] op_sel_hi:[1,0,0]
  v_pk_fma_f32 v[68:69], v[68:69], v[44:45], v[38:39] op_sel_hi:[1,0,0]
  v_pk_fma_f32 v[70:71], v[70:71], v[44:45], v[38:39] op_sel_hi:[1,0,0]
  s_bfe_u32 s46, s45, 0x20009
  s_lshl_b32 s46, s46, 6
  s_add_u32 s46, s46, s62
  s_buffer_load_dwordx2 s[64:65], s[24:27], s46
L_ws85:
  s_cbranch_execz L_wa_back
  v_exp_f32 v64, v64
  v_exp_f32 v65, v65
  v_pk_fma_f32 v[72:73], v[72:73], v[44:45], v[40:41] op_sel_hi:[1,0,0]
  s_add_u32 m0, s38, 49152
  s_add_u32 s37, s36, 180224
  buffer_load_dwordx4 v4, s[20:23], s37 offen offset:0 nt lds
  v_exp_f32 v66, v66
  v_exp_f32 v67, v67
  v_pk_fma_f32 v[74:75], v[74:75], v[44:45], v[40:41] op_sel_hi:[1,0,0]
  v_exp_f32 v68, v68
  v_exp_f32 v69, v69
  v_pk_fma_f32 v[76:77], v[76:77], v[44:45], v[40:41] op_sel_hi:[1,0,0]
  v_exp_f32 v70, v70
  v_exp_f32 v71, v71
  v_pk_fma_f32 v[78:79], v[78:79], v[44:45], v[40:41] op_sel_hi:[1,0,0]
  v_exp_f32 v72, v72
  v_pk_add_f32 v[46:47], v[46:47], v[64:65]
  v_exp_f32 v73, v73
  v_cvt_pk_bf16_f32 v64, v64, v65
  v_pk_fma_f32 v[80:81], v[80:81], v[44:45], v[42:43] op_sel_hi:[1,0,0]
  v_exp_f32 v74, v74
  v_pk_add_f32 v[46:47], v[46:47], v[66:67]
  v_exp_f32 v75, v75
  v_cvt_pk_bf16_f32 v65, v66, v67
  v_pk_fma_f32 v[82:83], v[82:83], v[44:45], v[42:43] op_sel_hi:[1,0,0]
  buffer_load_dwordx4 v5, s[20:23], s37 offen offset:1024 nt lds
  v_exp_f32 v76, v76
  v_pk_add_f32 v[46:47], v[46:47], v[68:69]
  v_exp_f32 v77, v77
  v_cvt_pk_bf16_f32 v66, v68, v69
  v_pk_fma_f32 v[84:85], v[84:85], v[44:45], v[42:43] op_sel_hi:[1,0,0]
  v_exp_f32 v78, v78
  v_pk_add_f32 v[46:47], v[46:47], v[70:71]
  v_exp_f32 v79, v79
  v_cvt_pk_bf16_f32 v67, v70, v71
  v_pk_fma_f32 v[86:87], v[86:87], v[44:45], v[42:43] op_sel_hi:[1,0,0]
  v_exp_f32 v80, v80
  v_pk_add_f32 v[48:49], v[48:49], v[72:73]
  v_exp_f32 v81, v81
  v_cvt_pk_bf16_f32 v68, v72, v73
L_ws86:
  s_cbranch_execz L_wa_back
  v_pk_fma_f32 v[88:89], v[88:89], v[44:45], v[38:39] op_sel_hi:[1,0,0]
  v_exp_f32 v82, v82
  v_pk_add_f32 v[48:49], v[48:49], v[74:75]
  v_exp_f32 v83, v83
  v_cvt_pk_bf16_f32 v69, v74, v75
  v_pk_fma_f32 v[90:91], v[90:91], v[44:45], v[38:39] op_sel_hi:[1,0,0]
  v_exp_f32 v84, v84
  v_pk_add_f32 v[48:49], v[48:49], v[76:77]
  v_exp_f32 v85, v85
  v_cvt_pk_bf16_f32 v70, v76, v77
  v_pk_fma_f32 v[92:93], v[92:93], v[44:45], v[38:39] op_sel_hi:[1,0,0]
  v_exp_f32 v86, v86
  v_pk_add_f32 v[48:49], v[48:49], v[78:79]
  v_exp_f32 v87, v87
  v_cvt_pk_bf16_f32 v71, v78, v79
  v_pk_fma_f32 v[94:95], v[94:95], v[44:45], v[38:39] op_sel_hi:[1,0,0]
  v_exp_f32 v88, v88
  v_pk_add_f32 v[50:51], v[50:51], v[80:81]
  v_exp_f32 v89, v89
  v_cvt_pk_bf16_f32 v72, v80, v81
  v_pk_fma_f32 v[96:97], v[96:97], v[44:45], v[40:41] op_sel_hi:[1,0,0]
  buffer_load_dwordx4 v4, s[20:23], s37 offen offset:2048 nt lds
  v_exp_f32 v90, v90
  v_pk_add_f32 v[50:51], v[50:51], v[82:83]
  v_exp_f32 v91, v91
  v_cvt_pk_bf16_f32 v73, v82, v83
  v_pk_fma_f32 v[98:99], v[98:99], v[44:45], v[40:41] op_sel_hi:[1,0,0]
  v_exp_f32 v92, v92
  v_pk_add_f32 v[50:51], v[50:51], v[84:85]
  v_exp_f32 v93, v93
  v_cvt_pk_bf16_f32 v74, v84, v85
  v_pk_fma_f32 v[100:101], v[100:101], v[44:45], v[40:41] op_sel_hi:[1,0,0]
  v_exp_f32 v94, v94
  v_pk_add_f32 v[50:51], v[50:51], v[86:87]
  v_exp_f32 v95, v95
  v_cvt_pk_bf16_f32 v75, v86, v87
  v_pk_fma_f32 v[102:103], v[102:103], v[44:45], v[40:41] op_sel_hi:[1,0,0]
  v_exp_f32 v96, v96
  v_pk_add_f32 v[46:47], v[46:47], v[88:89]
L_ws87:
  s_cbranch_execz L_wa_back
  v_exp_f32 v97, v97
  v_cvt_pk_bf16_f32 v76, v88, v89
  v_pk_fma_f32 v[104:105], v[104:105], v[44:45], v[42:43] op_sel_hi:[1,0,0]
  v_exp_f32 v98, v98
  v_pk_add_f32 v[46:47], v[46:47], v[90:91]
  v_exp_f32 v99, v99
  v_cvt_pk_bf16_f32 v77, v90, v91
  v_pk_fma_f32 v[106:107], v[106:107], v[44:45], v[42:43] op_sel_hi:[1,0,0]
  v_exp_f32 v100, v100
  v_pk_add_f32 v[46:47], v[46:47], v[92:93]
  v_exp_f32 v101, v101
  v_cvt_pk_bf16_f32 v78, v92, v93
  v_pk_fma_f32 v[108:109], v[108:109], v[44:45], v[42:43] op_sel_hi:[1,0,0]
  v_exp_f32 v102, v102
  v_pk_add_f32 v[46:47], v[46:47], v[94:95]
  v_exp_f32 v103, v103
  v_cvt_pk_bf16_f32 v79, v94, v95
  v_pk_fma_f32 v[110:111], v[110:111], v[44:45], v[42:43] op_sel_hi:[1,0,0]
  v_exp_f32 v104, v104
  v_pk_add_f32 v[48:49], v[48:49], v[96:97]
  v_exp_f32 v105, v105
  v_cvt_pk_bf16_f32 v80, v96, v97
  v_pk_fma_f32 v[112:113], v[112:113], v[44:45], v[38:39] op_sel_hi:[1,0,0]
  buffer_load_dwordx4 v5, s[20:23], s37 offen offset:3072 nt lds
  v_exp_f32 v106, v106
  v_pk_add_f32 v[48:49], v[48:49], v[98:99]
  v_exp_f32 v107, v107
  v_cvt_pk_bf16_f32 v81, v98, v99
  v_pk_fma_f32 v[114:115], v[114:115], v[44:45], v[38:39] op_sel_hi:[1,0,0]
  v_exp_f32 v108, v108
  v_pk_add_f32 v[48:49], v[48:49], v[100:101]
  v_exp_f32 v109, v109
  v_cvt_pk_bf16_f32 v82, v100, v101
  v_pk_fma_f32 v[116:117], v[116:117], v[44:45], v[38:39] op_sel_hi:[1,0,0]
  v_exp_f32 v110, v110
  v_pk_add_f32 v[48:49], v[48:49], v[102:103]
  v_exp_f32 v111, v111
  v_cvt_pk_bf16_f32 v83, v102, v103
  v_pk_fma_f32 v[118:119], v[118:119], v[44:45], v[38:39] op_sel_hi:[1,0,0]
L_ws88:
  s_cbranch_execz L_wa_back
  v_exp_f32 v112, v112
  v_pk_add_f32 v[50:51], v[50:51], v[104:105]
  v_exp_f32 v113, v113
  v_cvt_pk_bf16_f32 v84, v104, v105
  v_pk_fma_f32 v[120:121], v[120:121], v[44:45], v[40:41] op_sel_hi:[1,0,0]
  v_exp_f32 v114, v114
  v_pk_add_f32 v[50:51], v[50:51], v[106:107]
  v_exp_f32 v115, v115
  v_cvt_pk_bf16_f32 v85, v106, v107
  v_pk_fma_f32 v[122:123], v[122:123], v[44:45], v[40:41] op_sel_hi:[1,0,0]
  v_exp_f32 v116, v116
  v_pk_add_f32 v[50:51], v[50:51], v[108:109]
  v_exp_f32 v117, v117
  v_cvt_pk_bf16_f32 v86, v108, v109
  v_pk_fma_f32 v[124:125], v[124:125], v[44:45], v[40:41] op_sel_hi:[1,0,0]
  v_exp_f32 v118, v118
  v_pk_add_f32 v[50:51], v[50:51], v[110:111]
  v_exp_f32 v119, v119
  v_cvt_pk_bf16_f32 v87, v110, v111
  v_pk_fma_f32 v[126:127], v[126:127], v[44:45], v[40:41] op_sel_hi:[1,0,0]
  v_exp_f32 v120, v120
  v_pk_add_f32 v[46:47], v[46:47], v[112:113]
  v_exp_f32 v121, v121
  v_cvt_pk_bf16_f32 v88, v112, v113
  v_pk_fma_f32 v[128:129], v[128:129], v[44:45], v[42:43] op_sel_hi:[1,0,0]
  s_add_u32 m0, s38, 65536
  s_add_u32 s37, s36, 196608
  buffer_load_dwordx4 v4, s[20:23], s37 offen offset:0 nt lds
  v_exp_f32 v122, v122
  v_pk_add_f32 v[46:47], v[46:47], v[114:115]
  v_exp_f32 v123, v123
  v_cvt_pk_bf16_f32 v89, v114, v115
  v_pk_fma_f32 v[130:131], v[130:131], v[44:45], v[42:43] op_sel_hi:[1,0,0]
  v_exp_f32 v124, v124
  v_pk_add_f32 v[46:47], v[46:47], v[116:117]
  v_exp_f32 v125, v125
  v_cvt_pk_bf16_f32 v90, v116, v117
  v_pk_fma_f32 v[132:133], v[132:133], v[44:45], v[42:43] op_sel_hi:[1,0,0]
  v_exp_f32 v126, v126
L_ws89:
  s_cbranch_execz L_wa_back
  v_pk_add_f32 v[46:47], v[46:47], v[118:119]
  v_exp_f32 v127, v127
  v_cvt_pk_bf16_f32 v91, v118, v119
  v_pk_fma_f32 v[134:135], v[134:135], v[44:45], v[42:43] op_sel_hi:[1,0,0]
  s_waitcnt lgkmcnt(0)
  s_xor_b32 s64, s64, s60
  s_xor_b32 s65, s65, s60
  s_or_b32 s64, s64, s65
  s_cmp_eq_u32 s64, 0
  s_cbranch_scc0 L_slow_o01
L_back_o01:
  s_bfe_u32 s46, s45, 0x20011
  s_lshl_b32 s46, s46, 6
  s_add_u32 s46, s46, s62
  s_buffer_load_dwordx2 s[64:65], s[24:27], s46
  v_exp_f32 v128, v128
  v_pk_add_f32 v[48:49], v[48:49], v[120:121]
  v_exp_f32 v129, v129
  v_cvt_pk_bf16_f32 v92, v120, v121
  v_pk_fma_f32 v[136:137], v[136:137], v[44:45], v[38:39] op_sel_hi:[1,0,0]
  v_exp_f32 v130, v130
  v_pk_add_f32 v[48:49], v[48:49], v[122:123]
  v_exp_f32 v131, v131
  v_cvt_pk_bf16_f32 v93, v122, v123
  v_pk_fma_f32 v[138:139], v[138:139], v[44:45], v[38:39] op_sel_hi:[1,0,0]
  v_exp_f32 v132, v132
  v_pk_add_f32 v[48:49], v[48:49], v[124:125]
  v_exp_f32 v133, v133
  v_cvt_pk_bf16_f32 v94, v124, v125
  v_pk_fma_f32 v[140:141], v[140:141], v[44:45], v[38:39] op_sel_hi:[1,0,0]
  v_exp_f32 v134, v134
  v_pk_add_f32 v[48:49], v[48:49], v[126:127]
  v_exp_f32 v135, v135
  v_cvt_pk_bf16_f32 v95, v126, v127
  v_pk_fma_f32 v[142:143], v[142:143], v[44:45], v[38:39] op_sel_hi:[1,0,0]
  buffer_load_dwordx4 v5, s[20:23], s37 offen offset:1024 nt lds
  v_exp_f32 v136, v136
  v_pk_add_f32 v[50:51], v[50:51], v[128:129]
  v_exp_f32 v137, v137
  v_cvt_pk_bf16_f32 v96, v128, v129
  v_pk_fma_f32 v[144:145], v[144:145], v[44:45], v[40:41] op_sel_hi:[1,0,0]
  v_exp_f32 v138, v138
  v_pk_add_f32 v[50:51], v[50:51], v[130:131]
L_ws90:
  s_cbranch_execz L_wa_back
  v_exp_f32 v139, v139
  v_cvt_pk_bf16_f32 v97, v130, v131
  v_pk_fma_f32 v[146:147], v[146:147], v[44:45], v[40:41] op_sel_hi:[1,0,0]
  v_exp_f32 v140, v140
  v_pk_add_f32 v[50:51], v[50:51], v[132:133]
  v_exp_f32 v141, v141
  v_cvt_pk_bf16_f32 v98, v132, v133
  v_pk_fma_f32 v[148:149], v[148:149], v[44:45], v[40:41] op_sel_hi:[1,0,0]
  v_exp_f32 v142, v142
  v_pk_add_f32 v[50:51], v[50:51], v[134:135]
  v_exp_f32 v143, v143
  v_cvt_pk_bf16_f32 v99, v134, v135
  v_pk_fma_f32 v[150:151], v[150:151], v[44:45], v[40:41] op_sel_hi:[1,0,0]
  v_exp_f32 v144, v144
  v_pk_add_f32 v[46:47], v[46:47], v[136:137]
  v_exp_f32 v145, v145
  v_cvt_pk_bf16_f32 v100, v136, v137
  v_pk_fma_f32 v[152:153], v[152:153], v[44:45], v[42:43] op_sel_hi:[1,0,0]
  v_exp_f32 v146, v146
  v_pk_add_f32 v[46:47], v[46:47], v[138:139]
  v_exp_f32 v147, v147
  v_cvt_pk_bf16_f32 v101, v138, v139
  v_pk_fma_f32 v[154:155], v[154:155], v[44:45], v[42:43] op_sel_hi:[1,0,0]
  v_exp_f32 v148, v148
  v_pk_add_f32 v[46:47], v[46:47], v[140:141]
  v_exp_f32 v149, v149
  v_cvt_pk_bf16_f32 v102, v140, v141
  v_pk_fma_f32 v[156:157], v[156:157], v[44:45], v[42:43] op_sel_hi:[1,0,0]
  v_exp_f32 v150, v150
  v_pk_add_f32 v[46:47], v[46:47], v[142:143]
  v_exp_f32 v151, v151
  v_cvt_pk_bf16_f32 v103, v142, v143
  v_pk_fma_f32 v[158:159], v[158:159], v[44:45], v[42:43] op_sel_hi:[1,0,0]
  buffer_load_dwordx4 v4, s[20:23], s37 offen offset:2048 nt lds
  v_exp_f32 v152, v152
  v_pk_add_f32 v[48:49], v[48:49], v[144:145]
  v_exp_f32 v153, v153
  v_cvt_pk_bf16_f32 v104, v144, v145
  v_pk_fma_f32 v[160:161], v[160:161], v[44:45], v[38:39] op_sel_hi:[1,0,0]
L_ws91:
  s_cbranch_execz L_wa_back
  v_exp_f32 v154, v154
  v_pk_add_f32 v[48:49], v[48:49], v[146:147]
  v_exp_f32 v155, v155
  v_cvt_pk_bf16_f32 v105, v146, v147
  v_pk_fma_f32 v[162:163], v[162:163], v[44:45], v[38:39] op_sel_hi:[1,0,0]
  v_exp_f32 v156, v156
  v_pk_add_f32 v[48:49], v[48:49], v[148:149]
  v_exp_f32 v157, v157
  v_cvt_pk_bf16_f32 v106, v148, v149
  v_pk_fma_f32 v[164:165], v[164:165], v[44:45], v[38:39] op_sel_hi:[1,0,0]
  v_exp_f32 v158, v158
  v_pk_add_f32 v[48:49], v[48:49], v[150:151]
  v_exp_f32 v159, v159
  v_cvt_pk_bf16_f32 v107, v150, v151
  v_pk_fma_f32 v[166:167], v[166:167], v[44:45], v[38:39] op_sel_hi:[1,0,0]
  v_exp_f32 v160, v160
  v_pk_add_f32 v[50:51], v[50:51], v[152:153]
  v_exp_f32 v161, v161
  v_cvt_pk_bf16_f32 v108, v152, v153
  v_pk_fma_f32 v[168:169], v[168:169], v[44:45], v[40:41] op_sel_hi:[1,0,0]
  v_exp_f32 v162, v162
  v_pk_add_f32 v[50:51], v[50:51], v[154:155]
  v_exp_f32 v163, v163
  v_cvt_pk_bf16_f32 v109, v154, v155
  v_pk_fma_f32 v[170:171], v[170:171], v[44:45], v[40:41] op_sel_hi:[1,0,0]
  v_exp_f32 v164, v164
  v_pk_add_f32 v[50:51], v[50:51], v[156:157]
  v_exp_f32 v165, v165
  v_cvt_pk_bf16_f32 v110, v156, v157
  v_pk_fma_f32 v[172:173], v[172:173], v[44:45], v[40:41] op_sel_hi:[1,0,0]
  buffer_load_dwordx4 v5, s[20:23], s37 offen offset:3072 nt lds
  v_exp_f32 v166, v166
  v_pk_add_f32 v[50:51], v[50:51], v[158:159]
  v_exp_f32 v167, v167
  v_cvt_pk_bf16_f32 v111, v158, v159
  v_pk_fma_f32 v[174:175], v[174:175], v[44:45], v[40:41] op_sel_hi:[1,0,0]
  v_exp_f32 v168, v168
  v_pk_add_f32 v[46:47], v[46:47], v[160:161]
  v_exp_f32 v169, v169
L_ws92:
  s_cbranch_execz L_wa_back
  v_cvt_pk_bf16_f32 v112, v160, v161
  v_pk_fma_f32 v[176:177], v[176:177], v[44:45], v[42:43] op_sel_hi:[1,0,0]
  v_exp_f32 v170, v170
  v_pk_add_f32 v[46:47], v[46:47], v[162:163]
  v_exp_f32 v171, v171
  v_cvt_pk_bf16_f32 v113, v162, v163
  v_pk_fma_f32 v[178:179], v[178:179], v[44:45], v[42:43] op_sel_hi:[1,0,0]
  v_exp_f32 v172, v172
  v_pk_add_f32 v[46:47], v[46:47], v[164:165]
  v_exp_f32 v173, v173
  v_cvt_pk_bf16_f32 v114, v164, v165
  v_pk_fma_f32 v[180:181], v[180:181], v[44:45], v[42:43] op_sel_hi:[1,0,0]
  v_exp_f32 v174, v174
  v_pk_add_f32 v[46:47], v[46:47], v[166:167]
  v_exp_f32 v175, v175
  v_cvt_pk_bf16_f32 v115, v166, v167
  v_pk_fma_f32 v[182:183], v[182:183], v[44:45], v[42:43] op_sel_hi:[1,0,0]
  v_exp_f32 v176, v176
  v_pk_add_f32 v[48:49], v[48:49], v[168:169]
  v_exp_f32 v177, v177
  v_cvt_pk_bf16_f32 v116, v168, v169
  v_pk_fma_f32 v[184:185], v[184:185], v[44:45], v[38:39] op_sel_hi:[1,0,0]
  v_exp_f32 v178, v178
  v_pk_add_f32 v[48:49], v[48:49], v[170:171]
  v_exp_f32 v179, v179
  v_cvt_pk_bf16_f32 v117, v170, v171
  v_pk_fma_f32 v[186:187], v[186:187], v[44:45], v[38:39] op_sel_hi:[1,0,0]
  v_exp_f32 v180, v180
  v_pk_add_f32 v[48:49], v[48:49], v[172:173]
  v_exp_f32 v181, v181
  v_cvt_pk_bf16_f32 v118, v172, v173
  v_pk_fma_f32 v[188:189], v[188:189], v[44:45], v[38:39] op_sel_hi:[1,0,0]
  s_add_u32 m0, s38, 114688
  s_add_u32 s37, s36, 212992
  buffer_load_dwordx4 v4, s[20:23], s37 offen offset:0 nt lds
  v_exp_f32 v182, v182
  v_pk_add_f32 v[48:49], v[48:49], v[174:175]
  v_exp_f32 v183, v183
  v_cvt_pk_bf16_f32 v119, v174, v175
L_ws93:
  s_cbranch_execz L_wa_back
  v_pk_fma_f32 v[190:191], v[190:191], v[44:45], v[38:39] op_sel_hi:[1,0,0]
  v_exp_f32 v184, v184
  v_pk_add_f32 v[50:51], v[50:51], v[176:177]
  v_exp_f32 v185, v185
  v_cvt_pk_bf16_f32 v120, v176, v177
  v_pk_fma_f32 v[192:193], v[192:193], v[44:45], v[40:41] op_sel_hi:[1,0,0]
  v_exp_f32 v186, v186
  v_pk_add_f32 v[50:51], v[50:51], v[178:179]
  v_exp_f32 v187, v187
  v_cvt_pk_bf16_f32 v121, v178, v179
  v_pk_fma_f32 v[194:195], v[194:195], v[44:45], v[40:41] op_sel_hi:[1,0,0]
  v_exp_f32 v188, v188
  v_pk_add_f32 v[50:51], v[50:51], v[180:181]
  v_exp_f32 v189, v189
  v_cvt_pk_bf16_f32 v122, v180, v181
  v_pk_fma_f32 v[196:197], v[196:197], v[44:45], v[40:41] op_sel_hi:[1,0,0]
  v_exp_f32 v190, v190
  v_pk_add_f32 v[50:51], v[50:51], v[182:183]
  v_exp_f32 v191, v191
  v_cvt_pk_bf16_f32 v123, v182, v183
  v_pk_fma_f32 v[198:199], v[198:199], v[44:45], v[40:41] op_sel_hi:[1,0,0]
  s_waitcnt lgkmcnt(0)
  s_xor_b32 s64, s64, s60
  s_xor_b32 s65, s65, s60
  s_or_b32 s64, s64, s65
  s_cmp_eq_u32 s64, 0
  s_cbranch_scc0 L_slow_o02
L_back_o02:
  s_bfe_u32 s46, s45, 0x20019
  s_lshl_b32 s46, s46, 6
  s_add_u32 s46, s46, s62
  s_buffer_load_dwordx2 s[64:65], s[24:27], s46
  v_exp_f32 v192, v192
  v_pk_add_f32 v[46:47], v[46:47], v[184:185]
  v_exp_f32 v193, v193
  v_cvt_pk_bf16_f32 v124, v184, v185
  v_pk_fma_f32 v[200:201], v[200:201], v[44:45], v[42:43] op_sel_hi:[1,0,0]
  v_exp_f32 v194, v194
  v_pk_add_f32 v[46:47], v[46:47], v[186:187]
  v_exp_f32 v195, v195
  v_cvt_pk_bf16_f32 v125, v186, v187
  v_pk_fma_f32 v[202:203], v[202:203], v[44:45], v[42:43] op_sel_hi:[1,0,0]
L_ws94:
  s_cbranch_execz L_wa_back
  buffer_load_dwordx4 v5, s[20:23], s37 offen offset:1024 nt lds
  v_exp_f32 v196, v196
  v_pk_add_f32 v[46:47], v[46:47], v[188:189]
  v_exp_f32 v197, v197
  v_cvt_pk_bf16_f32 v126, v188, v189
  v_pk_fma_f32 v[204:205], v[204:205], v[44:45], v[42:43] op_sel_hi:[1,0,0]
  v_exp_f32 v198, v198
  v_pk_add_f32 v[46:47], v[46:47], v[190:191]
  v_exp_f32 v199, v199
  v_cvt_pk_bf16_f32 v127, v190, v191
  v_pk_fma_f32 v[206:207], v[206:207], v[44:45], v[42:43] op_sel_hi:[1,0,0]
  v_exp_f32 v200, v200
  v_pk_add_f32 v[48:49], v[48:49], v[192:193]
  v_exp_f32 v201, v201
  v_cvt_pk_bf16_f32 v128, v192, v193
  v_pk_fma_f32 v[208:209], v[208:209], v[44:45], v[38:39] op_sel_hi:[1,0,0]
  v_exp_f32 v202, v202
  v_pk_add_f32 v[48:49], v[48:49], v[194:195]
  v_exp_f32 v203, v203
  v_cvt_pk_bf16_f32 v129, v194, v195
  v_pk_fma_f32 v[210:211], v[210:211], v[44:45], v[38:39] op_sel_hi:[1,0,0]
  v_exp_f32 v204, v204
  v_pk_add_f32 v[48:49], v[48:49], v[196:197]
  v_exp_f32 v205, v205
  v_cvt_pk_bf16_f32 v130, v196, v197
  v_pk_fma_f32 v[212:213], v[212:213], v[44:45], v[38:39] op_sel_hi:[1,0,0]
  v_exp_f32 v206, v206
  v_pk_add_f32 v[48:49], v[48:49], v[198:199]
  v_exp_f32 v207, v207
  v_cvt_pk_bf16_f32 v131, v198, v199
  v_pk_fma_f32 v[214:215], v[214:215], v[44:45], v[38:39] op_sel_hi:[1,0,0]
  v_exp_f32 v208, v208
  v_pk_add_f32 v[50:51], v[50:51], v[200:201]
  v_exp_f32 v209, v209
  v_cvt_pk_bf16_f32 v132, v200, v201
  v_pk_fma_f32 v[216:217], v[216:217], v[44:45], v[40:41] op_sel_hi:[1,0,0]
  v_exp_f32 v210, v210
  v_pk_add_f32 v[50:51], v[50:51], v[202:203]
  v_exp_f32 v211, v211
  v_cvt_pk_bf16_f32 v133, v202, v203
L_ws95:
  s_cbranch_execz L_wa_back
  v_pk_fma_f32 v[218:219], v[218:219], v[44:45], v[40:41] op_sel_hi:[1,0,0]
  buffer_load_dwordx4 v4, s[20:23], s37 offen offset:2048 nt lds
  v_exp_f32 v212, v212
  v_pk_add_f32 v[50:51], v[50:51], v[204:205]
  v_exp_f32 v213, v213
  v_cvt_pk_bf16_f32 v134, v204, v205
  v_pk_fma_f32 v[220:221], v[220:221], v[44:45], v[40:41] op_sel_hi:[1,0,0]
  v_exp_f32 v214, v214
  v_pk_add_f32 v[50:51], v[50:51], v[206:207]
  v_exp_f32 v215, v215
  v_cvt_pk_bf16_f32 v135, v206, v207
  v_pk_fma_f32 v[222:223], v[222:223], v[44:45], v[40:41] op_sel_hi:[1,0,0]
  v_exp_f32 v216, v216
  v_pk_add_f32 v[46:47], v[46:47], v[208:209]
  v_exp_f32 v217, v217
  v_cvt_pk_bf16_f32 v136, v208, v209
  v_pk_fma_f32 v[224:225], v[224:225], v[44:45], v[42:43] op_sel_hi:[1,0,0]
  v_exp_f32 v218, v218
  v_pk_add_f32 v[46:47], v[46:47], v[210:211]
  v_exp_f32 v219, v219
  v_cvt_pk_bf16_f32 v137, v210, v211
  v_pk_fma_f32 v[226:227], v[226:227], v[44:45], v[42:43] op_sel_hi:[1,0,0]
  v_exp_f32 v220, v220
  v_pk_add_f32 v[46:47], v[46:47], v[212:213]
  v_exp_f32 v221, v221
  v_cvt_pk_bf16_f32 v138, v212, v213
  v_pk_fma_f32 v[228:229], v[228:229], v[44:45], v[42:43] op_sel_hi:[1,0,0]
  v_exp_f32 v222, v222
  v_pk_add_f32 v[46:47], v[46:47], v[214:215]
  v_exp_f32 v223, v223
  v_cvt_pk_bf16_f32 v139, v214, v215
  v_pk_fma_f32 v[230:231], v[230:231], v[44:45], v[42:43] op_sel_hi:[1,0,0]
  v_exp_f32 v224, v224
  v_pk_add_f32 v[48:49], v[48:49], v[216:217]
  v_exp_f32 v225, v225
  v_cvt_pk_bf16_f32 v140, v216, v217
  v_pk_fma_f32 v[232:233], v[232:233], v[44:45], v[38:39] op_sel_hi:[1,0,0]
  buffer_load_dwordx4 v5, s[20:23], s37 offen offset:3072 nt lds
L_ws96:
  s_cbranch_execz L_wa_back
  v_exp_f32 v226, v226
  v_pk_add_f32 v[48:49], v[48:49], v[218:219]
  v_exp_f32 v227, v227
  v_cvt_pk_bf16_f32 v141, v218, v219
  v_pk_fma_f32 v[234:235], v[234:235], v[44:45], v[38:39] op_sel_hi:[1,0,0]
  v_exp_f32 v228, v228
  v_pk_add_f32 v[48:49], v[48:49], v[220:221]
  v_exp_f32 v229, v229
  v_cvt_pk_bf16_f32 v142, v220, v221
  v_pk_fma_f32 v[236:237], v[236:237], v[44:45], v[38:39] op_sel_hi:[1,0,0]
  v_exp_f32 v230, v230
  v_pk_add_f32 v[48:49], v[48:49], v[222:223]
  v_exp_f32 v231, v231
  v_cvt_pk_bf16_f32 v143, v222, v223
  v_pk_fma_f32 v[238:239], v[238:239], v[44:45], v[38:39] op_sel_hi:[1,0,0]
  v_exp_f32 v232, v232
  v_pk_add_f32 v[50:51], v[50:51], v[224:225]
  v_exp_f32 v233, v233
  v_cvt_pk_bf16_f32 v144, v224, v225
  v_pk_fma_f32 v[240:241], v[240:241], v[44:45], v[40:41] op_sel_hi:[1,0,0]
  v_exp_f32 v234, v234
  v_pk_add_f32 v[50:51], v[50:51], v[226:227]
  v_exp_f32 v235, v235
  v_cvt_pk_bf16_f32 v145, v226, v227
  v_pk_fma_f32 v[242:243], v[242:243], v[44:45], v[40:41] op_sel_hi:[1,0,0]
  v_exp_f32 v236, v236
  v_pk_add_f32 v[50:51], v[50:51], v[228:229]
  v_exp_f32 v237, v237
  v_cvt_pk_bf16_f32 v146, v228, v229
  v_pk_fma_f32 v[244:245], v[244:245], v[44:45], v[40:41] op_sel_hi:[1,0,0]
  v_exp_f32 v238, v238
  v_pk_add_f32 v[50:51], v[50:51], v[230:231]
  v_exp_f32 v239, v239
  v_cvt_pk_bf16_f32 v147, v230, v231
  v_pk_fma_f32 v[246:247], v[246:247], v[44:45], v[40:41] op_sel_hi:[1,0,0]
  v_exp_f32 v240, v240
  v_pk_add_f32 v[46:47], v[46:47], v[232:233]
  v_exp_f32 v241, v241
  v_cvt_pk_bf16_f32 v148, v232, v233
  v_pk_fma_f32 v[248:249], v[248:249], v[44:45], v[42:43] op_sel_hi:[1,0,0]
L_ws97:
  s_cbranch_execz L_wa_back
  s_add_u32 m0, s38, 131072
  s_add_u32 s37, s36, 229376
  buffer_load_dwordx4 v4, s[20:23], s37 offen offset:0 nt lds
  v_exp_f32 v242, v242
  v_pk_add_f32 v[46:47], v[46:47], v[234:235]
  v_exp_f32 v243, v243
  v_cvt_pk_bf16_f32 v149, v234, v235
  v_pk_fma_f32 v[250:251], v[250:251], v[44:45], v[42:43] op_sel_hi:[1,0,0]
  v_exp_f32 v244, v244
  v_pk_add_f32 v[46:47], v[46:47], v[236:237]
  v_exp_f32 v245, v245
  v_cvt_pk_bf16_f32 v150, v236, v237
  v_pk_fma_f32 v[252:253], v[252:253], v[44:45], v[42:43] op_sel_hi:[1,0,0]
  v_exp_f32 v246, v246
  v_pk_add_f32 v[46:47], v[46:47], v[238:239]
  v_exp_f32 v247, v247
  v_cvt_pk_bf16_f32 v151, v238, v239
  v_pk_fma_f32 v[254:255], v[254:255], v[44:45], v[42:43] op_sel_hi:[1,0,0]
  v_exp_f32 v248, v248
  v_pk_add_f32 v[48:49], v[48:49], v[240:241]
  v_exp_f32 v249, v249
  v_cvt_pk_bf16_f32 v152, v240, v241
  v_exp_f32 v250, v250
  v_pk_add_f32 v[48:49], v[48:49], v[242:243]
  v_exp_f32 v251, v251
  v_cvt_pk_bf16_f32 v153, v242, v243
  v_exp_f32 v252, v252
  v_pk_add_f32 v[48:49], v[48:49], v[244:245]
  v_exp_f32 v253, v253
  v_cvt_pk_bf16_f32 v154, v244, v245
  v_exp_f32 v254, v254
  v_pk_add_f32 v[48:49], v[48:49], v[246:247]
  v_exp_f32 v255, v255
  v_cvt_pk_bf16_f32 v155, v246, v247
  s_waitcnt vmcnt(22) lgkmcnt(0)
  s_xor_b32 s64, s64, s60
  s_xor_b32 s65, s65, s60
  s_or_b32 s64, s64, s65
  s_cmp_eq_u32 s64, 0
  s_cbranch_scc0 L_slow_o03
L_back_o03:
  s_barrier
  v_add_u32 v17, 0xffff0000, v17
L_ws98:
  s_cbranch_execz L_wa_back
  v_add_u32 v18, 0xffff0000, v18
  v_add_u32 v19, 0xffff0000, v19
  v_add_u32 v20, 0xffff0000, v20
  v_add_u32 v21, 0xffff0000, v21
  v_add_u32 v22, 0xffff0000, v22
  v_add_u32 v23, 0xffff0000, v23
  v_add_u32 v24, 0xffff0000, v24
  ds_read_b64_tr_b16 a[96:97], v17 offset:0
  ds_read_b64_tr_b16 a[98:99], v17 offset:4096
  ds_read_b64_tr_b16 a[100:101], v18 offset:0
  ds_read_b64_tr_b16 a[102:103], v18 offset:4096
  ds_read_b64_tr_b16 a[104:105], v19 offset:0
  ds_read_b64_tr_b16 a[106:107], v19 offset:4096
  ds_read_b64_tr_b16 a[108:109], v20 offset:0
  ds_read_b64_tr_b16 a[110:111], v20 offset:4096
  ds_read_b64_tr_b16 a[112:113], v21 offset:0
  ds_read_b64_tr_b16 a[114:115], v21 offset:4096
  ds_read_b64_tr_b16 a[116:117], v22 offset:0
  ds_read_b64_tr_b16 a[118:119], v22 offset:4096
  ds_read_b64_tr_b16 a[120:121], v23 offset:0
  ds_read_b64_tr_b16 a[122:123], v23 offset:4096
  ds_read_b64_tr_b16 a[124:125], v24 offset:0
  ds_read_b64_tr_b16 a[126:127], v24 offset:4096
  v_pk_add_f32 v[50:51], v[50:51], v[248:249]
  v_cvt_pk_bf16_f32 v156, v248, v249
  v_pk_add_f32 v[50:51], v[50:51], v[250:251]
  v_cvt_pk_bf16_f32 v157, v250, v251
  v_pk_add_f32 v[50:51], v[50:51], v[252:253]
  v_cvt_pk_bf16_f32 v158, v252, v253
  v_pk_add_f32 v[50:51], v[50:51], v[254:255]
  v_cvt_pk_bf16_f32 v159, v254, v255
L_ws99:
  s_cbranch_execz L_wa_back
  buffer_load_dwordx4 v5, s[20:23], s37 offen offset:1024 nt lds
  v_add_f32 v46, v46, v47
  v_add_f32 v48, v48, v49
  v_add_f32 v50, v50, v51
  v_mov_b32 v35, v46
  v_mov_b32 v36, v48
  v_mov_b32 v37, v50
  s_nop 1
  v_permlane32_swap_b32 v35, v46
  v_permlane32_swap_b32 v36, v48
  v_permlane32_swap_b32 v37, v50
  s_nop 1
  v_add_f32 v46, v46, v35
  v_add_f32 v48, v48, v36
  v_add_f32 v50, v50, v37
  v_mov_b32 v35, v46
  v_mov_b32 v36, v48
  v_mov_b32 v37, v50
  s_nop 1
  v_permlane16_swap_b32 v35, v46
  v_permlane16_swap_b32 v36, v48
  v_permlane16_swap_b32 v37, v50
  s_nop 1
  v_add_f32 v46, v46, v35
  v_add_f32 v48, v48, v36
  v_add_f32 v50, v50, v37
  v_mov_b32 v52, v32
  v_mov_b32 v55, v46
  v_mov_b32 v53, v33
  v_mov_b32 v56, v48
  v_mov_b32 v54, v34
  v_mov_b32 v57, v50
  buffer_load_dwordx4 v4, s[20:23], s37 offen offset:2048 nt lds
  s_waitcnt vmcnt(19) lgkmcnt(0)
  s_barrier
  v_mfma_f32_16x16x32_bf16 v[160:163], a[96:99], v[64:67], 0
  ds_read_b64_tr_b16 a[128:129], v17 offset:16384
  v_mfma_f32_16x16x32_bf16 v[164:167], a[96:99], v[68:71], 0
  ds_read_b64_tr_b16 a[130:131], v17 offset:20480
  buffer_load_dwordx4 v5, s[20:23], s37 offen offset:3072 nt lds
  v_mfma_f32_16x16x32_bf16 v[168:171], a[96:99], v[72:75], 0
  ds_read_b64_tr_b16 a[132:133], v18 offset:16384
  v_mfma_f32_16x16x32_bf16 v[172:175], a[100:103], v[64:67], 0
  ds_read_b64_tr_b16 a[134:135], v18 offset:20480
  s_add_u32 m0, s38, 0
  s_add_u32 s37, s36, 245760
  buffer_load_dwordx4 v4, s[20:23], s37 offen offset:0 nt lds
  v_mfma_f32_16x16x32_bf16 v[176:179], a[100:103], v[68:71], 0
  ds_read_b64_tr_b16 a[136:137], v19 offset:16384
L_ws100:
  s_cbranch_execz L_wa_back
  v_mfma_f32_16x16x32_bf16 v[180:183], a[100:103], v[72:75], 0
  ds_read_b64_tr_b16 a[138:139], v19 offset:20480
  v_mfma_f32_16x16x32_bf16 v[184:187], a[104:107], v[64:67], 0
  ds_read_b64_tr_b16 a[140:141], v20 offset:16384
  v_mfma_f32_16x16x32_bf16 v[188:191], a[104:107], v[68:71], 0
  ds_read_b64_tr_b16 a[142:143], v20 offset:20480
  v_mfma_f32_16x16x32_bf16 v[192:195], a[104:107], v[72:75], 0
  ds_read_b64_tr_b16 a[144:145], v21 offset:16384
  v_mfma_f32_16x16x32_bf16 v[196:199], a[108:111], v[64:67], 0
  ds_read_b64_tr_b16 a[146:147], v21 offset:20480
  v_mfma_f32_16x16x32_bf16 v[200:203], a[108:111], v[68:71], 0
  ds_read_b64_tr_b16 a[148:149], v22 offset:16384
  v_mfma_f32_16x16x32_bf16 v[204:207], a[108:111], v[72:75], 0
  ds_read_b64_tr_b16 a[150:151], v22 offset:20480
  v_mfma_f32_16x16x32_bf16 v[208:211], a[112:115], v[64:67], 0
  ds_read_b64_tr_b16 a[152:153], v23 offset:16384
  v_mfma_f32_16x16x32_bf16 v[212:215], a[112:115], v[68:71], 0
  ds_read_b64_tr_b16 a[154:155], v23 offset:20480
  buffer_load_dwordx4 v5, s[20:23], s37 offen offset:1024 nt lds
  v_mfma_f32_16x16x32_bf16 v[216:219], a[112:115], v[72:75], 0
  ds_read_b64_tr_b16 a[156:157], v24 offset:16384
  v_mfma_f32_16x16x32_bf16 v[220:223], a[116:119], v[64:67], 0
  ds_read_b64_tr_b16 a[158:159], v24 offset:20480
  v_mfma_f32_16x16x32_bf16 v[224:227], a[116:119], v[68:71], 0
  v_mfma_f32_16x16x32_bf16 v[228:231], a[116:119], v[72:75], 0
  v_mfma_f32_16x16x32_bf16 v[232:235], a[120:123], v[64:67], 0
  v_mfma_f32_16x16x32_bf16 v[236:239], a[120:123], v[68:71], 0
  v_mfma_f32_16x16x32_bf16 v[240:243], a[120:123], v[72:75], 0
  v_mfma_f32_16x16x32_bf16 v[244:247], a[124:127], v[64:67], 0
  v_mfma_f32_16x16x32_bf16 v[248:251], a[124:127], v[68:71], 0
  v_mfma_f32_16x16x32_bf16 v[252:255], a[124:127], v[72:75], 0
L_ws101:
  s_cbranch_execz L_wa_back
  s_waitcnt vmcnt(18) lgkmcnt(0)
  s_barrier
  v_mfma_f32_16x16x32_bf16 v[160:163], a[128:131], v[76:79], v[160:163]
  ds_read_b64_tr_b16 a[96:97], v17 offset:32768
  buffer_load_dwordx4 v4, s[20:23], s37 offen offset:2048 nt lds
  v_mfma_f32_16x16x32_bf16 v[164:167], a[128:131], v[80:83], v[164:167]
  ds_read_b64_tr_b16 a[98:99], v17 offset:36864
  v_mfma_f32_16x16x32_bf16 v[168:171], a[128:131], v[84:87], v[168:171]
  ds_read_b64_tr_b16 a[100:101], v18 offset:32768
  v_mfma_f32_16x16x32_bf16 v[172:175], a[132:135], v[76:79], v[172:175]
  ds_read_b64_tr_b16 a[102:103], v18 offset:36864
  v_mfma_f32_16x16x32_bf16 v[176:179], a[132:135], v[80:83], v[176:179]
  ds_read_b64_tr_b16 a[104:105], v19 offset:32768
  v_mfma_f32_16x16x32_bf16 v[180:183], a[132:135], v[84:87], v[180:183]
  ds_read_b64_tr_b16 a[106:107], v19 offset:36864
  v_mfma_f32_16x16x32_bf16 v[184:187], a[136:139], v[76:79], v[184:187]
  ds_read_b64_tr_b16 a[108:109], v20 offset:32768
  v_mfma_f32_16x16x32_bf16 v[188:191], a[136:139], v[80:83], v[188:191]
  ds_read_b64_tr_b16 a[110:111], v20 offset:36864
  v_mfma_f32_16x16x32_bf16 v[192:195], a[136:139], v[84:87], v[192:195]
  ds_read_b64_tr_b16 a[112:113], v21 offset:32768
  v_mfma_f32_16x16x32_bf16 v[196:199], a[140:143], v[76:79], v[196:199]
  ds_read_b64_tr_b16 a[114:115], v21 offset:36864
  v_mfma_f32_16x16x32_bf16 v[200:203], a[140:143], v[80:83], v[200:203]
  ds_read_b64_tr_b16 a[116:117], v22 offset:32768
  v_mfma_f32_16x16x32_bf16 v[204:207], a[140:143], v[84:87], v[204:207]
  ds_read_b64_tr_b16 a[118:119], v22 offset:36864
  v_mfma_f32_16x16x32_bf16 v[208:211], a[144:147], v[76:79], v[208:211]
  ds_read_b64_tr_b16 a[120:121], v23 offset:32768
  buffer_load_dwordx4 v5, s[20:23], s37 offen offset:3072 nt lds
  v_mfma_f32_16x16x32_bf16 v[212:215], a[144:147], v[80:83], v[212:215]
  ds_read_b64_tr_b16 a[122:123], v23 offset:36864
  v_mfma_f32_16x16x32_bf16 v[216:219], a[144:147], v[84:87], v[216:219]
L_ws102:
  s_cbranch_execz L_wa_back
  ds_read_b64_tr_b16 a[124:125], v24 offset:32768
  v_mfma_f32_16x16x32_bf16 v[220:223], a[148:151], v[76:79], v[220:223]
  ds_read_b64_tr_b16 a[126:127], v24 offset:36864
  v_mfma_f32_16x16x32_bf16 v[224:227], a[148:151], v[80:83], v[224:227]
  v_mfma_f32_16x16x32_bf16 v[228:231], a[148:151], v[84:87], v[228:231]
  v_mfma_f32_16x16x32_bf16 v[232:235], a[152:155], v[76:79], v[232:235]
  v_mfma_f32_16x16x32_bf16 v[236:239], a[152:155], v[80:83], v[236:239]
  v_mfma_f32_16x16x32_bf16 v[240:243], a[152:155], v[84:87], v[240:243]
  v_mfma_f32_16x16x32_bf16 v[244:247], a[156:159], v[76:79], v[244:247]
  v_mfma_f32_16x16x32_bf16 v[248:251], a[156:159], v[80:83], v[248:251]
  v_mfma_f32_16x16x32_bf16 v[252:255], a[156:159], v[84:87], v[252:255]
  s_waitcnt vmcnt(16) lgkmcnt(0)
  s_barrier
  v_mfma_f32_16x16x32_bf16 v[160:163], a[96:99], v[88:91], v[160:163]
  ds_read_b64_tr_b16 a[128:129], v17 offset:49152
  s_add_u32 m0, s35, 94208
  s_bfe_u32 s37, s45, 0x20009
  s_mul_i32 s37, s37, 327680
  s_bfe_u32 s47, s45, 0x10008
  s_mul_i32 s47, s47, 81920
  s_add_u32 s37, s37, s47
  s_add_u32 s37, s37, s34
  buffer_load_dwordx4 v10, s[48:51], s37 offen offset:0 lds
  v_mfma_f32_16x16x32_bf16 v[164:167], a[96:99], v[92:95], v[164:167]
  ds_read_b64_tr_b16 a[130:131], v17 offset:53248
  v_mfma_f32_16x16x32_bf16 v[168:171], a[96:99], v[96:99], v[168:171]
  ds_read_b64_tr_b16 a[132:133], v18 offset:49152
  v_mfma_f32_16x16x32_bf16 v[172:175], a[100:103], v[88:91], v[172:175]
  ds_read_b64_tr_b16 a[134:135], v18 offset:53248
  v_mfma_f32_16x16x32_bf16 v[176:179], a[100:103], v[92:95], v[176:179]
  ds_read_b64_tr_b16 a[136:137], v19 offset:49152
  v_mfma_f32_16x16x32_bf16 v[180:183], a[100:103], v[96:99], v[180:183]
  ds_read_b64_tr_b16 a[138:139], v19 offset:53248
L_ws103:
  s_cbranch_execz L_wa_back
  v_mfma_f32_16x16x32_bf16 v[184:187], a[104:107], v[88:91], v[184:187]
  ds_read_b64_tr_b16 a[140:141], v20 offset:49152
  v_mfma_f32_16x16x32_bf16 v[188:191], a[104:107], v[92:95], v[188:191]
  ds_read_b64_tr_b16 a[142:143], v20 offset:53248
  v_mfma_f32_16x16x32_bf16 v[192:195], a[104:107], v[96:99], v[192:195]
  ds_read_b64_tr_b16 a[144:145], v21 offset:49152
  v_mfma_f32_16x16x32_bf16 v[196:199], a[108:111], v[88:91], v[196:199]
  ds_read_b64_tr_b16 a[146:147], v21 offset:53248
  v_mfma_f32_16x16x32_bf16 v[200:203], a[108:111], v[92:95], v[200:203]
  ds_read_b64_tr_b16 a[148:149], v22 offset:49152
  v_mfma_f32_16x16x32_bf16 v[204:207], a[108:111], v[96:99], v[204:207]
  ds_read_b64_tr_b16 a[150:151], v22 offset:53248
  v_mfma_f32_16x16x32_bf16 v[208:211], a[112:115], v[88:91], v[208:211]
  ds_read_b64_tr_b16 a[152:153], v23 offset:49152
  buffer_load_dwordx4 v11, s[48:51], s37 offen offset:1024 lds
  v_mfma_f32_16x16x32_bf16 v[212:215], a[112:115], v[92:95], v[212:215]
  ds_read_b64_tr_b16 a[154:155], v23 offset:53248
  v_mfma_f32_16x16x32_bf16 v[216:219], a[112:115], v[96:99], v[216:219]
  ds_read_b64_tr_b16 a[156:157], v24 offset:49152
  v_mfma_f32_16x16x32_bf16 v[220:223], a[116:119], v[88:91], v[220:223]
  ds_read_b64_tr_b16 a[158:159], v24 offset:53248
  v_mfma_f32_16x16x32_bf16 v[224:227], a[116:119], v[92:95], v[224:227]
  v_mfma_f32_16x16x32_bf16 v[228:231], a[116:119], v[96:99], v[228:231]
  v_mfma_f32_16x16x32_bf16 v[232:235], a[120:123], v[88:91], v[232:235]
  v_mfma_f32_16x16x32_bf16 v[236:239], a[120:123], v[92:95], v[236:239]
  v_mfma_f32_16x16x32_bf16 v[240:243], a[120:123], v[96:99], v[240:243]
  v_mfma_f32_16x16x32_bf16 v[244:247], a[124:127], v[88:91], v[244:247]
  v_mfma_f32_16x16x32_bf16 v[248:251], a[124:127], v[92:95], v[248:251]
  v_mfma_f32_16x16x32_bf16 v[252:255], a[124:127], v[96:99], v[252:255]
  s_waitcnt vmcnt(14) lgkmcnt(0)
  s_barrier
  v_add_u32 v17, 0x10000, v17
  v_add_u32 v18, 0x10000, v18
L_ws104:
  s_cbranch_execz L_wa_back
  v_add_u32 v19, 0x10000, v19
  v_add_u32 v20, 0x10000, v20
  v_add_u32 v21, 0x10000, v21
  v_add_u32 v22, 0x10000, v22
  v_add_u32 v23, 0x10000, v23
  v_add_u32 v24, 0x10000, v24
  v_mfma_f32_16x16x32_bf16 v[160:163], a[128:131], v[100:103], v[160:163]
  ds_read_b64_tr_b16 a[96:97], v17 offset:0
  buffer_load_dwordx4 v12, s[48:51], s37 offen offset:2048 lds
  v_mfma_f32_16x16x32_bf16 v[164:167], a[128:131], v[104:107], v[164:167]
  ds_read_b64_tr_b16 a[98:99], v17 offset:4096
  v_mfma_f32_16x16x32_bf16 v[168:171], a[128:131], v[108:111], v[168:171]
  ds_read_b64_tr_b16 a[100:101], v18 offset:0
  v_mfma_f32_16x16x32_bf16 v[172:175], a[132:135], v[100:103], v[172:175]
  ds_read_b64_tr_b16 a[102:103], v18 offset:4096
  v_mfma_f32_16x16x32_bf16 v[176:179], a[132:135], v[104:107], v[176:179]
  ds_read_b64_tr_b16 a[104:105], v19 offset:0
  v_mfma_f32_16x16x32_bf16 v[180:183], a[132:135], v[108:111], v[180:183]
  ds_read_b64_tr_b16 a[106:107], v19 offset:4096
  v_mfma_f32_16x16x32_bf16 v[184:187], a[136:139], v[100:103], v[184:187]
  ds_read_b64_tr_b16 a[108:109], v20 offset:0
  v_mfma_f32_16x16x32_bf16 v[188:191], a[136:139], v[104:107], v[188:191]
  ds_read_b64_tr_b16 a[110:111], v20 offset:4096
  v_mfma_f32_16x16x32_bf16 v[192:195], a[136:139], v[108:111], v[192:195]
  ds_read_b64_tr_b16 a[112:113], v21 offset:0
  v_mfma_f32_16x16x32_bf16 v[196:199], a[140:143], v[100:103], v[196:199]
  ds_read_b64_tr_b16 a[114:115], v21 offset:4096
  v_mfma_f32_16x16x32_bf16 v[200:203], a[140:143], v[104:107], v[200:203]
  ds_read_b64_tr_b16 a[116:117], v22 offset:0
  v_mfma_f32_16x16x32_bf16 v[204:207], a[140:143], v[108:111], v[204:207]
  ds_read_b64_tr_b16 a[118:119], v22 offset:4096
L_ws105:
  s_cbranch_execz L_wa_back
  buffer_load_dwordx4 v25, s[48:51], s37 offen offset:3072 lds
  v_mfma_f32_16x16x32_bf16 v[208:211], a[144:147], v[100:103], v[208:211]
  ds_read_b64_tr_b16 a[120:121], v23 offset:0
  v_mfma_f32_16x16x32_bf16 v[212:215], a[144:147], v[104:107], v[212:215]
  ds_read_b64_tr_b16 a[122:123], v23 offset:4096
  v_mfma_f32_16x16x32_bf16 v[216:219], a[144:147], v[108:111], v[216:219]
  ds_read_b64_tr_b16 a[124:125], v24 offset:0
  v_mfma_f32_16x16x32_bf16 v[220:223], a[148:151], v[100:103], v[220:223]
  ds_read_b64_tr_b16 a[126:127], v24 offset:4096
  v_mfma_f32_16x16x32_bf16 v[224:227], a[148:151], v[104:107], v[224:227]
  v_mfma_f32_16x16x32_bf16 v[228:231], a[148:151], v[108:111], v[228:231]
  v_mfma_f32_16x16x32_bf16 v[232:235], a[152:155], v[100:103], v[232:235]
  v_mfma_f32_16x16x32_bf16 v[236:239], a[152:155], v[104:107], v[236:239]
  v_mfma_f32_16x16x32_bf16 v[240:243], a[152:155], v[108:111], v[240:243]
  v_mfma_f32_16x16x32_bf16 v[244:247], a[156:159], v[100:103], v[244:247]
  v_mfma_f32_16x16x32_bf16 v[248:251], a[156:159], v[104:107], v[248:251]
  v_mfma_f32_16x16x32_bf16 v[252:255], a[156:159], v[108:111], v[252:255]
  s_waitcnt vmcnt(12) lgkmcnt(0)
  s_barrier
  v_mfma_f32_16x16x32_bf16 v[160:163], a[96:99], v[112:115], v[160:163]
  ds_read_b64_tr_b16 a[128:129], v17 offset:49152
  s_add_u32 m0, m0, 4096
  s_nop 0
  buffer_load_dwordx4 v26, s[48:51], s37 offen offset:0 lds
  v_mfma_f32_16x16x32_bf16 v[164:167], a[96:99], v[116:119], v[164:167]
  ds_read_b64_tr_b16 a[130:131], v17 offset:53248
  v_mfma_f32_16x16x32_bf16 v[168:171], a[96:99], v[120:123], v[168:171]
  ds_read_b64_tr_b16 a[132:133], v18 offset:49152
  v_mfma_f32_16x16x32_bf16 v[172:175], a[100:103], v[112:115], v[172:175]
  ds_read_b64_tr_b16 a[134:135], v18 offset:53248
  v_mfma_f32_16x16x32_bf16 v[176:179], a[100:103], v[116:119], v[176:179]
  ds_read_b64_tr_b16 a[136:137], v19 offset:49152
  v_mfma_f32_16x16x32_bf16 v[180:183], a[100:103], v[120:123], v[180:183]
L_ws106:
  s_cbranch_execz L_wa_back
  ds_read_b64_tr_b16 a[138:139], v19 offset:53248
  v_mfma_f32_16x16x32_bf16 v[184:187], a[104:107], v[112:115], v[184:187]
  ds_read_b64_tr_b16 a[140:141], v20 offset:49152
  v_mfma_f32_16x16x32_bf16 v[188:191], a[104:107], v[116:119], v[188:191]
  ds_read_b64_tr_b16 a[142:143], v20 offset:53248
  v_mfma_f32_16x16x32_bf16 v[192:195], a[104:107], v[120:123], v[192:195]
  ds_read_b64_tr_b16 a[144:145], v21 offset:49152
  v_mfma_f32_16x16x32_bf16 v[196:199], a[108:111], v[112:115], v[196:199]
  ds_read_b64_tr_b16 a[146:147], v21 offset:53248
  v_mfma_f32_16x16x32_bf16 v[200:203], a[108:111], v[116:119], v[200:203]
  ds_read_b64_tr_b16 a[148:149], v22 offset:49152
  v_mfma_f32_16x16x32_bf16 v[204:207], a[108:111], v[120:123], v[204:207]
  ds_read_b64_tr_b16 a[150:151], v22 offset:53248
  s_add_u32 m0, s39, 0xffff4000
  s_bfe_u32 s37, s45, 0x30008
  s_mul_i32 s37, s37, 12288
  s_add_u32 s37, s37, s44
  buffer_load_dwordx4 v27, s[24:27], s37 offen offset:0 sc1 lds
  v_mfma_f32_16x16x32_bf16 v[208:211], a[112:115], v[112:115], v[208:211]
  ds_read_b64_tr_b16 a[152:153], v23 offset:49152
  v_mfma_f32_16x16x32_bf16 v[212:215], a[112:115], v[116:119], v[212:215]
  ds_read_b64_tr_b16 a[154:155], v23 offset:53248
  v_mfma_f32_16x16x32_bf16 v[216:219], a[112:115], v[120:123], v[216:219]
  ds_read_b64_tr_b16 a[156:157], v24 offset:49152
  v_mfma_f32_16x16x32_bf16 v[220:223], a[116:119], v[112:115], v[220:223]
  ds_read_b64_tr_b16 a[158:159], v24 offset:53248
  v_mfma_f32_16x16x32_bf16 v[224:227], a[116:119], v[116:119], v[224:227]
  ds_write_b128 v30, v[52:55]
  v_mfma_f32_16x16x32_bf16 v[228:231], a[116:119], v[120:123], v[228:231]
  ds_write_b64 v30, v[56:57] offset:1024
  v_mfma_f32_16x16x32_bf16 v[232:235], a[120:123], v[112:115], v[232:235]
  v_mfma_f32_16x16x32_bf16 v[236:239], a[120:123], v[116:119], v[236:239]
L_ws107:
  s_cbranch_execz L_wa_back
  v_mfma_f32_16x16x32_bf16 v[240:243], a[120:123], v[120:123], v[240:243]
  v_mfma_f32_16x16x32_bf16 v[244:247], a[124:127], v[112:115], v[244:247]
  v_mfma_f32_16x16x32_bf16 v[248:251], a[124:127], v[116:119], v[248:251]
  v_mfma_f32_16x16x32_bf16 v[252:255], a[124:127], v[120:123], v[252:255]
  s_waitcnt vmcnt(10) lgkmcnt(0)
  s_barrier
  v_add_u32 v17, 0x10000, v17
  v_add_u32 v18, 0x10000, v18
  v_add_u32 v19, 0x10000, v19
  v_add_u32 v20, 0x10000, v20
  v_add_u32 v21, 0x10000, v21
  v_add_u32 v22, 0x10000, v22
  v_add_u32 v23, 0x10000, v23
  v_add_u32 v24, 0x10000, v24
  v_mfma_f32_16x16x32_bf16 v[160:163], a[128:131], v[124:127], v[160:163]
  ds_read_b64_tr_b16 a[96:97], v17 offset:0
  buffer_load_dwordx4 v27, s[24:27], s37 offen offset:1024 sc1 lds
  v_mfma_f32_16x16x32_bf16 v[164:167], a[128:131], v[128:131], v[164:167]
  ds_read_b64_tr_b16 a[98:99], v17 offset:4096
  v_mfma_f32_16x16x32_bf16 v[168:171], a[128:131], v[132:135], v[168:171]
  ds_read_b64_tr_b16 a[100:101], v18 offset:0
  v_mfma_f32_16x16x32_bf16 v[172:175], a[132:135], v[124:127], v[172:175]
  ds_read_b64_tr_b16 a[102:103], v18 offset:4096
  v_mfma_f32_16x16x32_bf16 v[176:179], a[132:135], v[128:131], v[176:179]
  ds_read_b64_tr_b16 a[104:105], v19 offset:0
  v_mfma_f32_16x16x32_bf16 v[180:183], a[132:135], v[132:135], v[180:183]
  ds_read_b64_tr_b16 a[106:107], v19 offset:4096
  v_mfma_f32_16x16x32_bf16 v[184:187], a[136:139], v[124:127], v[184:187]
  ds_read_b64_tr_b16 a[108:109], v20 offset:0
  v_mfma_f32_16x16x32_bf16 v[188:191], a[136:139], v[128:131], v[188:191]
  ds_read_b64_tr_b16 a[110:111], v20 offset:4096
  v_mfma_f32_16x16x32_bf16 v[192:195], a[136:139], v[132:135], v[192:195]
  ds_read_b64_tr_b16 a[112:113], v21 offset:0
L_ws108:
  s_cbranch_execz L_wa_back
  v_accvgpr_read_b32 v64, a0
  v_accvgpr_read_b32 v65, a1
  v_mfma_f32_16x16x32_bf16 v[196:199], a[140:143], v[124:127], v[196:199]
  ds_read_b64_tr_b16 a[114:115], v21 offset:4096
  v_accvgpr_read_b32 v66, a2
  v_accvgpr_read_b32 v67, a3
  v_mfma_f32_16x16x32_bf16 v[200:203], a[140:143], v[128:131], v[200:203]
  ds_read_b64_tr_b16 a[116:117], v22 offset:0
  buffer_load_dwordx4 v27, s[24:27], s37 offen offset:2048 sc1 lds
  v_accvgpr_read_b32 v68, a4
  v_accvgpr_read_b32 v69, a5
  v_mfma_f32_16x16x32_bf16 v[204:207], a[140:143], v[132:135], v[204:207]
  ds_read_b64_tr_b16 a[118:119], v22 offset:4096
  v_accvgpr_read_b32 v70, a6
  v_accvgpr_read_b32 v71, a7
  v_mfma_f32_16x16x32_bf16 v[208:211], a[144:147], v[124:127], v[208:211]
  ds_read_b64_tr_b16 a[120:121], v23 offset:0
  v_accvgpr_read_b32 v72, a8
  v_accvgpr_read_b32 v73, a9
  v_mfma_f32_16x16x32_bf16 v[212:215], a[144:147], v[128:131], v[212:215]
  ds_read_b64_tr_b16 a[122:123], v23 offset:4096
  v_accvgpr_read_b32 v74, a10
  v_accvgpr_read_b32 v75, a11
  v_mfma_f32_16x16x32_bf16 v[216:219], a[144:147], v[132:135], v[216:219]
  ds_read_b64_tr_b16 a[124:125], v24 offset:0
  s_add_u32 m0, s35, 16384
  s_bfe_u32 s37, s45, 0x20001
  s_mul_i32 s37, s37, 327680
  s_bfe_u32 s47, s45, 0x10000
  s_mul_i32 s47, s47, 81920
  s_add_u32 s37, s37, s47
  s_add_u32 s37, s37, 163840
L_ws109:
  s_cbranch_execz L_wa_back
  s_add_u32 s37, s37, s34
  buffer_load_dwordx4 v10, s[48:51], s37 offen offset:0 lds
  v_accvgpr_read_b32 v76, a12
  v_accvgpr_read_b32 v77, a13
  v_mfma_f32_16x16x32_bf16 v[220:223], a[148:151], v[124:127], v[220:223]
  ds_read_b64_tr_b16 a[126:127], v24 offset:4096
  v_mfma_f32_16x16x32_bf16 v[224:227], a[148:151], v[128:131], v[224:227]
  v_xor_b32 v58, 4096, v30
  v_accvgpr_read_b32 v78, a14
  v_accvgpr_read_b32 v79, a15
  v_mfma_f32_16x16x32_bf16 v[228:231], a[148:151], v[132:135], v[228:231]
  ds_read_b128 v[52:55], v58
  v_accvgpr_read_b32 v80, a16
  v_accvgpr_read_b32 v81, a17
  v_mfma_f32_16x16x32_bf16 v[232:235], a[152:155], v[124:127], v[232:235]
  buffer_load_dwordx4 v11, s[48:51], s37 offen offset:1024 lds
  ds_read_b64 v[56:57], v58 offset:1024
  v_accvgpr_read_b32 v82, a18
  v_accvgpr_read_b32 v83, a19
  v_mfma_f32_16x16x32_bf16 v[236:239], a[152:155], v[128:131], v[236:239]
  v_accvgpr_read_b32 v84, a20
  v_accvgpr_read_b32 v85, a21
  v_mfma_f32_16x16x32_bf16 v[240:243], a[152:155], v[132:135], v[240:243]
  v_accvgpr_read_b32 v86, a22
  v_accvgpr_read_b32 v87, a23
  v_mfma_f32_16x16x32_bf16 v[244:247], a[156:159], v[124:127], v[244:247]
  v_accvgpr_read_b32 v88, a24
  v_accvgpr_read_b32 v89, a25
  v_mfma_f32_16x16x32_bf16 v[248:251], a[156:159], v[128:131], v[248:251]
  buffer_load_dwordx4 v12, s[48:51], s37 offen offset:2048 lds
  v_accvgpr_read_b32 v90, a26
  v_accvgpr_read_b32 v91, a27
L_ws110:
  s_cbranch_execz L_wa_back
  v_mfma_f32_16x16x32_bf16 v[252:255], a[156:159], v[132:135], v[252:255]
  s_waitcnt vmcnt(11) lgkmcnt(0)
  s_barrier
  v_add_u32 v17, 0xfffe0000, v17
  v_add_u32 v18, 0xfffe0000, v18
  v_add_u32 v19, 0xfffe0000, v19
  v_add_u32 v20, 0xfffe0000, v20
  v_add_u32 v21, 0xfffe0000, v21
  v_add_u32 v22, 0xfffe0000, v22
  v_add_u32 v23, 0xfffe0000, v23
  v_add_u32 v24, 0xfffe0000, v24
  v_mfma_f32_16x16x32_bf16 v[160:163], a[96:99], v[136:139], v[160:163]
  ds_read_b64_tr_b16 a[144:145], v21 offset:0
  buffer_load_dwordx4 v25, s[48:51], s37 offen offset:3072 lds
  v_max_f32 v35, v32, v52
  v_mfma_f32_16x16x32_bf16 v[164:167], a[96:99], v[140:143], v[164:167]
  ds_read_b64_tr_b16 a[146:147], v21 offset:4096
  v_max_f32 v36, v33, v53
  v_mfma_f32_16x16x32_bf16 v[168:171], a[96:99], v[144:147], v[168:171]
  ds_read_b64_tr_b16 a[148:149], v22 offset:0
  s_add_u32 m0, m0, 4096
  s_nop 0
  buffer_load_dwordx4 v26, s[48:51], s37 offen offset:0 lds
  v_max_f32 v37, v34, v54
  v_mfma_f32_16x16x32_bf16 v[172:175], a[100:103], v[136:139], v[172:175]
  ds_read_b64_tr_b16 a[150:151], v22 offset:4096
  v_sub_f32 v32, v32, v35
  v_sub_f32 v52, v52, v35
  v_mfma_f32_16x16x32_bf16 v[176:179], a[100:103], v[140:143], v[176:179]
  ds_read_b64_tr_b16 a[152:153], v23 offset:0
  v_sub_f32 v33, v33, v36
  v_sub_f32 v53, v53, v36
  v_mfma_f32_16x16x32_bf16 v[180:183], a[100:103], v[144:147], v[180:183]
  ds_read_b64_tr_b16 a[154:155], v23 offset:4096
  s_add_u32 m0, s35, 36864
  s_bfe_u32 s37, s45, 0x20005
L_ws111:
  s_cbranch_execz L_wa_back
  s_mul_i32 s37, s37, 327680
  s_bfe_u32 s47, s45, 0x10004
  s_mul_i32 s47, s47, 81920
  s_add_u32 s37, s37, s47
  s_add_u32 s37, s37, 163840
  s_add_u32 s37, s37, s34
  buffer_load_dwordx4 v10, s[48:51], s37 offen offset:0 lds
  v_sub_f32 v34, v34, v37
  v_sub_f32 v54, v54, v37
  v_mfma_f32_16x16x32_bf16 v[184:187], a[104:107], v[136:139], v[184:187]
  ds_read_b64_tr_b16 a[156:157], v24 offset:0
  v_mul_f32 v32, v44, v32
  v_mul_f32 v52, v44, v52
  v_mfma_f32_16x16x32_bf16 v[188:191], a[104:107], v[140:143], v[188:191]
  ds_read_b64_tr_b16 a[158:159], v24 offset:4096
  v_mul_f32 v33, v44, v33
  v_mul_f32 v53, v44, v53
  v_mfma_f32_16x16x32_bf16 v[192:195], a[104:107], v[144:147], v[192:195]
  ds_read_b64_tr_b16 a[128:129], v17 offset:0
  v_mul_f32 v34, v44, v34
  v_mul_f32 v54, v44, v54
  v_accvgpr_read_b32 v92, a28
  v_accvgpr_read_b32 v93, a29
  v_mfma_f32_16x16x32_bf16 v[196:199], a[108:111], v[136:139], v[196:199]
  ds_read_b64_tr_b16 a[130:131], v17 offset:4096
  buffer_load_dwordx4 v11, s[48:51], s37 offen offset:1024 lds
  v_exp_f32 v32, v32
  v_exp_f32 v52, v52
  v_accvgpr_read_b32 v94, a30
  v_accvgpr_read_b32 v95, a31
  v_mfma_f32_16x16x32_bf16 v[200:203], a[108:111], v[140:143], v[200:203]
  ds_read_b64_tr_b16 a[132:133], v18 offset:0
  v_exp_f32 v33, v33
  v_exp_f32 v53, v53
  v_accvgpr_read_b32 v96, a32
  v_accvgpr_read_b32 v97, a33
  v_mfma_f32_16x16x32_bf16 v[204:207], a[108:111], v[144:147], v[204:207]
  ds_read_b64_tr_b16 a[134:135], v18 offset:4096
  v_exp_f32 v34, v34
L_ws112:
  s_cbranch_execz L_wa_back
  v_exp_f32 v54, v54
  v_accvgpr_read_b32 v98, a34
  v_accvgpr_read_b32 v99, a35
  v_mfma_f32_16x16x32_bf16 v[208:211], a[112:115], v[136:139], v[208:211]
  ds_read_b64_tr_b16 a[136:137], v19 offset:0
  v_mul_f32 v46, v46, v32
  v_accvgpr_read_b32 v100, a36
  v_accvgpr_read_b32 v101, a37
  v_mfma_f32_16x16x32_bf16 v[212:215], a[112:115], v[140:143], v[212:215]
  ds_read_b64_tr_b16 a[138:139], v19 offset:4096
  v_mul_f32 v48, v48, v33
  v_accvgpr_read_b32 v102, a38
  v_accvgpr_read_b32 v103, a39
  v_mfma_f32_16x16x32_bf16 v[216:219], a[112:115], v[144:147], v[216:219]
  ds_read_b64_tr_b16 a[140:141], v20 offset:0
  v_mul_f32 v50, v50, v34
  v_accvgpr_read_b32 v104, a40
  v_accvgpr_read_b32 v105, a41
  v_mfma_f32_16x16x32_bf16 v[220:223], a[116:119], v[136:139], v[220:223]
  ds_read_b64_tr_b16 a[142:143], v20 offset:4096
  v_fma_f32 v46, v55, v52, v46
  v_accvgpr_read_b32 v106, a42
  v_accvgpr_read_b32 v107, a43
  v_mfma_f32_16x16x32_bf16 v[224:227], a[116:119], v[140:143], v[224:227]
  buffer_load_dwordx4 v12, s[48:51], s37 offen offset:2048 lds
  v_fma_f32 v48, v56, v53, v48
  v_accvgpr_read_b32 v108, a44
  v_accvgpr_read_b32 v109, a45
  v_mfma_f32_16x16x32_bf16 v[228:231], a[116:119], v[144:147], v[228:231]
  v_fma_f32 v50, v57, v54, v50
  v_accvgpr_read_b32 v110, a46
  v_accvgpr_read_b32 v111, a47
  v_mfma_f32_16x16x32_bf16 v[232:235], a[120:123], v[136:139], v[232:235]
  v_rcp_f32 v46, v46
L_ws113:
  s_cbranch_execz L_wa_back
  v_accvgpr_read_b32 v112, a160
  v_accvgpr_read_b32 v113, a161
  v_mfma_f32_16x16x32_bf16 v[236:239], a[120:123], v[140:143], v[236:239]
  v_rcp_f32 v48, v48
  v_accvgpr_read_b32 v114, a162
  v_accvgpr_read_b32 v115, a163
  v_mfma_f32_16x16x32_bf16 v[240:243], a[120:123], v[144:147], v[240:243]
  buffer_load_dwordx4 v25, s[48:51], s37 offen offset:3072 lds
  v_rcp_f32 v50, v50
  v_accvgpr_read_b32 v116, a164
  v_accvgpr_read_b32 v117, a165
  v_mfma_f32_16x16x32_bf16 v[244:247], a[124:127], v[136:139], v[244:247]
  v_mul_f32 v38, v46, v32
  v_mul_f32 v39, v46, v52
  v_accvgpr_read_b32 v118, a166
  v_accvgpr_read_b32 v119, a167
  v_mfma_f32_16x16x32_bf16 v[248:251], a[124:127], v[140:143], v[248:251]
  v_mul_f32 v40, v48, v33
  v_mul_f32 v41, v48, v53
  v_accvgpr_read_b32 v120, a168
  v_accvgpr_read_b32 v121, a169
  v_mfma_f32_16x16x32_bf16 v[252:255], a[124:127], v[144:147], v[252:255]
  v_mul_f32 v42, v50, v34
  v_mul_f32 v43, v50, v54
  v_accvgpr_read_b32 v122, a170
  v_accvgpr_read_b32 v123, a171
  s_waitcnt lgkmcnt(0)
  s_barrier
  v_mfma_f32_16x16x32_bf16 v[208:211], a[144:147], v[148:151], v[208:211]
  s_add_u32 m0, m0, 4096
  s_nop 0
  buffer_load_dwordx4 v26, s[48:51], s37 offen offset:0 lds
  v_mfma_f32_16x16x32_bf16 v[212:215], a[144:147], v[152:155], v[212:215]
  v_mfma_f32_16x16x32_bf16 v[216:219], a[144:147], v[156:159], v[216:219]
  s_add_u32 m0, s35, 57344
  s_bfe_u32 s37, s45, 0x2000d
  s_mul_i32 s37, s37, 327680
L_ws114:
  s_cbranch_execz L_wa_back
  s_bfe_u32 s47, s45, 0x1000c
  s_mul_i32 s47, s47, 81920
  s_add_u32 s37, s37, s47
  s_add_u32 s37, s37, s34
  buffer_load_dwordx4 v10, s[48:51], s37 offen offset:0 lds
  v_mfma_f32_16x16x32_bf16 v[220:223], a[148:151], v[148:151], v[220:223]
  v_mfma_f32_16x16x32_bf16 v[224:227], a[148:151], v[152:155], v[224:227]
  buffer_load_dwordx4 v11, s[48:51], s37 offen offset:1024 lds
  v_mfma_f32_16x16x32_bf16 v[228:231], a[148:151], v[156:159], v[228:231]
  v_mfma_f32_16x16x32_bf16 v[232:235], a[152:155], v[148:151], v[232:235]
  buffer_load_dwordx4 v12, s[48:51], s37 offen offset:2048 lds
  v_mfma_f32_16x16x32_bf16 v[236:239], a[152:155], v[152:155], v[236:239]
  v_mfma_f32_16x16x32_bf16 v[240:243], a[152:155], v[156:159], v[240:243]
  buffer_load_dwordx4 v25, s[48:51], s37 offen offset:3072 lds
  v_mfma_f32_16x16x32_bf16 v[244:247], a[156:159], v[148:151], v[244:247]
  v_mfma_f32_16x16x32_bf16 v[248:251], a[156:159], v[152:155], v[248:251]
  ds_write_b128 v28, v[208:211] offset:0
  v_mfma_f32_16x16x32_bf16 v[252:255], a[156:159], v[156:159], v[252:255]
  s_add_u32 m0, m0, 4096
  s_nop 0
  buffer_load_dwordx4 v26, s[48:51], s37 offen offset:0 lds
  ds_write_b128 v28, v[212:215] offset:1024
  v_mfma_f32_16x16x32_bf16 v[160:163], a[128:131], v[148:151], v[160:163]
  ds_write_b128 v28, v[216:219] offset:2048
  v_mfma_f32_16x16x32_bf16 v[164:167], a[128:131], v[152:155], v[164:167]
  ds_write_b128 v28, v[220:223] offset:3072
  v_mfma_f32_16x16x32_bf16 v[168:171], a[128:131], v[156:159], v[168:171]
  s_add_u32 m0, s39, 0xfffe0000
  s_bfe_u32 s37, s45, 0x3000c
  s_mul_i32 s37, s37, 12288
  s_add_u32 s37, s37, s44
  buffer_load_dwordx4 v27, s[24:27], s37 offen offset:0 sc1 lds
  ds_write_b128 v28, v[224:227] offset:4096
  v_mfma_f32_16x16x32_bf16 v[172:175], a[132:135], v[148:151], v[172:175]
L_ws115:
  s_cbranch_execz L_wa_back
  ds_write_b128 v28, v[228:231] offset:5120
  v_mfma_f32_16x16x32_bf16 v[176:179], a[132:135], v[152:155], v[176:179]
  buffer_load_dwordx4 v27, s[24:27], s37 offen offset:1024 sc1 lds
  ds_write_b128 v28, v[232:235] offset:6144
  v_mfma_f32_16x16x32_bf16 v[180:183], a[132:135], v[156:159], v[180:183]
  ds_write_b128 v28, v[236:239] offset:7168
  v_mfma_f32_16x16x32_bf16 v[184:187], a[136:139], v[148:151], v[184:187]
  ds_write_b128 v28, v[240:243] offset:8192
  v_mfma_f32_16x16x32_bf16 v[188:191], a[136:139], v[152:155], v[188:191]
  ds_write_b128 v28, v[244:247] offset:9216
  v_mfma_f32_16x16x32_bf16 v[192:195], a[136:139], v[156:159], v[192:195]
  ds_write_b128 v28, v[248:251] offset:10240
  v_mfma_f32_16x16x32_bf16 v[196:199], a[140:143], v[148:151], v[196:199]
  ds_write_b128 v28, v[252:255] offset:11264
  v_mfma_f32_16x16x32_bf16 v[200:203], a[140:143], v[152:155], v[200:203]
  buffer_load_dwordx4 v27, s[24:27], s37 offen offset:2048 sc1 lds
  v_mfma_f32_16x16x32_bf16 v[204:207], a[140:143], v[156:159], v[204:207]
  v_pk_mul_f32 v[160:161], v[160:161], v[38:39] op_sel_hi:[1,0]
  v_pk_mul_f32 v[162:163], v[162:163], v[38:39] op_sel_hi:[1,0]
  v_pk_mul_f32 v[164:165], v[164:165], v[40:41] op_sel_hi:[1,0]
  v_pk_mul_f32 v[166:167], v[166:167], v[40:41] op_sel_hi:[1,0]
  v_pk_mul_f32 v[168:169], v[168:169], v[42:43] op_sel_hi:[1,0]
  v_pk_mul_f32 v[170:171], v[170:171], v[42:43] op_sel_hi:[1,0]
  v_pk_mul_f32 v[172:173], v[172:173], v[38:39] op_sel_hi:[1,0]
  v_pk_mul_f32 v[174:175], v[174:175], v[38:39] op_sel_hi:[1,0]
  v_pk_mul_f32 v[176:177], v[176:177], v[40:41] op_sel_hi:[1,0]
  v_pk_mul_f32 v[178:179], v[178:179], v[40:41] op_sel_hi:[1,0]
  v_pk_mul_f32 v[180:181], v[180:181], v[42:43] op_sel_hi:[1,0]
  v_pk_mul_f32 v[182:183], v[182:183], v[42:43] op_sel_hi:[1,0]
  v_pk_mul_f32 v[184:185], v[184:185], v[38:39] op_sel_hi:[1,0]
  v_pk_mul_f32 v[186:187], v[186:187], v[38:39] op_sel_hi:[1,0]
L_ws116:
  s_cbranch_execz L_wa_back
  v_pk_mul_f32 v[188:189], v[188:189], v[40:41] op_sel_hi:[1,0]
  v_pk_mul_f32 v[190:191], v[190:191], v[40:41] op_sel_hi:[1,0]
  v_pk_mul_f32 v[192:193], v[192:193], v[42:43] op_sel_hi:[1,0]
  v_pk_mul_f32 v[194:195], v[194:195], v[42:43] op_sel_hi:[1,0]
  v_pk_mul_f32 v[196:197], v[196:197], v[38:39] op_sel_hi:[1,0]
  v_pk_mul_f32 v[198:199], v[198:199], v[38:39] op_sel_hi:[1,0]
  v_pk_mul_f32 v[200:201], v[200:201], v[40:41] op_sel_hi:[1,0]
  v_pk_mul_f32 v[202:203], v[202:203], v[40:41] op_sel_hi:[1,0]
  v_pk_mul_f32 v[204:205], v[204:205], v[42:43] op_sel_hi:[1,0]
  v_pk_mul_f32 v[206:207], v[206:207], v[42:43] op_sel_hi:[1,0]
  s_and_b32 s3, s45, 1
  s_mul_i32 s3, s3, 24576
  s_mul_i32 s4, s29, 12288
  s_add_u32 s4, s4, 114688
  s_add_u32 s5, s4, s3
  s_sub_u32 s4, s4, s3
  s_add_u32 s4, s4, 24576
  v_add_u32 v56, s4, v27
  v_add_u32 v57, s5, v27
  s_waitcnt vmcnt(18) lgkmcnt(0)
  s_barrier
  ds_read_b128 v[208:211], v29 offset:0
  ds_read_b128 v[212:215], v29 offset:1024
  ds_read_b128 v[216:219], v29 offset:2048
  ds_read_b128 v[220:223], v29 offset:3072
  ds_read_b128 v[224:227], v29 offset:4096
  ds_read_b128 v[228:231], v29 offset:5120
  ds_read_b128 v[232:235], v29 offset:6144
  ds_read_b128 v[236:239], v29 offset:7168
  ds_read_b128 v[240:243], v29 offset:8192
  ds_read_b128 v[244:247], v29 offset:9216
  ds_read_b128 v[248:251], v29 offset:10240
  ds_read_b128 v[252:255], v29 offset:11264
  ds_read_b128 a[212:215], v8 offset:0
  ds_read_b128 a[216:219], v8 offset:1024
L_ws117:
  s_cbranch_execz L_wa_back
  ds_read_b128 a[220:223], v8 offset:2048
  ds_read_b64_tr_b16 a[172:173], v6 offset:20480
  ds_read_b64_tr_b16 a[174:175], v6 offset:25600
  ds_read_b64_tr_b16 a[176:177], v7 offset:20512
  ds_read_b64_tr_b16 a[178:179], v7 offset:25632
  ds_read_b64_tr_b16 a[180:181], v6 offset:20544
  s_waitcnt lgkmcnt(15)
  v_pk_fma_f32 v[160:161], v[208:209], v[38:39], v[160:161] op_sel:[0,1,0] op_sel_hi:[1,1,1]
  v_pk_fma_f32 v[162:163], v[210:211], v[38:39], v[162:163] op_sel:[0,1,0] op_sel_hi:[1,1,1]
  v_pk_fma_f32 v[172:173], v[220:221], v[38:39], v[172:173] op_sel:[0,1,0] op_sel_hi:[1,1,1]
  v_pk_fma_f32 v[174:175], v[222:223], v[38:39], v[174:175] op_sel:[0,1,0] op_sel_hi:[1,1,1]
  v_cvt_pk_bf16_f32 v124, v160, v161
  v_cvt_pk_bf16_f32 v125, v162, v163
  v_cvt_pk_bf16_f32 v126, v172, v173
  v_cvt_pk_bf16_f32 v127, v174, v175
  buffer_store_dwordx4 v[124:127], v27, s[24:27], s40 offen offset:0 sc1
  ds_write_b128 v29, v[124:127] offset:0
  s_waitcnt lgkmcnt(15)
  v_pk_fma_f32 v[164:165], v[212:213], v[40:41], v[164:165] op_sel:[0,1,0] op_sel_hi:[1,1,1]
  v_pk_fma_f32 v[166:167], v[214:215], v[40:41], v[166:167] op_sel:[0,1,0] op_sel_hi:[1,1,1]
  v_pk_fma_f32 v[176:177], v[224:225], v[40:41], v[176:177] op_sel:[0,1,0] op_sel_hi:[1,1,1]
  v_pk_fma_f32 v[178:179], v[226:227], v[40:41], v[178:179] op_sel:[0,1,0] op_sel_hi:[1,1,1]
  v_cvt_pk_bf16_f32 v128, v164, v165
  v_cvt_pk_bf16_f32 v129, v166, v167
  v_cvt_pk_bf16_f32 v130, v176, v177
  v_cvt_pk_bf16_f32 v131, v178, v179
  buffer_store_dwordx4 v[128:131], v27, s[24:27], s40 offen offset:1024 sc1
  ds_write_b128 v29, v[128:131] offset:1024
  s_waitcnt lgkmcnt(15)
  v_pk_fma_f32 v[168:169], v[216:217], v[42:43], v[168:169] op_sel:[0,1,0] op_sel_hi:[1,1,1]
  v_pk_fma_f32 v[170:171], v[218:219], v[42:43], v[170:171] op_sel:[0,1,0] op_sel_hi:[1,1,1]
  v_pk_fma_f32 v[180:181], v[228:229], v[42:43], v[180:181] op_sel:[0,1,0] op_sel_hi:[1,1,1]
  v_pk_fma_f32 v[182:183], v[230:231], v[42:43], v[182:183] op_sel:[0,1,0] op_sel_hi:[1,1,1]
L_ws118:
  s_cbranch_execz L_wa_back
  v_cvt_pk_bf16_f32 v132, v168, v169
  v_cvt_pk_bf16_f32 v133, v170, v171
  v_cvt_pk_bf16_f32 v134, v180, v181
  v_cvt_pk_bf16_f32 v135, v182, v183
  buffer_store_dwordx4 v[132:135], v27, s[24:27], s40 offen offset:2048 sc1
  ds_write_b128 v29, v[132:135] offset:2048
  ds_read_b64_tr_b16 a[182:183], v6 offset:25664
  ds_read_b64_tr_b16 a[184:185], v7 offset:20576
  ds_read_b64_tr_b16 a[186:187], v7 offset:25696
  ds_read_b64_tr_b16 a[188:189], v6 offset:20608
  ds_read_b64_tr_b16 a[190:191], v6 offset:25728
  ds_read_b128 a[224:227], v8 offset:6144
  s_waitcnt lgkmcnt(15)
  v_pk_fma_f32 v[184:185], v[232:233], v[38:39], v[184:185] op_sel:[0,1,0] op_sel_hi:[1,1,1]
  v_pk_fma_f32 v[186:187], v[234:235], v[38:39], v[186:187] op_sel:[0,1,0] op_sel_hi:[1,1,1]
  v_pk_fma_f32 v[196:197], v[244:245], v[38:39], v[196:197] op_sel:[0,1,0] op_sel_hi:[1,1,1]
  v_pk_fma_f32 v[198:199], v[246:247], v[38:39], v[198:199] op_sel:[0,1,0] op_sel_hi:[1,1,1]
  v_cvt_pk_bf16_f32 v136, v184, v185
  v_cvt_pk_bf16_f32 v137, v186, v187
  v_cvt_pk_bf16_f32 v138, v196, v197
  v_cvt_pk_bf16_f32 v139, v198, v199
  buffer_store_dwordx4 v[136:139], v27, s[24:27], s41 offen offset:0 sc1
  ds_write_b128 v29, v[136:139] offset:6144
  ds_read_b128 a[228:231], v8 offset:7168
  ds_read_b128 a[232:235], v8 offset:8192
  ds_read_b64_tr_b16 a[192:193], v6 offset:30720
  ds_read_b64_tr_b16 a[194:195], v6 offset:35840
  ds_read_b64_tr_b16 a[196:197], v7 offset:30752
  ds_read_b64_tr_b16 a[198:199], v7 offset:35872
  s_waitcnt lgkmcnt(15)
  v_pk_fma_f32 v[188:189], v[236:237], v[40:41], v[188:189] op_sel:[0,1,0] op_sel_hi:[1,1,1]
  v_pk_fma_f32 v[190:191], v[238:239], v[40:41], v[190:191] op_sel:[0,1,0] op_sel_hi:[1,1,1]
  v_pk_fma_f32 v[200:201], v[248:249], v[40:41], v[200:201] op_sel:[0,1,0] op_sel_hi:[1,1,1]
L_ws119:
  s_cbranch_execz L_wa_back
  v_pk_fma_f32 v[202:203], v[250:251], v[40:41], v[202:203] op_sel:[0,1,0] op_sel_hi:[1,1,1]
  v_cvt_pk_bf16_f32 v140, v188, v189
  v_cvt_pk_bf16_f32 v141, v190, v191
  v_cvt_pk_bf16_f32 v142, v200, v201
  v_cvt_pk_bf16_f32 v143, v202, v203
  buffer_store_dwordx4 v[140:143], v27, s[24:27], s41 offen offset:1024 sc1
  ds_write_b128 v29, v[140:143] offset:7168
  ds_read_b64_tr_b16 a[200:201], v6 offset:30784
  ds_read_b64_tr_b16 a[202:203], v6 offset:35904
  ds_read_b64_tr_b16 a[204:205], v7 offset:30816
  ds_read_b64_tr_b16 a[206:207], v7 offset:35936
  ds_read_b64_tr_b16 a[208:209], v6 offset:30848
  ds_read_b64_tr_b16 a[210:211], v6 offset:35968
  s_waitcnt lgkmcnt(15)
  v_pk_fma_f32 v[192:193], v[240:241], v[42:43], v[192:193] op_sel:[0,1,0] op_sel_hi:[1,1,1]
  v_pk_fma_f32 v[194:195], v[242:243], v[42:43], v[194:195] op_sel:[0,1,0] op_sel_hi:[1,1,1]
  v_pk_fma_f32 v[204:205], v[252:253], v[42:43], v[204:205] op_sel:[0,1,0] op_sel_hi:[1,1,1]
  v_pk_fma_f32 v[206:207], v[254:255], v[42:43], v[206:207] op_sel:[0,1,0] op_sel_hi:[1,1,1]
  v_cvt_pk_bf16_f32 v144, v192, v193
  v_cvt_pk_bf16_f32 v145, v194, v195
  v_cvt_pk_bf16_f32 v146, v204, v205
  v_cvt_pk_bf16_f32 v147, v206, v207
  buffer_store_dwordx4 v[144:147], v27, s[24:27], s41 offen offset:2048 sc1
  ds_write_b128 v29, v[144:147] offset:8192
  s_waitcnt vmcnt(19) lgkmcnt(0)
  s_barrier
  v_add_u32 v6, 0xffff2000, v6
  v_add_u32 v7, 0xffff2000, v7
  v_mfma_f32_16x16x32_bf16 v[64:67], a[172:175], a[212:215], v[64:67]
  ds_read_b128 a[136:139], v56 offset:0
  s_add_u32 m0, s35, 94208
  s_bfe_u32 s37, s45, 0x20011
  s_mul_i32 s37, s37, 327680
L_ws120:
  s_cbranch_execz L_wa_back
  s_bfe_u32 s47, s45, 0x10010
  s_mul_i32 s47, s47, 81920
  s_add_u32 s37, s37, s47
  s_add_u32 s37, s37, s34
  buffer_load_dwordx4 v10, s[48:51], s37 offen offset:0 lds
  v_mfma_f32_16x16x32_bf16 v[68:71], a[172:175], a[216:219], v[68:71]
  ds_read_b128 a[140:143], v56 offset:1024
  v_mfma_f32_16x16x32_bf16 v[72:75], a[172:175], a[220:223], v[72:75]
  ds_read_b128 a[144:147], v56 offset:2048
  buffer_load_dwordx4 v11, s[48:51], s37 offen offset:1024 lds
  v_mfma_f32_16x16x32_bf16 v[76:79], a[176:179], a[212:215], v[76:79]
  ds_read_b64_tr_b16 a[96:97], v6 offset:0
  v_mfma_f32_16x16x32_bf16 v[80:83], a[176:179], a[216:219], v[80:83]
  ds_read_b64_tr_b16 a[98:99], v6 offset:5120
  buffer_load_dwordx4 v12, s[48:51], s37 offen offset:2048 lds
  v_mfma_f32_16x16x32_bf16 v[84:87], a[176:179], a[220:223], v[84:87]
  ds_read_b64_tr_b16 a[100:101], v7 offset:32
  v_mfma_f32_16x16x32_bf16 v[88:91], a[180:183], a[212:215], v[88:91]
  ds_read_b64_tr_b16 a[102:103], v7 offset:5152
  buffer_load_dwordx4 v25, s[48:51], s37 offen offset:3072 lds
  v_mfma_f32_16x16x32_bf16 v[92:95], a[180:183], a[216:219], v[92:95]
  ds_read_b64_tr_b16 a[104:105], v6 offset:64
  v_mfma_f32_16x16x32_bf16 v[96:99], a[180:183], a[220:223], v[96:99]
  ds_read_b64_tr_b16 a[106:107], v6 offset:5184
  s_add_u32 m0, m0, 4096
  s_nop 0
  buffer_load_dwordx4 v26, s[48:51], s37 offen offset:0 lds
  v_mfma_f32_16x16x32_bf16 v[100:103], a[184:187], a[212:215], v[100:103]
  ds_read_b64_tr_b16 a[108:109], v7 offset:96
  v_mfma_f32_16x16x32_bf16 v[104:107], a[184:187], a[216:219], v[104:107]
  ds_read_b64_tr_b16 a[110:111], v7 offset:5216
  s_add_u32 m0, s39, 0xffff4000
  s_bfe_u32 s37, s45, 0x30010
L_ws121:
  s_cbranch_execz L_wa_back
  s_mul_i32 s37, s37, 12288
  s_add_u32 s37, s37, s44
  buffer_load_dwordx4 v27, s[24:27], s37 offen offset:0 sc1 lds
  v_mfma_f32_16x16x32_bf16 v[108:111], a[184:187], a[220:223], v[108:111]
  ds_read_b64_tr_b16 a[112:113], v6 offset:128
  v_mfma_f32_16x16x32_bf16 v[112:115], a[188:191], a[212:215], v[112:115]
  ds_read_b64_tr_b16 a[114:115], v6 offset:5248
  buffer_load_dwordx4 v27, s[24:27], s37 offen offset:1024 sc1 lds
  v_mfma_f32_16x16x32_bf16 v[116:119], a[188:191], a[216:219], v[116:119]
  ds_read_b128 a[148:151], v56 offset:6144
  v_mfma_f32_16x16x32_bf16 v[120:123], a[188:191], a[220:223], v[120:123]
  ds_read_b128 a[152:155], v56 offset:7168
  buffer_load_dwordx4 v27, s[24:27], s37 offen offset:2048 sc1 lds
  v_mfma_f32_16x16x32_bf16 v[64:67], a[192:195], a[224:227], v[64:67]
  ds_read_b128 a[156:159], v56 offset:8192
  v_mfma_f32_16x16x32_bf16 v[68:71], a[192:195], a[228:231], v[68:71]
  ds_read_b64_tr_b16 a[116:117], v6 offset:10240
  v_mfma_f32_16x16x32_bf16 v[72:75], a[192:195], a[232:235], v[72:75]
  ds_read_b64_tr_b16 a[118:119], v6 offset:15360
  v_mfma_f32_16x16x32_bf16 v[76:79], a[196:199], a[224:227], v[76:79]
  ds_read_b64_tr_b16 a[120:121], v7 offset:10272
  v_mfma_f32_16x16x32_bf16 v[80:83], a[196:199], a[228:231], v[80:83]
  ds_read_b64_tr_b16 a[122:123], v7 offset:15392
  v_mfma_f32_16x16x32_bf16 v[84:87], a[196:199], a[232:235], v[84:87]
  ds_read_b64_tr_b16 a[124:125], v6 offset:10304
  v_mfma_f32_16x16x32_bf16 v[88:91], a[200:203], a[224:227], v[88:91]
  ds_read_b64_tr_b16 a[126:127], v6 offset:15424
  v_mfma_f32_16x16x32_bf16 v[92:95], a[200:203], a[228:231], v[92:95]
  ds_read_b64_tr_b16 a[128:129], v7 offset:10336
  v_mfma_f32_16x16x32_bf16 v[96:99], a[200:203], a[232:235], v[96:99]
  ds_read_b64_tr_b16 a[130:131], v7 offset:15456
  v_mfma_f32_16x16x32_bf16 v[100:103], a[204:207], a[224:227], v[100:103]
L_ws122:
  s_cbranch_execz L_wa_back
  ds_read_b64_tr_b16 a[132:133], v6 offset:10368
  v_mfma_f32_16x16x32_bf16 v[104:107], a[204:207], a[228:231], v[104:107]
  ds_read_b64_tr_b16 a[134:135], v6 offset:15488
  v_mfma_f32_16x16x32_bf16 v[108:111], a[204:207], a[232:235], v[108:111]
  v_mfma_f32_16x16x32_bf16 v[112:115], a[208:211], a[224:227], v[112:115]
  v_mfma_f32_16x16x32_bf16 v[116:119], a[208:211], a[228:231], v[116:119]
  v_mfma_f32_16x16x32_bf16 v[120:123], a[208:211], a[232:235], v[120:123]
  s_waitcnt vmcnt(22) lgkmcnt(0)
  s_barrier
  v_mfma_f32_16x16x32_bf16 v[64:67], a[96:99], a[136:139], v[64:67]
  ds_read_b128 a[212:215], v57 offset:0
  s_add_u32 m0, s35, 16384
  s_bfe_u32 s37, s45, 0x20015
  s_mul_i32 s37, s37, 327680
  s_bfe_u32 s47, s45, 0x10014
  s_mul_i32 s47, s47, 81920
  s_add_u32 s37, s37, s47
  s_add_u32 s37, s37, s34
  buffer_load_dwordx4 v10, s[48:51], s37 offen offset:0 lds
  v_mfma_f32_16x16x32_bf16 v[68:71], a[96:99], a[140:143], v[68:71]
  ds_read_b128 a[216:219], v57 offset:1024
  v_mfma_f32_16x16x32_bf16 v[72:75], a[96:99], a[144:147], v[72:75]
  ds_read_b128 a[220:223], v57 offset:2048
  v_mfma_f32_16x16x32_bf16 v[76:79], a[100:103], a[136:139], v[76:79]
  ds_read_b64_tr_b16 a[172:173], v6 offset:20480
  v_mfma_f32_16x16x32_bf16 v[80:83], a[100:103], a[140:143], v[80:83]
  ds_read_b64_tr_b16 a[174:175], v6 offset:25600
  buffer_load_dwordx4 v11, s[48:51], s37 offen offset:1024 lds
  v_mfma_f32_16x16x32_bf16 v[84:87], a[100:103], a[144:147], v[84:87]
  ds_read_b64_tr_b16 a[176:177], v7 offset:20512
  v_mfma_f32_16x16x32_bf16 v[88:91], a[104:107], a[136:139], v[88:91]
  ds_read_b64_tr_b16 a[178:179], v7 offset:25632
  v_mfma_f32_16x16x32_bf16 v[92:95], a[104:107], a[140:143], v[92:95]
L_ws123:
  s_cbranch_execz L_wa_back
  ds_read_b64_tr_b16 a[180:181], v6 offset:20544
  v_mfma_f32_16x16x32_bf16 v[96:99], a[104:107], a[144:147], v[96:99]
  ds_read_b64_tr_b16 a[182:183], v6 offset:25664
  buffer_load_dwordx4 v12, s[48:51], s37 offen offset:2048 lds
  v_mfma_f32_16x16x32_bf16 v[100:103], a[108:111], a[136:139], v[100:103]
  ds_read_b64_tr_b16 a[184:185], v7 offset:20576
  v_mfma_f32_16x16x32_bf16 v[104:107], a[108:111], a[140:143], v[104:107]
  ds_read_b64_tr_b16 a[186:187], v7 offset:25696
  v_mfma_f32_16x16x32_bf16 v[108:111], a[108:111], a[144:147], v[108:111]
  ds_read_b64_tr_b16 a[188:189], v6 offset:20608
  v_mfma_f32_16x16x32_bf16 v[112:115], a[112:115], a[136:139], v[112:115]
  ds_read_b64_tr_b16 a[190:191], v6 offset:25728
  buffer_load_dwordx4 v25, s[48:51], s37 offen offset:3072 lds
  v_mfma_f32_16x16x32_bf16 v[116:119], a[112:115], a[140:143], v[116:119]
  ds_read_b128 a[224:227], v57 offset:6144
  v_mfma_f32_16x16x32_bf16 v[120:123], a[112:115], a[144:147], v[120:123]
  ds_read_b128 a[228:231], v57 offset:7168
  v_mfma_f32_16x16x32_bf16 v[64:67], a[116:119], a[148:151], v[64:67]
  ds_read_b128 a[232:235], v57 offset:8192
  v_mfma_f32_16x16x32_bf16 v[68:71], a[116:119], a[152:155], v[68:71]
  ds_read_b64_tr_b16 a[192:193], v6 offset:30720
  s_add_u32 m0, m0, 4096
  s_nop 0
  buffer_load_dwordx4 v26, s[48:51], s37 offen offset:0 lds
  v_mfma_f32_16x16x32_bf16 v[72:75], a[116:119], a[156:159], v[72:75]
  ds_read_b64_tr_b16 a[194:195], v6 offset:35840
  v_mfma_f32_16x16x32_bf16 v[76:79], a[120:123], a[148:151], v[76:79]
  ds_read_b64_tr_b16 a[196:197], v7 offset:30752
  v_mfma_f32_16x16x32_bf16 v[80:83], a[120:123], a[152:155], v[80:83]
  ds_read_b64_tr_b16 a[198:199], v7 offset:35872
  v_mfma_f32_16x16x32_bf16 v[84:87], a[120:123], a[156:159], v[84:87]
  ds_read_b64_tr_b16 a[200:201], v6 offset:30784
L_ws124:
  s_cbranch_execz L_wa_back
  v_mfma_f32_16x16x32_bf16 v[88:91], a[124:127], a[148:151], v[88:91]
  ds_read_b64_tr_b16 a[202:203], v6 offset:35904
  v_mfma_f32_16x16x32_bf16 v[92:95], a[124:127], a[152:155], v[92:95]
  ds_read_b64_tr_b16 a[204:205], v7 offset:30816
  v_mfma_f32_16x16x32_bf16 v[96:99], a[124:127], a[156:159], v[96:99]
  ds_read_b64_tr_b16 a[206:207], v7 offset:35936
  v_mfma_f32_16x16x32_bf16 v[100:103], a[128:131], a[148:151], v[100:103]
  ds_read_b64_tr_b16 a[208:209], v6 offset:30848
  v_mfma_f32_16x16x32_bf16 v[104:107], a[128:131], a[152:155], v[104:107]
  ds_read_b64_tr_b16 a[210:211], v6 offset:35968
  v_mfma_f32_16x16x32_bf16 v[108:111], a[128:131], a[156:159], v[108:111]
  v_mfma_f32_16x16x32_bf16 v[112:115], a[132:135], a[148:151], v[112:115]
  v_mfma_f32_16x16x32_bf16 v[116:119], a[132:135], a[152:155], v[116:119]
  v_mfma_f32_16x16x32_bf16 v[120:123], a[132:135], a[156:159], v[120:123]
  s_waitcnt vmcnt(13) lgkmcnt(0)
  s_barrier
  v_add_u32 v8, 0xfffec000, v8
  v_mfma_f32_16x16x32_bf16 v[64:67], a[172:175], a[212:215], v[64:67]
  ds_read_b128 a[136:139], v8 offset:0
  s_add_u32 m0, s39, 0x5000
  s_bfe_u32 s37, s45, 0x30014
  s_mul_i32 s37, s37, 12288
  s_add_u32 s37, s37, s44
  buffer_load_dwordx4 v27, s[24:27], s37 offen offset:0 sc1 lds
  v_mfma_f32_16x16x32_bf16 v[68:71], a[172:175], a[216:219], v[68:71]
  ds_read_b128 a[140:143], v8 offset:1024
  v_mfma_f32_16x16x32_bf16 v[72:75], a[172:175], a[220:223], v[72:75]
  ds_read_b128 a[144:147], v8 offset:2048
  buffer_load_dwordx4 v27, s[24:27], s37 offen offset:1024 sc1 lds
  v_mfma_f32_16x16x32_bf16 v[76:79], a[176:179], a[212:215], v[76:79]
  ds_read_b64_tr_b16 a[96:97], v6 offset:40960
  v_mfma_f32_16x16x32_bf16 v[80:83], a[176:179], a[216:219], v[80:83]
  ds_read_b64_tr_b16 a[98:99], v6 offset:46080
L_ws125:
  s_cbranch_execz L_wa_back
  buffer_load_dwordx4 v27, s[24:27], s37 offen offset:2048 sc1 lds
  v_mfma_f32_16x16x32_bf16 v[84:87], a[176:179], a[220:223], v[84:87]
  ds_read_b64_tr_b16 a[100:101], v7 offset:40992
  v_mfma_f32_16x16x32_bf16 v[88:91], a[180:183], a[212:215], v[88:91]
  ds_read_b64_tr_b16 a[102:103], v7 offset:46112
  s_add_u32 m0, s35, 131072
  s_bfe_u32 s37, s45, 0x20019
  s_mul_i32 s37, s37, 327680
  s_bfe_u32 s47, s45, 0x10018
  s_mul_i32 s47, s47, 81920
  s_add_u32 s37, s37, s47
  s_add_u32 s37, s37, s34
  buffer_load_dwordx4 v10, s[48:51], s37 offen offset:0 lds
  v_mfma_f32_16x16x32_bf16 v[92:95], a[180:183], a[216:219], v[92:95]
  ds_read_b64_tr_b16 a[104:105], v6 offset:41024
  v_mfma_f32_16x16x32_bf16 v[96:99], a[180:183], a[220:223], v[96:99]
  ds_read_b64_tr_b16 a[106:107], v6 offset:46144
  buffer_load_dwordx4 v11, s[48:51], s37 offen offset:1024 lds
  v_mov_b32 v58, s60
  s_mov_b64 exec, 15
  s_cmp_eq_u32 s61, 0
  s_cbranch_scc1 L_fl1a
  buffer_store_dword v58, v59, s[24:27], s63 offen
  s_branch L_fl1b
L_fl1a:
  buffer_store_dword v58, v59, s[24:27], s63 offen sc1
L_fl1b:
  s_mov_b64 exec, -1
  s_add_u32 s63, s63, 2048
  v_mfma_f32_16x16x32_bf16 v[100:103], a[184:187], a[212:215], v[100:103]
  ds_read_b64_tr_b16 a[108:109], v7 offset:41056
  v_mfma_f32_16x16x32_bf16 v[104:107], a[184:187], a[216:219], v[104:107]
  ds_read_b64_tr_b16 a[110:111], v7 offset:46176
  buffer_load_dwordx4 v12, s[48:51], s37 offen offset:2048 lds
  v_mfma_f32_16x16x32_bf16 v[108:111], a[184:187], a[220:223], v[108:111]
  ds_read_b64_tr_b16 a[112:113], v6 offset:41088
  v_mfma_f32_16x16x32_bf16 v[112:115], a[188:191], a[212:215], v[112:115]
  ds_read_b64_tr_b16 a[114:115], v6 offset:46208
L_ws126:
  s_cbranch_execz L_wa_back
  buffer_load_dwordx4 v25, s[48:51], s37 offen offset:3072 lds
  v_mfma_f32_16x16x32_bf16 v[116:119], a[188:191], a[216:219], v[116:119]
  ds_read_b128 a[148:151], v8 offset:6144
  v_mfma_f32_16x16x32_bf16 v[120:123], a[188:191], a[220:223], v[120:123]
  ds_read_b128 a[152:155], v8 offset:7168
  s_add_u32 m0, m0, 4096
  s_nop 0
  buffer_load_dwordx4 v26, s[48:51], s37 offen offset:0 lds
  v_mfma_f32_16x16x32_bf16 v[64:67], a[192:195], a[224:227], v[64:67]
  ds_read_b128 a[156:159], v8 offset:8192
  v_mfma_f32_16x16x32_bf16 v[68:71], a[192:195], a[228:231], v[68:71]
  ds_read_b64_tr_b16 a[116:117], v6 offset:51200
  v_mfma_f32_16x16x32_bf16 v[72:75], a[192:195], a[232:235], v[72:75]
  ds_read_b64_tr_b16 a[118:119], v6 offset:56320
  v_mfma_f32_16x16x32_bf16 v[76:79], a[196:199], a[224:227], v[76:79]
  ds_read_b64_tr_b16 a[120:121], v7 offset:51232
  v_mfma_f32_16x16x32_bf16 v[80:83], a[196:199], a[228:231], v[80:83]
  ds_read_b64_tr_b16 a[122:123], v7 offset:56352
  v_mfma_f32_16x16x32_bf16 v[84:87], a[196:199], a[232:235], v[84:87]
  ds_read_b64_tr_b16 a[124:125], v6 offset:51264
  v_mfma_f32_16x16x32_bf16 v[88:91], a[200:203], a[224:227], v[88:91]
  ds_read_b64_tr_b16 a[126:127], v6 offset:56384
  v_mfma_f32_16x16x32_bf16 v[92:95], a[200:203], a[228:231], v[92:95]
  ds_read_b64_tr_b16 a[128:129], v7 offset:51296
  v_mfma_f32_16x16x32_bf16 v[96:99], a[200:203], a[232:235], v[96:99]
  ds_read_b64_tr_b16 a[130:131], v7 offset:56416
  v_mfma_f32_16x16x32_bf16 v[100:103], a[204:207], a[224:227], v[100:103]
  ds_read_b64_tr_b16 a[132:133], v6 offset:51328
  v_mfma_f32_16x16x32_bf16 v[104:107], a[204:207], a[228:231], v[104:107]
  ds_read_b64_tr_b16 a[134:135], v6 offset:56448
  v_mfma_f32_16x16x32_bf16 v[108:111], a[204:207], a[232:235], v[108:111]
  v_mfma_f32_16x16x32_bf16 v[112:115], a[208:211], a[224:227], v[112:115]
L_ws127:
  s_cbranch_execz L_wa_back
  v_mfma_f32_16x16x32_bf16 v[116:119], a[208:211], a[228:231], v[116:119]
  v_mfma_f32_16x16x32_bf16 v[120:123], a[208:211], a[232:235], v[120:123]
  s_waitcnt vmcnt(14) lgkmcnt(0)
  s_barrier
  s_bfe_u32 s46, s45, 0x20009
  s_lshl_b32 s46, s46, 6
  s_add_u32 s46, s46, s62
  s_add_u32 s46, s46, 2048
  buffer_load_dword v62, v61, s[24:27], s46 offen sc1
  v_add_u32 v6, 0x13000, v6
  v_add_u32 v7, 0x13000, v7
  v_add_u32 v8, 0x14000, v8
  v_mfma_f32_16x16x32_bf16 v[64:67], a[96:99], a[136:139], v[64:67]
  ds_read_b128 a[212:215], v8 offset:0
  s_add_u32 m0, s39, 0xffffd000
  s_bfe_u32 s37, s45, 0x30018
  s_mul_i32 s37, s37, 12288
  s_add_u32 s37, s37, s44
  buffer_load_dwordx4 v27, s[24:27], s37 offen offset:0 sc1 lds
  v_mfma_f32_16x16x32_bf16 v[68:71], a[96:99], a[140:143], v[68:71]
  ds_read_b128 a[216:219], v8 offset:1024
  v_mfma_f32_16x16x32_bf16 v[72:75], a[96:99], a[144:147], v[72:75]
  ds_read_b128 a[220:223], v8 offset:2048
  v_mfma_f32_16x16x32_bf16 v[76:79], a[100:103], a[136:139], v[76:79]
  ds_read_b64_tr_b16 a[172:173], v6 offset:0
  v_mfma_f32_16x16x32_bf16 v[80:83], a[100:103], a[140:143], v[80:83]
  ds_read_b64_tr_b16 a[174:175], v6 offset:5120
  buffer_load_dwordx4 v27, s[24:27], s37 offen offset:1024 sc1 lds
  v_mfma_f32_16x16x32_bf16 v[84:87], a[100:103], a[144:147], v[84:87]
  ds_read_b64_tr_b16 a[176:177], v7 offset:32
  v_mfma_f32_16x16x32_bf16 v[88:91], a[104:107], a[136:139], v[88:91]
  ds_read_b64_tr_b16 a[178:179], v7 offset:5152
  v_mfma_f32_16x16x32_bf16 v[92:95], a[104:107], a[140:143], v[92:95]
  ds_read_b64_tr_b16 a[180:181], v6 offset:64
L_ws128:
  s_cbranch_execz L_wb_back
  v_mfma_f32_16x16x32_bf16 v[96:99], a[104:107], a[144:147], v[96:99]
  ds_read_b64_tr_b16 a[182:183], v6 offset:5184
  buffer_load_dwordx4 v27, s[24:27], s37 offen offset:2048 sc1 lds
  v_mfma_f32_16x16x32_bf16 v[100:103], a[108:111], a[136:139], v[100:103]
  ds_read_b64_tr_b16 a[184:185], v7 offset:96
  v_mfma_f32_16x16x32_bf16 v[104:107], a[108:111], a[140:143], v[104:107]
  ds_read_b64_tr_b16 a[186:187], v7 offset:5216
  v_mfma_f32_16x16x32_bf16 v[108:111], a[108:111], a[144:147], v[108:111]
  ds_read_b64_tr_b16 a[188:189], v6 offset:128
  v_mfma_f32_16x16x32_bf16 v[112:115], a[112:115], a[136:139], v[112:115]
  ds_read_b64_tr_b16 a[190:191], v6 offset:5248
  s_add_u32 m0, s35, 36864
  s_bfe_u32 s37, s45, 0x2001d
  s_mul_i32 s37, s37, 327680
  s_bfe_u32 s47, s45, 0x1001c
  s_mul_i32 s47, s47, 81920
  s_add_u32 s37, s37, s47
  s_add_u32 s37, s37, s34
  buffer_load_dwordx4 v10, s[48:51], s37 offen offset:0 lds
  v_mfma_f32_16x16x32_bf16 v[116:119], a[112:115], a[140:143], v[116:119]
  ds_read_b128 a[224:227], v8 offset:6144
  v_mfma_f32_16x16x32_bf16 v[120:123], a[112:115], a[144:147], v[120:123]
  ds_read_b128 a[228:231], v8 offset:7168
  v_mfma_f32_16x16x32_bf16 v[64:67], a[116:119], a[148:151], v[64:67]
  ds_read_b128 a[232:235], v8 offset:8192
  v_mfma_f32_16x16x32_bf16 v[68:71], a[116:119], a[152:155], v[68:71]
  ds_read_b64_tr_b16 a[192:193], v6 offset:10240
  buffer_load_dwordx4 v11, s[48:51], s37 offen offset:1024 lds
  v_mfma_f32_16x16x32_bf16 v[72:75], a[116:119], a[156:159], v[72:75]
  ds_read_b64_tr_b16 a[194:195], v6 offset:15360
  v_mfma_f32_16x16x32_bf16 v[76:79], a[120:123], a[148:151], v[76:79]
  ds_read_b64_tr_b16 a[196:197], v7 offset:10272
L_ws129:
  s_cbranch_execz L_wb_back
  v_mfma_f32_16x16x32_bf16 v[80:83], a[120:123], a[152:155], v[80:83]
  ds_read_b64_tr_b16 a[198:199], v7 offset:15392
  v_mfma_f32_16x16x32_bf16 v[84:87], a[120:123], a[156:159], v[84:87]
  ds_read_b64_tr_b16 a[200:201], v6 offset:10304
  buffer_load_dwordx4 v12, s[48:51], s37 offen offset:2048 lds
  v_mfma_f32_16x16x32_bf16 v[88:91], a[124:127], a[148:151], v[88:91]
  ds_read_b64_tr_b16 a[202:203], v6 offset:15424
  v_mfma_f32_16x16x32_bf16 v[92:95], a[124:127], a[152:155], v[92:95]
  ds_read_b64_tr_b16 a[204:205], v7 offset:10336
  v_mfma_f32_16x16x32_bf16 v[96:99], a[124:127], a[156:159], v[96:99]
  ds_read_b64_tr_b16 a[206:207], v7 offset:15456
  v_mfma_f32_16x16x32_bf16 v[100:103], a[128:131], a[148:151], v[100:103]
  ds_read_b64_tr_b16 a[208:209], v6 offset:10368
  buffer_load_dwordx4 v25, s[48:51], s37 offen offset:3072 lds
  v_mfma_f32_16x16x32_bf16 v[104:107], a[128:131], a[152:155], v[104:107]
  ds_read_b64_tr_b16 a[210:211], v6 offset:15488
  v_mfma_f32_16x16x32_bf16 v[108:111], a[128:131], a[156:159], v[108:111]
  v_mfma_f32_16x16x32_bf16 v[112:115], a[132:135], a[148:151], v[112:115]
  v_mfma_f32_16x16x32_bf16 v[116:119], a[132:135], a[152:155], v[116:119]
  s_add_u32 m0, m0, 4096
  s_nop 0
  buffer_load_dwordx4 v26, s[48:51], s37 offen offset:0 lds
  v_mfma_f32_16x16x32_bf16 v[120:123], a[132:135], a[156:159], v[120:123]
  s_waitcnt vmcnt(15) lgkmcnt(0)
  s_barrier
  v_add_u32 v6, 0xfffed000, v6
  v_add_u32 v7, 0xfffed000, v7
  v_add_u32 v8, 0x9000, v8
  v_mfma_f32_16x16x32_bf16 v[64:67], a[172:175], a[212:215], v[64:67]
  ds_read_b128 a[136:139], v8 offset:32768
  s_add_u32 m0, s39, 0xffff1000
  s_bfe_u32 s37, s45, 0x3001c
  s_mul_i32 s37, s37, 12288
L_ws130:
  s_cbranch_execz L_wb_back
  s_add_u32 s37, s37, s44
  buffer_load_dwordx4 v27, s[24:27], s37 offen offset:0 sc1 lds
  v_mfma_f32_16x16x32_bf16 v[68:71], a[172:175], a[216:219], v[68:71]
  ds_read_b128 a[140:143], v8 offset:33792
  v_mfma_f32_16x16x32_bf16 v[72:75], a[172:175], a[220:223], v[72:75]
  ds_read_b128 a[144:147], v8 offset:34816
  v_mfma_f32_16x16x32_bf16 v[76:79], a[176:179], a[212:215], v[76:79]
  ds_read_b64_tr_b16 a[96:97], v6 offset:0
  v_mfma_f32_16x16x32_bf16 v[80:83], a[176:179], a[216:219], v[80:83]
  ds_read_b64_tr_b16 a[98:99], v6 offset:5120
  buffer_load_dwordx4 v27, s[24:27], s37 offen offset:1024 sc1 lds
  v_mfma_f32_16x16x32_bf16 v[84:87], a[176:179], a[220:223], v[84:87]
  ds_read_b64_tr_b16 a[100:101], v7 offset:32
  v_mfma_f32_16x16x32_bf16 v[88:91], a[180:183], a[212:215], v[88:91]
  ds_read_b64_tr_b16 a[102:103], v7 offset:5152
  v_mfma_f32_16x16x32_bf16 v[92:95], a[180:183], a[216:219], v[92:95]
  ds_read_b64_tr_b16 a[104:105], v6 offset:64
  v_mfma_f32_16x16x32_bf16 v[96:99], a[180:183], a[220:223], v[96:99]
  ds_read_b64_tr_b16 a[106:107], v6 offset:5184
  buffer_load_dwordx4 v27, s[24:27], s37 offen offset:2048 sc1 lds
  v_mfma_f32_16x16x32_bf16 v[100:103], a[184:187], a[212:215], v[100:103]
  ds_read_b64_tr_b16 a[108:109], v7 offset:96
  v_mfma_f32_16x16x32_bf16 v[104:107], a[184:187], a[216:219], v[104:107]
  ds_read_b64_tr_b16 a[110:111], v7 offset:5216
  v_mfma_f32_16x16x32_bf16 v[108:111], a[184:187], a[220:223], v[108:111]
  ds_read_b64_tr_b16 a[112:113], v6 offset:128
  v_mfma_f32_16x16x32_bf16 v[112:115], a[188:191], a[212:215], v[112:115]
  ds_read_b64_tr_b16 a[114:115], v6 offset:5248
  s_add_u32 m0, s35, 98304
  s_bfe_u32 s37, s45, 0x20009
  s_mul_i32 s37, s37, 327680
  s_bfe_u32 s47, s45, 0x10008
L_ws131:
  s_cbranch_execz L_wb_back
  s_mul_i32 s47, s47, 81920
  s_add_u32 s37, s37, s47
  s_add_u32 s37, s37, 163840
  s_add_u32 s37, s37, s34
  buffer_load_dwordx4 v10, s[48:51], s37 offen offset:0 lds
  v_mfma_f32_16x16x32_bf16 v[116:119], a[188:191], a[216:219], v[116:119]
  ds_read_b128 a[148:151], v8 offset:38912
  v_mfma_f32_16x16x32_bf16 v[120:123], a[188:191], a[220:223], v[120:123]
  ds_read_b128 a[152:155], v8 offset:39936
  v_mfma_f32_16x16x32_bf16 v[64:67], a[192:195], a[224:227], v[64:67]
  ds_read_b128 a[156:159], v8 offset:40960
  v_mfma_f32_16x16x32_bf16 v[68:71], a[192:195], a[228:231], v[68:71]
  ds_read_b64_tr_b16 a[116:117], v6 offset:10240
  buffer_load_dwordx4 v11, s[48:51], s37 offen offset:1024 lds
  v_mfma_f32_16x16x32_bf16 v[72:75], a[192:195], a[232:235], v[72:75]
  ds_read_b64_tr_b16 a[118:119], v6 offset:15360
  v_mfma_f32_16x16x32_bf16 v[76:79], a[196:199], a[224:227], v[76:79]
  ds_read_b64_tr_b16 a[120:121], v7 offset:10272
  v_mfma_f32_16x16x32_bf16 v[80:83], a[196:199], a[228:231], v[80:83]
  ds_read_b64_tr_b16 a[122:123], v7 offset:15392
  v_mfma_f32_16x16x32_bf16 v[84:87], a[196:199], a[232:235], v[84:87]
  ds_read_b64_tr_b16 a[124:125], v6 offset:10304
  buffer_load_dwordx4 v12, s[48:51], s37 offen offset:2048 lds
  v_mfma_f32_16x16x32_bf16 v[88:91], a[200:203], a[224:227], v[88:91]
  ds_read_b64_tr_b16 a[126:127], v6 offset:15424
  v_mfma_f32_16x16x32_bf16 v[92:95], a[200:203], a[228:231], v[92:95]
  ds_read_b64_tr_b16 a[128:129], v7 offset:10336
  v_mfma_f32_16x16x32_bf16 v[96:99], a[200:203], a[232:235], v[96:99]
  ds_read_b64_tr_b16 a[130:131], v7 offset:15456
  v_mfma_f32_16x16x32_bf16 v[100:103], a[204:207], a[224:227], v[100:103]
  ds_read_b64_tr_b16 a[132:133], v6 offset:10368
  buffer_load_dwordx4 v25, s[48:51], s37 offen offset:3072 lds
  v_mfma_f32_16x16x32_bf16 v[104:107], a[204:207], a[228:231], v[104:107]
L_ws132:
  s_cbranch_execz L_wb_back
  ds_read_b64_tr_b16 a[134:135], v6 offset:15488
  v_mfma_f32_16x16x32_bf16 v[108:111], a[204:207], a[232:235], v[108:111]
  v_mfma_f32_16x16x32_bf16 v[112:115], a[208:211], a[224:227], v[112:115]
  v_mfma_f32_16x16x32_bf16 v[116:119], a[208:211], a[228:231], v[116:119]
  s_add_u32 m0, m0, 4096
  s_nop 0
  buffer_load_dwordx4 v26, s[48:51], s37 offen offset:0 lds
  v_mfma_f32_16x16x32_bf16 v[120:123], a[208:211], a[232:235], v[120:123]
  s_waitcnt vmcnt(13) lgkmcnt(0)
  v_cmp_ne_u32 vcc, s60, v62
  s_cbranch_vccnz L_slow_o11
L_back_o11:
  s_barrier
  s_bfe_u32 s46, s45, 0x20011
  s_lshl_b32 s46, s46, 6
  s_add_u32 s46, s46, s62
  s_add_u32 s46, s46, 2048
  buffer_load_dword v62, v61, s[24:27], s46 offen sc1
  v_add_u32 v6, 0x1c000, v6
  v_add_u32 v7, 0x1c000, v7
  v_mfma_f32_16x16x32_bf16 v[64:67], a[96:99], a[136:139], v[64:67]
  ds_read_b128 a[212:215], v8 offset:0
  s_add_u32 m0, s39, 0x5000
  s_bfe_u32 s37, s45, 0x30008
  s_mul_i32 s37, s37, 12288
  s_add_u32 s37, s37, 98304
  s_add_u32 s37, s37, s44
  buffer_load_dwordx4 v27, s[24:27], s37 offen offset:0 sc1 lds
  v_mfma_f32_16x16x32_bf16 v[68:71], a[96:99], a[140:143], v[68:71]
  ds_read_b128 a[216:219], v8 offset:1024
  v_mfma_f32_16x16x32_bf16 v[72:75], a[96:99], a[144:147], v[72:75]
  ds_read_b128 a[220:223], v8 offset:2048
  v_mfma_f32_16x16x32_bf16 v[76:79], a[100:103], a[136:139], v[76:79]
  ds_read_b64_tr_b16 a[172:173], v6 offset:0
  v_mfma_f32_16x16x32_bf16 v[80:83], a[100:103], a[140:143], v[80:83]
  ds_read_b64_tr_b16 a[174:175], v6 offset:5120
L_ws133:
  s_cbranch_execz L_wb_back
  buffer_load_dwordx4 v27, s[24:27], s37 offen offset:1024 sc1 lds
  v_mfma_f32_16x16x32_bf16 v[84:87], a[100:103], a[144:147], v[84:87]
  ds_read_b64_tr_b16 a[176:177], v7 offset:32
  v_mfma_f32_16x16x32_bf16 v[88:91], a[104:107], a[136:139], v[88:91]
  ds_read_b64_tr_b16 a[178:179], v7 offset:5152
  v_mfma_f32_16x16x32_bf16 v[92:95], a[104:107], a[140:143], v[92:95]
  ds_read_b64_tr_b16 a[180:181], v6 offset:64
  v_mfma_f32_16x16x32_bf16 v[96:99], a[104:107], a[144:147], v[96:99]
  ds_read_b64_tr_b16 a[182:183], v6 offset:5184
  buffer_load_dwordx4 v27, s[24:27], s37 offen offset:2048 sc1 lds
  v_mfma_f32_16x16x32_bf16 v[100:103], a[108:111], a[136:139], v[100:103]
  ds_read_b64_tr_b16 a[184:185], v7 offset:96
  v_mfma_f32_16x16x32_bf16 v[104:107], a[108:111], a[140:143], v[104:107]
  ds_read_b64_tr_b16 a[186:187], v7 offset:5216
  v_mfma_f32_16x16x32_bf16 v[108:111], a[108:111], a[144:147], v[108:111]
  ds_read_b64_tr_b16 a[188:189], v6 offset:128
  v_mfma_f32_16x16x32_bf16 v[112:115], a[112:115], a[136:139], v[112:115]
  ds_read_b64_tr_b16 a[190:191], v6 offset:5248
  s_add_u32 m0, s35, 16384
  s_bfe_u32 s37, s45, 0x2000d
  s_mul_i32 s37, s37, 327680
  s_bfe_u32 s47, s45, 0x1000c
  s_mul_i32 s47, s47, 81920
  s_add_u32 s37, s37, s47
  s_add_u32 s37, s37, 163840
  s_add_u32 s37, s37, s34
  buffer_load_dwordx4 v10, s[48:51], s37 offen offset:0 lds
  v_mfma_f32_16x16x32_bf16 v[116:119], a[112:115], a[140:143], v[116:119]
  ds_read_b128 a[224:227], v8 offset:6144
  v_mfma_f32_16x16x32_bf16 v[120:123], a[112:115], a[144:147], v[120:123]
  ds_read_b128 a[228:231], v8 offset:7168
  v_mfma_f32_16x16x32_bf16 v[64:67], a[116:119], a[148:151], v[64:67]
  ds_read_b128 a[232:235], v8 offset:8192
L_ws134:
  s_cbranch_execz L_wb_back
  v_mfma_f32_16x16x32_bf16 v[68:71], a[116:119], a[152:155], v[68:71]
  ds_read_b64_tr_b16 a[192:193], v6 offset:10240
  buffer_load_dwordx4 v11, s[48:51], s37 offen offset:1024 lds
  v_mfma_f32_16x16x32_bf16 v[72:75], a[116:119], a[156:159], v[72:75]
  ds_read_b64_tr_b16 a[194:195], v6 offset:15360
  v_mfma_f32_16x16x32_bf16 v[76:79], a[120:123], a[148:151], v[76:79]
  ds_read_b64_tr_b16 a[196:197], v7 offset:10272
  v_mfma_f32_16x16x32_bf16 v[80:83], a[120:123], a[152:155], v[80:83]
  ds_read_b64_tr_b16 a[198:199], v7 offset:15392
  v_mfma_f32_16x16x32_bf16 v[84:87], a[120:123], a[156:159], v[84:87]
  ds_read_b64_tr_b16 a[200:201], v6 offset:10304
  buffer_load_dwordx4 v12, s[48:51], s37 offen offset:2048 lds
  v_mfma_f32_16x16x32_bf16 v[88:91], a[124:127], a[148:151], v[88:91]
  ds_read_b64_tr_b16 a[202:203], v6 offset:15424
  v_mfma_f32_16x16x32_bf16 v[92:95], a[124:127], a[152:155], v[92:95]
  ds_read_b64_tr_b16 a[204:205], v7 offset:10336
  v_mfma_f32_16x16x32_bf16 v[96:99], a[124:127], a[156:159], v[96:99]
  ds_read_b64_tr_b16 a[206:207], v7 offset:15456
  v_mfma_f32_16x16x32_bf16 v[100:103], a[128:131], a[148:151], v[100:103]
  ds_read_b64_tr_b16 a[208:209], v6 offset:10368
  buffer_load_dwordx4 v25, s[48:51], s37 offen offset:3072 lds
  v_mfma_f32_16x16x32_bf16 v[104:107], a[128:131], a[152:155], v[104:107]
  ds_read_b64_tr_b16 a[210:211], v6 offset:15488
  v_mfma_f32_16x16x32_bf16 v[108:111], a[128:131], a[156:159], v[108:111]
  v_mfma_f32_16x16x32_bf16 v[112:115], a[132:135], a[148:151], v[112:115]
  v_mfma_f32_16x16x32_bf16 v[116:119], a[132:135], a[152:155], v[116:119]
  s_add_u32 m0, m0, 4096
  s_nop 0
  buffer_load_dwordx4 v26, s[48:51], s37 offen offset:0 lds
  v_mfma_f32_16x16x32_bf16 v[120:123], a[132:135], a[156:159], v[120:123]
  s_waitcnt vmcnt(14) lgkmcnt(0)
  s_barrier
  v_add_u32 v6, 0xfffe9000, v6
L_ws135:
  s_cbranch_execz L_wb_back
  v_add_u32 v7, 0xfffe9000, v7
  v_add_u32 v8, 0xffff4000, v8
  v_mfma_f32_16x16x32_bf16 v[64:67], a[172:175], a[212:215], v[64:67]
  ds_read_b128 a[136:139], v8 offset:0
  s_add_u32 m0, s39, 0xffff5000
  s_bfe_u32 s37, s45, 0x3000c
  s_mul_i32 s37, s37, 12288
  s_add_u32 s37, s37, 98304
  s_add_u32 s37, s37, s44
  buffer_load_dwordx4 v27, s[24:27], s37 offen offset:0 sc1 lds
  v_mfma_f32_16x16x32_bf16 v[68:71], a[172:175], a[216:219], v[68:71]
  ds_read_b128 a[140:143], v8 offset:1024
  v_mfma_f32_16x16x32_bf16 v[72:75], a[172:175], a[220:223], v[72:75]
  ds_read_b128 a[144:147], v8 offset:2048
  v_mfma_f32_16x16x32_bf16 v[76:79], a[176:179], a[212:215], v[76:79]
  ds_read_b64_tr_b16 a[96:97], v6 offset:0
  v_mfma_f32_16x16x32_bf16 v[80:83], a[176:179], a[216:219], v[80:83]
  ds_read_b64_tr_b16 a[98:99], v6 offset:5120
  buffer_load_dwordx4 v27, s[24:27], s37 offen offset:1024 sc1 lds
  v_mfma_f32_16x16x32_bf16 v[84:87], a[176:179], a[220:223], v[84:87]
  ds_read_b64_tr_b16 a[100:101], v7 offset:32
  v_mfma_f32_16x16x32_bf16 v[88:91], a[180:183], a[212:215], v[88:91]
  ds_read_b64_tr_b16 a[102:103], v7 offset:5152
  v_mfma_f32_16x16x32_bf16 v[92:95], a[180:183], a[216:219], v[92:95]
  ds_read_b64_tr_b16 a[104:105], v6 offset:64
  v_mfma_f32_16x16x32_bf16 v[96:99], a[180:183], a[220:223], v[96:99]
  ds_read_b64_tr_b16 a[106:107], v6 offset:5184
  buffer_load_dwordx4 v27, s[24:27], s37 offen offset:2048 sc1 lds
  v_mfma_f32_16x16x32_bf16 v[100:103], a[184:187], a[212:215], v[100:103]
  ds_read_b64_tr_b16 a[108:109], v7 offset:96
  v_mfma_f32_16x16x32_bf16 v[104:107], a[184:187], a[216:219], v[104:107]
  ds_read_b64_tr_b16 a[110:111], v7 offset:5216
L_ws136:
  s_cbranch_execz L_wb_back
  v_mfma_f32_16x16x32_bf16 v[108:111], a[184:187], a[220:223], v[108:111]
  ds_read_b64_tr_b16 a[112:113], v6 offset:128
  v_mfma_f32_16x16x32_bf16 v[112:115], a[188:191], a[212:215], v[112:115]
  ds_read_b64_tr_b16 a[114:115], v6 offset:5248
  s_add_u32 m0, s35, 131072
  s_bfe_u32 s37, s45, 0x20011
  s_mul_i32 s37, s37, 327680
  s_bfe_u32 s47, s45, 0x10010
  s_mul_i32 s47, s47, 81920
  s_add_u32 s37, s37, s47
  s_add_u32 s37, s37, 163840
  s_add_u32 s37, s37, s34
  buffer_load_dwordx4 v10, s[48:51], s37 offen offset:0 lds
  v_mfma_f32_16x16x32_bf16 v[116:119], a[188:191], a[216:219], v[116:119]
  ds_read_b128 a[148:151], v8 offset:6144
  v_mfma_f32_16x16x32_bf16 v[120:123], a[188:191], a[220:223], v[120:123]
  ds_read_b128 a[152:155], v8 offset:7168
  v_mfma_f32_16x16x32_bf16 v[64:67], a[192:195], a[224:227], v[64:67]
  ds_read_b128 a[156:159], v8 offset:8192
  v_mfma_f32_16x16x32_bf16 v[68:71], a[192:195], a[228:231], v[68:71]
  ds_read_b64_tr_b16 a[116:117], v6 offset:10240
  buffer_load_dwordx4 v11, s[48:51], s37 offen offset:1024 lds
  v_mfma_f32_16x16x32_bf16 v[72:75], a[192:195], a[232:235], v[72:75]
  ds_read_b64_tr_b16 a[118:119], v6 offset:15360
  v_mfma_f32_16x16x32_bf16 v[76:79], a[196:199], a[224:227], v[76:79]
  ds_read_b64_tr_b16 a[120:121], v7 offset:10272
  v_mfma_f32_16x16x32_bf16 v[80:83], a[196:199], a[228:231], v[80:83]
  ds_read_b64_tr_b16 a[122:123], v7 offset:15392
  v_mfma_f32_16x16x32_bf16 v[84:87], a[196:199], a[232:235], v[84:87]
  ds_read_b64_tr_b16 a[124:125], v6 offset:10304
  buffer_load_dwordx4 v12, s[48:51], s37 offen offset:2048 lds
  v_mfma_f32_16x16x32_bf16 v[88:91], a[200:203], a[224:227], v[88:91]
L_ws137:
  s_cbranch_execz L_wb_back
  ds_read_b64_tr_b16 a[126:127], v6 offset:15424
  v_mfma_f32_16x16x32_bf16 v[92:95], a[200:203], a[228:231], v[92:95]
  ds_read_b64_tr_b16 a[128:129], v7 offset:10336
  v_mfma_f32_16x16x32_bf16 v[96:99], a[200:203], a[232:235], v[96:99]
  ds_read_b64_tr_b16 a[130:131], v7 offset:15456
  v_mfma_f32_16x16x32_bf16 v[100:103], a[204:207], a[224:227], v[100:103]
  ds_read_b64_tr_b16 a[132:133], v6 offset:10368
  buffer_load_dwordx4 v25, s[48:51], s37 offen offset:3072 lds
  v_mfma_f32_16x16x32_bf16 v[104:107], a[204:207], a[228:231], v[104:107]
  ds_read_b64_tr_b16 a[134:135], v6 offset:15488
  v_mfma_f32_16x16x32_bf16 v[108:111], a[204:207], a[232:235], v[108:111]
  v_mfma_f32_16x16x32_bf16 v[112:115], a[208:211], a[224:227], v[112:115]
  v_mfma_f32_16x16x32_bf16 v[116:119], a[208:211], a[228:231], v[116:119]
  s_add_u32 m0, m0, 4096
  s_nop 0
  buffer_load_dwordx4 v26, s[48:51], s37 offen offset:0 lds
  v_mfma_f32_16x16x32_bf16 v[120:123], a[208:211], a[232:235], v[120:123]
  s_waitcnt vmcnt(13) lgkmcnt(0)
  v_cmp_ne_u32 vcc, s60, v62
  s_cbranch_vccnz L_slow_o12
L_back_o12:
  s_barrier
  s_bfe_u32 s46, s45, 0x20019
  s_lshl_b32 s46, s46, 6
  s_add_u32 s46, s46, s62
  s_add_u32 s46, s46, 2048
  buffer_load_dword v62, v61, s[24:27], s46 offen sc1
  v_add_u32 v6, 0xf000, v6
  v_add_u32 v7, 0xf000, v7
  v_add_u32 v8, 0x14000, v8
  v_mfma_f32_16x16x32_bf16 v[64:67], a[96:99], a[136:139], v[64:67]
  ds_read_b128 a[212:215], v8 offset:0
  s_add_u32 m0, s39, 0xffffd000
  s_bfe_u32 s37, s45, 0x30010
  s_mul_i32 s37, s37, 12288
  s_add_u32 s37, s37, 98304
L_ws138:
  s_cbranch_execz L_wb_back
  s_add_u32 s37, s37, s44
  buffer_load_dwordx4 v27, s[24:27], s37 offen offset:0 sc1 lds
  v_mfma_f32_16x16x32_bf16 v[68:71], a[96:99], a[140:143], v[68:71]
  ds_read_b128 a[216:219], v8 offset:1024
  v_mfma_f32_16x16x32_bf16 v[72:75], a[96:99], a[144:147], v[72:75]
  ds_read_b128 a[220:223], v8 offset:2048
  v_mfma_f32_16x16x32_bf16 v[76:79], a[100:103], a[136:139], v[76:79]
  ds_read_b64_tr_b16 a[172:173], v6 offset:0
  v_mfma_f32_16x16x32_bf16 v[80:83], a[100:103], a[140:143], v[80:83]
  ds_read_b64_tr_b16 a[174:175], v6 offset:5120
  buffer_load_dwordx4 v27, s[24:27], s37 offen offset:1024 sc1 lds
  v_mfma_f32_16x16x32_bf16 v[84:87], a[100:103], a[144:147], v[84:87]
  ds_read_b64_tr_b16 a[176:177], v7 offset:32
  v_mfma_f32_16x16x32_bf16 v[88:91], a[104:107], a[136:139], v[88:91]
  ds_read_b64_tr_b16 a[178:179], v7 offset:5152
  v_mfma_f32_16x16x32_bf16 v[92:95], a[104:107], a[140:143], v[92:95]
  ds_read_b64_tr_b16 a[180:181], v6 offset:64
  v_mfma_f32_16x16x32_bf16 v[96:99], a[104:107], a[144:147], v[96:99]
  ds_read_b64_tr_b16 a[182:183], v6 offset:5184
  buffer_load_dwordx4 v27, s[24:27], s37 offen offset:2048 sc1 lds
  v_mfma_f32_16x16x32_bf16 v[100:103], a[108:111], a[136:139], v[100:103]
  ds_read_b64_tr_b16 a[184:185], v7 offset:96
  v_mfma_f32_16x16x32_bf16 v[104:107], a[108:111], a[140:143], v[104:107]
  ds_read_b64_tr_b16 a[186:187], v7 offset:5216
  v_mfma_f32_16x16x32_bf16 v[108:111], a[108:111], a[144:147], v[108:111]
  ds_read_b64_tr_b16 a[188:189], v6 offset:128
  v_mfma_f32_16x16x32_bf16 v[112:115], a[112:115], a[136:139], v[112:115]
  ds_read_b64_tr_b16 a[190:191], v6 offset:5248
  s_add_u32 m0, s35, 65536
  s_bfe_u32 s37, s45, 0x20015
  s_mul_i32 s37, s37, 327680
  s_bfe_u32 s47, s45, 0x10014
L_ws139:
  s_cbranch_execz L_wb_back
  s_mul_i32 s47, s47, 81920
  s_add_u32 s37, s37, s47
  s_add_u32 s37, s37, 163840
  s_add_u32 s37, s37, s34
  buffer_load_dwordx4 v10, s[48:51], s37 offen offset:0 lds
  v_mfma_f32_16x16x32_bf16 v[116:119], a[112:115], a[140:143], v[116:119]
  ds_read_b128 a[224:227], v8 offset:6144
  v_mfma_f32_16x16x32_bf16 v[120:123], a[112:115], a[144:147], v[120:123]
  ds_read_b128 a[228:231], v8 offset:7168
  v_mfma_f32_16x16x32_bf16 v[64:67], a[116:119], a[148:151], v[64:67]
  ds_read_b128 a[232:235], v8 offset:8192
  v_mfma_f32_16x16x32_bf16 v[68:71], a[116:119], a[152:155], v[68:71]
  ds_read_b64_tr_b16 a[192:193], v6 offset:10240
  buffer_load_dwordx4 v11, s[48:51], s37 offen offset:1024 lds
  v_mfma_f32_16x16x32_bf16 v[72:75], a[116:119], a[156:159], v[72:75]
  ds_read_b64_tr_b16 a[194:195], v6 offset:15360
  v_mfma_f32_16x16x32_bf16 v[76:79], a[120:123], a[148:151], v[76:79]
  ds_read_b64_tr_b16 a[196:197], v7 offset:10272
  v_mfma_f32_16x16x32_bf16 v[80:83], a[120:123], a[152:155], v[80:83]
  ds_read_b64_tr_b16 a[198:199], v7 offset:15392
  v_mfma_f32_16x16x32_bf16 v[84:87], a[120:123], a[156:159], v[84:87]
  ds_read_b64_tr_b16 a[200:201], v6 offset:10304
  buffer_load_dwordx4 v12, s[48:51], s37 offen offset:2048 lds
  v_mfma_f32_16x16x32_bf16 v[88:91], a[124:127], a[148:151], v[88:91]
  ds_read_b64_tr_b16 a[202:203], v6 offset:15424
  v_mfma_f32_16x16x32_bf16 v[92:95], a[124:127], a[152:155], v[92:95]
  ds_read_b64_tr_b16 a[204:205], v7 offset:10336
  v_mfma_f32_16x16x32_bf16 v[96:99], a[124:127], a[156:159], v[96:99]
  ds_read_b64_tr_b16 a[206:207], v7 offset:15456
  v_mfma_f32_16x16x32_bf16 v[100:103], a[128:131], a[148:151], v[100:103]
  ds_read_b64_tr_b16 a[208:209], v6 offset:10368
  buffer_load_dwordx4 v25, s[48:51], s37 offen offset:3072 lds
  v_mfma_f32_16x16x32_bf16 v[104:107], a[128:131], a[152:155], v[104:107]
L_ws140:
  s_cbranch_execz L_wb_back
  ds_read_b64_tr_b16 a[210:211], v6 offset:15488
  v_mfma_f32_16x16x32_bf16 v[108:111], a[128:131], a[156:159], v[108:111]
  v_mfma_f32_16x16x32_bf16 v[112:115], a[132:135], a[148:151], v[112:115]
  v_mfma_f32_16x16x32_bf16 v[116:119], a[132:135], a[152:155], v[116:119]
  s_add_u32 m0, m0, 4096
  s_nop 0
  buffer_load_dwordx4 v26, s[48:51], s37 offen offset:0 lds
  v_mfma_f32_16x16x32_bf16 v[120:123], a[132:135], a[156:159], v[120:123]
  s_waitcnt vmcnt(14) lgkmcnt(0)
  s_barrier
  v_add_u32 v6, 0xfffec000, v6
  v_add_u32 v7, 0xfffec000, v7
  v_add_u32 v8, 0xffff0000, v8
  v_mfma_f32_16x16x32_bf16 v[64:67], a[172:175], a[212:215], v[64:67]
  ds_read_b128 a[136:139], v8 offset:0
  s_add_u32 m0, s39, 0xfffed000
  s_bfe_u32 s37, s45, 0x30014
  s_mul_i32 s37, s37, 12288
  s_add_u32 s37, s37, 98304
  s_add_u32 s37, s37, s44
  buffer_load_dwordx4 v27, s[24:27], s37 offen offset:0 sc1 lds
  v_mfma_f32_16x16x32_bf16 v[68:71], a[172:175], a[216:219], v[68:71]
  ds_read_b128 a[140:143], v8 offset:1024
  v_mfma_f32_16x16x32_bf16 v[72:75], a[172:175], a[220:223], v[72:75]
  ds_read_b128 a[144:147], v8 offset:2048
  v_mfma_f32_16x16x32_bf16 v[76:79], a[176:179], a[212:215], v[76:79]
  ds_read_b64_tr_b16 a[96:97], v6 offset:0
  v_mfma_f32_16x16x32_bf16 v[80:83], a[176:179], a[216:219], v[80:83]
  ds_read_b64_tr_b16 a[98:99], v6 offset:5120
  buffer_load_dwordx4 v27, s[24:27], s37 offen offset:1024 sc1 lds
  v_mfma_f32_16x16x32_bf16 v[84:87], a[176:179], a[220:223], v[84:87]
  ds_read_b64_tr_b16 a[100:101], v7 offset:32
  v_mfma_f32_16x16x32_bf16 v[88:91], a[180:183], a[212:215], v[88:91]
L_ws141:
  s_cbranch_execz L_wb_back
  ds_read_b64_tr_b16 a[102:103], v7 offset:5152
  v_mfma_f32_16x16x32_bf16 v[92:95], a[180:183], a[216:219], v[92:95]
  ds_read_b64_tr_b16 a[104:105], v6 offset:64
  v_mfma_f32_16x16x32_bf16 v[96:99], a[180:183], a[220:223], v[96:99]
  ds_read_b64_tr_b16 a[106:107], v6 offset:5184
  buffer_load_dwordx4 v27, s[24:27], s37 offen offset:2048 sc1 lds
  v_mfma_f32_16x16x32_bf16 v[100:103], a[184:187], a[212:215], v[100:103]
  ds_read_b64_tr_b16 a[108:109], v7 offset:96
  v_mfma_f32_16x16x32_bf16 v[104:107], a[184:187], a[216:219], v[104:107]
  ds_read_b64_tr_b16 a[110:111], v7 offset:5216
  v_mfma_f32_16x16x32_bf16 v[108:111], a[184:187], a[220:223], v[108:111]
  ds_read_b64_tr_b16 a[112:113], v6 offset:128
  v_mfma_f32_16x16x32_bf16 v[112:115], a[188:191], a[212:215], v[112:115]
  ds_read_b64_tr_b16 a[114:115], v6 offset:5248
  s_add_u32 m0, s35, 98304
  s_bfe_u32 s37, s45, 0x20019
  s_mul_i32 s37, s37, 327680
  s_bfe_u32 s47, s45, 0x10018
  s_mul_i32 s47, s47, 81920
  s_add_u32 s37, s37, s47
  s_add_u32 s37, s37, 163840
  s_add_u32 s37, s37, s34
  buffer_load_dwordx4 v10, s[48:51], s37 offen offset:0 lds
  v_mfma_f32_16x16x32_bf16 v[116:119], a[188:191], a[216:219], v[116:119]
  ds_read_b128 a[148:151], v8 offset:6144
  v_mfma_f32_16x16x32_bf16 v[120:123], a[188:191], a[220:223], v[120:123]
  ds_read_b128 a[152:155], v8 offset:7168
  v_mfma_f32_16x16x32_bf16 v[64:67], a[192:195], a[224:227], v[64:67]
  ds_read_b128 a[156:159], v8 offset:8192
  v_mfma_f32_16x16x32_bf16 v[68:71], a[192:195], a[228:231], v[68:71]
  ds_read_b64_tr_b16 a[116:117], v6 offset:10240
  buffer_load_dwordx4 v11, s[48:51], s37 offen offset:1024 lds
  v_mfma_f32_16x16x32_bf16 v[72:75], a[192:195], a[232:235], v[72:75]
L_ws142:
  s_cbranch_execz L_wb_back
  ds_read_b64_tr_b16 a[118:119], v6 offset:15360
  v_mfma_f32_16x16x32_bf16 v[76:79], a[196:199], a[224:227], v[76:79]
  ds_read_b64_tr_b16 a[120:121], v7 offset:10272
  v_mfma_f32_16x16x32_bf16 v[80:83], a[196:199], a[228:231], v[80:83]
  ds_read_b64_tr_b16 a[122:123], v7 offset:15392
  v_mfma_f32_16x16x32_bf16 v[84:87], a[196:199], a[232:235], v[84:87]
  ds_read_b64_tr_b16 a[124:125], v6 offset:10304
  buffer_load_dwordx4 v12, s[48:51], s37 offen offset:2048 lds
  v_mfma_f32_16x16x32_bf16 v[88:91], a[200:203], a[224:227], v[88:91]
  ds_read_b64_tr_b16 a[126:127], v6 offset:15424
  v_mfma_f32_16x16x32_bf16 v[92:95], a[200:203], a[228:231], v[92:95]
  ds_read_b64_tr_b16 a[128:129], v7 offset:10336
  v_mfma_f32_16x16x32_bf16 v[96:99], a[200:203], a[232:235], v[96:99]
  ds_read_b64_tr_b16 a[130:131], v7 offset:15456
  v_mfma_f32_16x16x32_bf16 v[100:103], a[204:207], a[224:227], v[100:103]
  ds_read_b64_tr_b16 a[132:133], v6 offset:10368
  buffer_load_dwordx4 v25, s[48:51], s37 offen offset:3072 lds
  v_mfma_f32_16x16x32_bf16 v[104:107], a[204:207], a[228:231], v[104:107]
  ds_read_b64_tr_b16 a[134:135], v6 offset:15488
  v_mfma_f32_16x16x32_bf16 v[108:111], a[204:207], a[232:235], v[108:111]
  v_mfma_f32_16x16x32_bf16 v[112:115], a[208:211], a[224:227], v[112:115]
  v_mfma_f32_16x16x32_bf16 v[116:119], a[208:211], a[228:231], v[116:119]
  s_add_u32 m0, m0, 4096
  s_nop 0
  buffer_load_dwordx4 v26, s[48:51], s37 offen offset:0 lds
  v_mfma_f32_16x16x32_bf16 v[120:123], a[208:211], a[232:235], v[120:123]
  s_waitcnt vmcnt(13) lgkmcnt(0)
  v_cmp_ne_u32 vcc, s60, v62
  s_cbranch_vccnz L_slow_o13
L_back_o13:
  s_barrier
  v_add_u32 v6, 0x1c000, v6
  v_add_u32 v7, 0x1c000, v7
  v_mfma_f32_16x16x32_bf16 v[64:67], a[96:99], a[136:139], v[64:67]
  ds_read_b128 a[212:215], v8 offset:32768
L_ws143:
  s_cbranch_execz L_wb_back
  s_add_u32 m0, s39, 0x5000
  s_bfe_u32 s37, s45, 0x30018
  s_mul_i32 s37, s37, 12288
  s_add_u32 s37, s37, 98304
  s_add_u32 s37, s37, s44
  buffer_load_dwordx4 v27, s[24:27], s37 offen offset:0 sc1 lds
  v_mfma_f32_16x16x32_bf16 v[68:71], a[96:99], a[140:143], v[68:71]
  ds_read_b128 a[216:219], v8 offset:33792
  v_mfma_f32_16x16x32_bf16 v[72:75], a[96:99], a[144:147], v[72:75]
  ds_read_b128 a[220:223], v8 offset:34816
  v_mfma_f32_16x16x32_bf16 v[76:79], a[100:103], a[136:139], v[76:79]
  ds_read_b64_tr_b16 a[172:173], v6 offset:0
  v_mfma_f32_16x16x32_bf16 v[80:83], a[100:103], a[140:143], v[80:83]
  ds_read_b64_tr_b16 a[174:175], v6 offset:5120
  buffer_load_dwordx4 v27, s[24:27], s37 offen offset:1024 sc1 lds
  v_mfma_f32_16x16x32_bf16 v[84:87], a[100:103], a[144:147], v[84:87]
  ds_read_b64_tr_b16 a[176:177], v7 offset:32
  v_mfma_f32_16x16x32_bf16 v[88:91], a[104:107], a[136:139], v[88:91]
  ds_read_b64_tr_b16 a[178:179], v7 offset:5152
  v_mfma_f32_16x16x32_bf16 v[92:95], a[104:107], a[140:143], v[92:95]
  ds_read_b64_tr_b16 a[180:181], v6 offset:64
  v_mfma_f32_16x16x32_bf16 v[96:99], a[104:107], a[144:147], v[96:99]
  ds_read_b64_tr_b16 a[182:183], v6 offset:5184
  buffer_load_dwordx4 v27, s[24:27], s37 offen offset:2048 sc1 lds
  v_mfma_f32_16x16x32_bf16 v[100:103], a[108:111], a[136:139], v[100:103]
  ds_read_b64_tr_b16 a[184:185], v7 offset:96
  v_mfma_f32_16x16x32_bf16 v[104:107], a[108:111], a[140:143], v[104:107]
  ds_read_b64_tr_b16 a[186:187], v7 offset:5216
  v_mfma_f32_16x16x32_bf16 v[108:111], a[108:111], a[144:147], v[108:111]
  ds_read_b64_tr_b16 a[188:189], v6 offset:128
  v_mfma_f32_16x16x32_bf16 v[112:115], a[112:115], a[136:139], v[112:115]
  ds_read_b64_tr_b16 a[190:191], v6 offset:5248
L_ws144:
  s_cbranch_execz L_wb_back
  s_add_u32 m0, s35, 32768
  s_bfe_u32 s37, s45, 0x2001d
  s_mul_i32 s37, s37, 327680
  s_bfe_u32 s47, s45, 0x1001c
  s_mul_i32 s47, s47, 81920
  s_add_u32 s37, s37, s47
  s_add_u32 s37, s37, 163840
  s_add_u32 s37, s37, s34
  buffer_load_dwordx4 v10, s[48:51], s37 offen offset:0 lds
  v_mfma_f32_16x16x32_bf16 v[116:119], a[112:115], a[140:143], v[116:119]
  ds_read_b128 a[224:227], v8 offset:38912
  v_mfma_f32_16x16x32_bf16 v[120:123], a[112:115], a[144:147], v[120:123]
  ds_read_b128 a[228:231], v8 offset:39936
  v_mfma_f32_16x16x32_bf16 v[64:67], a[116:119], a[148:151], v[64:67]
  ds_read_b128 a[232:235], v8 offset:40960
  v_mfma_f32_16x16x32_bf16 v[68:71], a[116:119], a[152:155], v[68:71]
  ds_read_b64_tr_b16 a[192:193], v6 offset:10240
  buffer_load_dwordx4 v11, s[48:51], s37 offen offset:1024 lds
  v_mfma_f32_16x16x32_bf16 v[72:75], a[116:119], a[156:159], v[72:75]
  ds_read_b64_tr_b16 a[194:195], v6 offset:15360
  v_mfma_f32_16x16x32_bf16 v[76:79], a[120:123], a[148:151], v[76:79]
  ds_read_b64_tr_b16 a[196:197], v7 offset:10272
  v_mfma_f32_16x16x32_bf16 v[80:83], a[120:123], a[152:155], v[80:83]
  ds_read_b64_tr_b16 a[198:199], v7 offset:15392
  v_mfma_f32_16x16x32_bf16 v[84:87], a[120:123], a[156:159], v[84:87]
  ds_read_b64_tr_b16 a[200:201], v6 offset:10304
  buffer_load_dwordx4 v12, s[48:51], s37 offen offset:2048 lds
  v_mfma_f32_16x16x32_bf16 v[88:91], a[124:127], a[148:151], v[88:91]
  ds_read_b64_tr_b16 a[202:203], v6 offset:15424
  v_mfma_f32_16x16x32_bf16 v[92:95], a[124:127], a[152:155], v[92:95]
  ds_read_b64_tr_b16 a[204:205], v7 offset:10336
  v_mfma_f32_16x16x32_bf16 v[96:99], a[124:127], a[156:159], v[96:99]
L_ws145:
  s_cbranch_execz L_wb_back
  ds_read_b64_tr_b16 a[206:207], v7 offset:15456
  v_mfma_f32_16x16x32_bf16 v[100:103], a[128:131], a[148:151], v[100:103]
  ds_read_b64_tr_b16 a[208:209], v6 offset:10368
  buffer_load_dwordx4 v25, s[48:51], s37 offen offset:3072 lds
  v_mfma_f32_16x16x32_bf16 v[104:107], a[128:131], a[152:155], v[104:107]
  ds_read_b64_tr_b16 a[210:211], v6 offset:15488
  v_mfma_f32_16x16x32_bf16 v[108:111], a[128:131], a[156:159], v[108:111]
  v_mfma_f32_16x16x32_bf16 v[112:115], a[132:135], a[148:151], v[112:115]
  v_mfma_f32_16x16x32_bf16 v[116:119], a[132:135], a[152:155], v[116:119]
  s_add_u32 m0, m0, 4096
  s_nop 0
  buffer_load_dwordx4 v26, s[48:51], s37 offen offset:0 lds
  v_mfma_f32_16x16x32_bf16 v[120:123], a[132:135], a[156:159], v[120:123]
  s_waitcnt vmcnt(13) lgkmcnt(0)
  s_barrier
  v_add_u32 v6, 0xffff0000, v6
  v_add_u32 v7, 0xffff0000, v7
  v_add_u32 v8, 0xffff8000, v8
  v_mfma_f32_16x16x32_bf16 v[64:67], a[172:175], a[212:215], v[64:67]
  ds_read_b128 a[136:139], v8 offset:0
  s_add_u32 m0, s39, 0xffff5000
  s_bfe_u32 s37, s45, 0x3001c
  s_mul_i32 s37, s37, 12288
  s_add_u32 s37, s37, 98304
  s_add_u32 s37, s37, s44
  buffer_load_dwordx4 v27, s[24:27], s37 offen offset:0 sc1 lds
  v_mfma_f32_16x16x32_bf16 v[68:71], a[172:175], a[216:219], v[68:71]
  ds_read_b128 a[140:143], v8 offset:1024
  v_mfma_f32_16x16x32_bf16 v[72:75], a[172:175], a[220:223], v[72:75]
  ds_read_b128 a[144:147], v8 offset:2048
  v_mfma_f32_16x16x32_bf16 v[76:79], a[176:179], a[212:215], v[76:79]
  ds_read_b64_tr_b16 a[96:97], v6 offset:0
  v_mfma_f32_16x16x32_bf16 v[80:83], a[176:179], a[216:219], v[80:83]
  ds_read_b64_tr_b16 a[98:99], v6 offset:5120
L_ws146:
  s_cbranch_execz L_wb_back
  buffer_load_dwordx4 v27, s[24:27], s37 offen offset:1024 sc1 lds
  v_mfma_f32_16x16x32_bf16 v[84:87], a[176:179], a[220:223], v[84:87]
  ds_read_b64_tr_b16 a[100:101], v7 offset:32
  v_mfma_f32_16x16x32_bf16 v[88:91], a[180:183], a[212:215], v[88:91]
  ds_read_b64_tr_b16 a[102:103], v7 offset:5152
  v_mfma_f32_16x16x32_bf16 v[92:95], a[180:183], a[216:219], v[92:95]
  ds_read_b64_tr_b16 a[104:105], v6 offset:64
  v_mfma_f32_16x16x32_bf16 v[96:99], a[180:183], a[220:223], v[96:99]
  ds_read_b64_tr_b16 a[106:107], v6 offset:5184
  buffer_load_dwordx4 v27, s[24:27], s37 offen offset:2048 sc1 lds
  v_mfma_f32_16x16x32_bf16 v[100:103], a[184:187], a[212:215], v[100:103]
  ds_read_b64_tr_b16 a[108:109], v7 offset:96
  v_mfma_f32_16x16x32_bf16 v[104:107], a[184:187], a[216:219], v[104:107]
  ds_read_b64_tr_b16 a[110:111], v7 offset:5216
  v_mfma_f32_16x16x32_bf16 v[108:111], a[184:187], a[220:223], v[108:111]
  ds_read_b64_tr_b16 a[112:113], v6 offset:128
  v_mfma_f32_16x16x32_bf16 v[112:115], a[188:191], a[212:215], v[112:115]
  ds_read_b64_tr_b16 a[114:115], v6 offset:5248
  v_mfma_f32_16x16x32_bf16 v[116:119], a[188:191], a[216:219], v[116:119]
  ds_read_b128 a[148:151], v8 offset:6144
  v_mfma_f32_16x16x32_bf16 v[120:123], a[188:191], a[220:223], v[120:123]
  ds_read_b128 a[152:155], v8 offset:7168
  v_mfma_f32_16x16x32_bf16 v[64:67], a[192:195], a[224:227], v[64:67]
  ds_read_b128 a[156:159], v8 offset:8192
  v_mfma_f32_16x16x32_bf16 v[68:71], a[192:195], a[228:231], v[68:71]
  ds_read_b64_tr_b16 a[116:117], v6 offset:10240
  v_mfma_f32_16x16x32_bf16 v[72:75], a[192:195], a[232:235], v[72:75]
  ds_read_b64_tr_b16 a[118:119], v6 offset:15360
  v_mfma_f32_16x16x32_bf16 v[76:79], a[196:199], a[224:227], v[76:79]
  ds_read_b64_tr_b16 a[120:121], v7 offset:10272
  v_mfma_f32_16x16x32_bf16 v[80:83], a[196:199], a[228:231], v[80:83]
L_ws147:
  s_cbranch_execz L_wb_back
  ds_read_b64_tr_b16 a[122:123], v7 offset:15392
  v_mfma_f32_16x16x32_bf16 v[84:87], a[196:199], a[232:235], v[84:87]
  ds_read_b64_tr_b16 a[124:125], v6 offset:10304
  v_mfma_f32_16x16x32_bf16 v[88:91], a[200:203], a[224:227], v[88:91]
  ds_read_b64_tr_b16 a[126:127], v6 offset:15424
  v_mfma_f32_16x16x32_bf16 v[92:95], a[200:203], a[228:231], v[92:95]
  ds_read_b64_tr_b16 a[128:129], v7 offset:10336
  v_mfma_f32_16x16x32_bf16 v[96:99], a[200:203], a[232:235], v[96:99]
  ds_read_b64_tr_b16 a[130:131], v7 offset:15456
  v_mfma_f32_16x16x32_bf16 v[100:103], a[204:207], a[224:227], v[100:103]
  ds_read_b64_tr_b16 a[132:133], v6 offset:10368
  v_mfma_f32_16x16x32_bf16 v[104:107], a[204:207], a[228:231], v[104:107]
  ds_read_b64_tr_b16 a[134:135], v6 offset:15488
  v_mfma_f32_16x16x32_bf16 v[108:111], a[204:207], a[232:235], v[108:111]
  v_mfma_f32_16x16x32_bf16 v[112:115], a[208:211], a[224:227], v[112:115]
  v_mfma_f32_16x16x32_bf16 v[116:119], a[208:211], a[228:231], v[116:119]
  v_mfma_f32_16x16x32_bf16 v[120:123], a[208:211], a[232:235], v[120:123]
  s_waitcnt vmcnt(8) lgkmcnt(0)
  s_barrier
  v_add_u32 v8, 0x18000, v8
  v_mfma_f32_16x16x32_bf16 v[64:67], a[96:99], a[136:139], v[64:67]
  ds_read_b128 a[212:215], v8 offset:0
  v_and_b32 v60, 3, v1
  v_mfma_f32_16x16x32_bf16 v[68:71], a[96:99], a[140:143], v[68:71]
  ds_read_b128 a[216:219], v8 offset:1024
  v_mfma_f32_16x16x32_bf16 v[72:75], a[96:99], a[144:147], v[72:75]
  ds_read_b128 a[220:223], v8 offset:2048
  v_mfma_f32_16x16x32_bf16 v[76:79], a[100:103], a[136:139], v[76:79]
  ds_read_b64_tr_b16 a[172:173], v6 offset:32768
  v_mfma_f32_16x16x32_bf16 v[80:83], a[100:103], a[140:143], v[80:83]
  ds_read_b64_tr_b16 a[174:175], v6 offset:37888
  v_mfma_f32_16x16x32_bf16 v[84:87], a[100:103], a[144:147], v[84:87]
  ds_read_b64_tr_b16 a[176:177], v7 offset:32800
L_ws148:
  s_cbranch_execz L_wb_back
  v_mfma_f32_16x16x32_bf16 v[88:91], a[104:107], a[136:139], v[88:91]
  ds_read_b64_tr_b16 a[178:179], v7 offset:37920
  v_mfma_f32_16x16x32_bf16 v[92:95], a[104:107], a[140:143], v[92:95]
  ds_read_b64_tr_b16 a[180:181], v6 offset:32832
  v_mfma_f32_16x16x32_bf16 v[96:99], a[104:107], a[144:147], v[96:99]
  ds_read_b64_tr_b16 a[182:183], v6 offset:37952
  v_mfma_f32_16x16x32_bf16 v[100:103], a[108:111], a[136:139], v[100:103]
  ds_read_b64_tr_b16 a[184:185], v7 offset:32864
  v_mfma_f32_16x16x32_bf16 v[104:107], a[108:111], a[140:143], v[104:107]
  ds_read_b64_tr_b16 a[186:187], v7 offset:37984
  v_mfma_f32_16x16x32_bf16 v[108:111], a[108:111], a[144:147], v[108:111]
  ds_read_b64_tr_b16 a[188:189], v6 offset:32896
  v_mfma_f32_16x16x32_bf16 v[112:115], a[112:115], a[136:139], v[112:115]
  ds_read_b64_tr_b16 a[190:191], v6 offset:38016
  v_mfma_f32_16x16x32_bf16 v[116:119], a[112:115], a[140:143], v[116:119]
  ds_read_b128 a[224:227], v8 offset:6144
  v_mfma_f32_16x16x32_bf16 v[120:123], a[112:115], a[144:147], v[120:123]
  ds_read_b128 a[228:231], v8 offset:7168
  v_mfma_f32_16x16x32_bf16 v[64:67], a[116:119], a[148:151], v[64:67]
  ds_read_b128 a[232:235], v8 offset:8192
  v_lshlrev_b32 v60, 7, v60
  v_mfma_f32_16x16x32_bf16 v[68:71], a[116:119], a[152:155], v[68:71]
  ds_read_b64_tr_b16 a[192:193], v6 offset:43008
  v_mfma_f32_16x16x32_bf16 v[72:75], a[116:119], a[156:159], v[72:75]
  ds_read_b64_tr_b16 a[194:195], v6 offset:48128
  v_mfma_f32_16x16x32_bf16 v[76:79], a[120:123], a[148:151], v[76:79]
  ds_read_b64_tr_b16 a[196:197], v7 offset:43040
  v_mfma_f32_16x16x32_bf16 v[80:83], a[120:123], a[152:155], v[80:83]
  ds_read_b64_tr_b16 a[198:199], v7 offset:48160
  v_mfma_f32_16x16x32_bf16 v[84:87], a[120:123], a[156:159], v[84:87]
  ds_read_b64_tr_b16 a[200:201], v6 offset:43072
  v_mfma_f32_16x16x32_bf16 v[88:91], a[124:127], a[148:151], v[88:91]
L_ws149:
  s_cbranch_execz L_wb_back
  ds_read_b64_tr_b16 a[202:203], v6 offset:48192
  v_mfma_f32_16x16x32_bf16 v[92:95], a[124:127], a[152:155], v[92:95]
  ds_read_b64_tr_b16 a[204:205], v7 offset:43104
  v_mfma_f32_16x16x32_bf16 v[96:99], a[124:127], a[156:159], v[96:99]
  ds_read_b64_tr_b16 a[206:207], v7 offset:48224
  v_mfma_f32_16x16x32_bf16 v[100:103], a[128:131], a[148:151], v[100:103]
  ds_read_b64_tr_b16 a[208:209], v6 offset:43136
  v_mfma_f32_16x16x32_bf16 v[104:107], a[128:131], a[152:155], v[104:107]
  ds_read_b64_tr_b16 a[210:211], v6 offset:48256
  v_mfma_f32_16x16x32_bf16 v[108:111], a[128:131], a[156:159], v[108:111]
  v_mfma_f32_16x16x32_bf16 v[112:115], a[132:135], a[148:151], v[112:115]
  v_mfma_f32_16x16x32_bf16 v[116:119], a[132:135], a[152:155], v[116:119]
  v_mfma_f32_16x16x32_bf16 v[120:123], a[132:135], a[156:159], v[120:123]
  s_waitcnt vmcnt(0) lgkmcnt(0)
  s_barrier
  v_add_u32 v6, 0xffff8000, v6
  v_add_u32 v7, 0xffff8000, v7
  v_add_u32 v8, 0xffff0000, v8
  v_mfma_f32_16x16x32_bf16 v[64:67], a[172:175], a[212:215], v[64:67]
  ds_read_b128 a[136:139], v8 offset:0
  v_mov_b32 v124, 0
  v_mfma_f32_16x16x32_bf16 v[68:71], a[172:175], a[216:219], v[68:71]
  ds_read_b128 a[140:143], v8 offset:1024
  v_mov_b32 v125, 0
  s_cmp_eq_u32 s28, 0
  s_cbranch_scc0 L_noann
  s_and_b32 s3, s2, 3
  s_lshl_b32 s3, s3, 7
  s_add_u32 s3, s3, s85
  s_mov_b64 exec, 1
  buffer_store_dword v31, off, s[24:27], s3 sc1
  s_mov_b64 exec, -1
L_noann:
  v_mfma_f32_16x16x32_bf16 v[72:75], a[172:175], a[220:223], v[72:75]
  ds_read_b128 a[144:147], v8 offset:2048
  v_mfma_f32_16x16x32_bf16 v[76:79], a[176:179], a[212:215], v[76:79]
  ds_read_b64_tr_b16 a[96:97], v6 offset:0
  v_mov_b32 v126, 0
  v_mfma_f32_16x16x32_bf16 v[80:83], a[176:179], a[216:219], v[80:83]
L_ws150:
  s_cbranch_execz L_wb_back
  ds_read_b64_tr_b16 a[98:99], v6 offset:5120
  v_mfma_f32_16x16x32_bf16 v[84:87], a[176:179], a[220:223], v[84:87]
  ds_read_b64_tr_b16 a[100:101], v7 offset:32
  v_mov_b32 v127, 0
  v_mfma_f32_16x16x32_bf16 v[88:91], a[180:183], a[212:215], v[88:91]
  ds_read_b64_tr_b16 a[102:103], v7 offset:5152
  v_mov_b32 v128, 0
  v_mfma_f32_16x16x32_bf16 v[92:95], a[180:183], a[216:219], v[92:95]
  ds_read_b64_tr_b16 a[104:105], v6 offset:64
  v_mfma_f32_16x16x32_bf16 v[96:99], a[180:183], a[220:223], v[96:99]
  ds_read_b64_tr_b16 a[106:107], v6 offset:5184
  v_mov_b32 v129, 0
  v_mfma_f32_16x16x32_bf16 v[100:103], a[184:187], a[212:215], v[100:103]
  ds_read_b64_tr_b16 a[108:109], v7 offset:96
  v_mfma_f32_16x16x32_bf16 v[104:107], a[184:187], a[216:219], v[104:107]
  ds_read_b64_tr_b16 a[110:111], v7 offset:5216
  v_mov_b32 v130, 0
  v_mfma_f32_16x16x32_bf16 v[108:111], a[184:187], a[220:223], v[108:111]
  ds_read_b64_tr_b16 a[112:113], v6 offset:128
  v_mov_b32 v131, 0
  v_mfma_f32_16x16x32_bf16 v[112:115], a[188:191], a[212:215], v[112:115]
  ds_read_b64_tr_b16 a[114:115], v6 offset:5248
  v_mfma_f32_16x16x32_bf16 v[116:119], a[188:191], a[216:219], v[116:119]
  ds_read_b128 a[148:151], v8 offset:6144
  v_mov_b32 v132, 0
  v_mfma_f32_16x16x32_bf16 v[120:123], a[188:191], a[220:223], v[120:123]
  ds_read_b128 a[152:155], v8 offset:7168
  v_mfma_f32_16x16x32_bf16 v[64:67], a[192:195], a[224:227], v[64:67]
  ds_read_b128 a[156:159], v8 offset:8192
  v_mov_b32 v133, 0
  v_mfma_f32_16x16x32_bf16 v[68:71], a[192:195], a[228:231], v[68:71]
  ds_read_b64_tr_b16 a[116:117], v6 offset:10240
  v_mov_b32 v134, 0
  v_mfma_f32_16x16x32_bf16 v[72:75], a[192:195], a[232:235], v[72:75]
  ds_read_b64_tr_b16 a[118:119], v6 offset:15360
L_ws151:
  s_cbranch_execz L_wb_back
  v_mfma_f32_16x16x32_bf16 v[76:79], a[196:199], a[224:227], v[76:79]
  ds_read_b64_tr_b16 a[120:121], v7 offset:10272
  v_mov_b32 v135, 0
  v_mfma_f32_16x16x32_bf16 v[80:83], a[196:199], a[228:231], v[80:83]
  ds_read_b64_tr_b16 a[122:123], v7 offset:15392
  v_mfma_f32_16x16x32_bf16 v[84:87], a[196:199], a[232:235], v[84:87]
  ds_read_b64_tr_b16 a[124:125], v6 offset:10304
  v_mov_b32 v136, 0
  v_mfma_f32_16x16x32_bf16 v[88:91], a[200:203], a[224:227], v[88:91]
  ds_read_b64_tr_b16 a[126:127], v6 offset:15424
  v_mov_b32 v137, 0
  v_mfma_f32_16x16x32_bf16 v[92:95], a[200:203], a[228:231], v[92:95]
  ds_read_b64_tr_b16 a[128:129], v7 offset:10336
  v_mfma_f32_16x16x32_bf16 v[96:99], a[200:203], a[232:235], v[96:99]
  ds_read_b64_tr_b16 a[130:131], v7 offset:15456
  v_mov_b32 v138, 0
  v_mfma_f32_16x16x32_bf16 v[100:103], a[204:207], a[224:227], v[100:103]
  ds_read_b64_tr_b16 a[132:133], v6 offset:10368
  v_mfma_f32_16x16x32_bf16 v[104:107], a[204:207], a[228:231], v[104:107]
  ds_read_b64_tr_b16 a[134:135], v6 offset:15488
  v_mov_b32 v139, 0
  v_mfma_f32_16x16x32_bf16 v[108:111], a[204:207], a[232:235], v[108:111]
  v_mov_b32 v140, 0
  v_mfma_f32_16x16x32_bf16 v[112:115], a[208:211], a[224:227], v[112:115]
  v_mfma_f32_16x16x32_bf16 v[116:119], a[208:211], a[228:231], v[116:119]
  v_mov_b32 v141, 0
  v_mfma_f32_16x16x32_bf16 v[120:123], a[208:211], a[232:235], v[120:123]
  s_waitcnt lgkmcnt(0)
  s_barrier
  buffer_load_dword v62, v60, s[24:27], s85 offen sc1
  v_mfma_f32_16x16x32_bf16 v[64:67], a[96:99], a[136:139], v[64:67]
  v_mfma_f32_16x16x32_bf16 v[68:71], a[96:99], a[140:143], v[68:71]
  v_mfma_f32_16x16x32_bf16 v[72:75], a[96:99], a[144:147], v[72:75]
  v_mfma_f32_16x16x32_bf16 v[64:67], a[116:119], a[148:151], v[64:67]
  v_mfma_f32_16x16x32_bf16 v[68:71], a[116:119], a[152:155], v[68:71]
  v_mfma_f32_16x16x32_bf16 v[72:75], a[116:119], a[156:159], v[72:75]
L_ws152:
  s_cbranch_execz L_wb_back
  v_mfma_f32_16x16x32_bf16 v[76:79], a[100:103], a[136:139], v[76:79]
  v_mfma_f32_16x16x32_bf16 v[80:83], a[100:103], a[140:143], v[80:83]
  v_mfma_f32_16x16x32_bf16 v[84:87], a[100:103], a[144:147], v[84:87]
  v_mfma_f32_16x16x32_bf16 v[76:79], a[120:123], a[148:151], v[76:79]
  v_cvt_pk_bf16_f32 v187, v68, v69
  v_cvt_pk_bf16_f32 v184, v64, v65
  v_cvt_pk_bf16_f32 v186, v66, v67
  v_mfma_f32_16x16x32_bf16 v[80:83], a[120:123], a[152:155], v[80:83]
  v_bfi_b32 v185, s80, v187, v31
  v_alignbit_b32 v187, v31, v187, 16
  buffer_store_dwordx4 v[184:187], v27, s[24:27], s72 offen offset:0 sc1
  v_mfma_f32_16x16x32_bf16 v[84:87], a[120:123], a[156:159], v[84:87]
  v_cvt_pk_bf16_f32 v191, v70, v71
  v_cvt_pk_bf16_f32 v188, v72, v73
  v_cvt_pk_bf16_f32 v190, v74, v75
  v_mfma_f32_16x16x32_bf16 v[88:91], a[104:107], a[136:139], v[88:91]
  v_bfi_b32 v189, s80, v191, v31
  v_alignbit_b32 v191, v31, v191, 16
  buffer_store_dwordx4 v[188:191], v27, s[24:27], s72 offen offset:1024 sc1
  v_mfma_f32_16x16x32_bf16 v[92:95], a[104:107], a[140:143], v[92:95]
  v_cvt_pk_bf16_f32 v195, v80, v81
  v_cvt_pk_bf16_f32 v192, v76, v77
  v_cvt_pk_bf16_f32 v194, v78, v79
  v_mfma_f32_16x16x32_bf16 v[96:99], a[104:107], a[144:147], v[96:99]
  v_bfi_b32 v193, s80, v195, v31
  v_alignbit_b32 v195, v31, v195, 16
  buffer_store_dwordx4 v[192:195], v27, s[24:27], s72 offen offset:2048 sc1
  v_mfma_f32_16x16x32_bf16 v[88:91], a[124:127], a[148:151], v[88:91]
  v_cvt_pk_bf16_f32 v199, v82, v83
  v_cvt_pk_bf16_f32 v196, v84, v85
  v_cvt_pk_bf16_f32 v198, v86, v87
  v_mfma_f32_16x16x32_bf16 v[92:95], a[124:127], a[152:155], v[92:95]
L_ws153:
  s_cbranch_execz L_wb_back
  v_bfi_b32 v197, s80, v199, v31
  v_alignbit_b32 v199, v31, v199, 16
  buffer_store_dwordx4 v[196:199], v27, s[24:27], s72 offen offset:3072 sc1
  v_mfma_f32_16x16x32_bf16 v[96:99], a[124:127], a[156:159], v[96:99]
  v_mfma_f32_16x16x32_bf16 v[100:103], a[108:111], a[136:139], v[100:103]
  v_mfma_f32_16x16x32_bf16 v[104:107], a[108:111], a[140:143], v[104:107]
  v_mfma_f32_16x16x32_bf16 v[108:111], a[108:111], a[144:147], v[108:111]
  v_mfma_f32_16x16x32_bf16 v[100:103], a[128:131], a[148:151], v[100:103]
  v_cvt_pk_bf16_f32 v203, v92, v93
  v_cvt_pk_bf16_f32 v200, v88, v89
  v_cvt_pk_bf16_f32 v202, v90, v91
  v_mfma_f32_16x16x32_bf16 v[104:107], a[128:131], a[152:155], v[104:107]
  v_bfi_b32 v201, s80, v203, v31
  v_alignbit_b32 v203, v31, v203, 16
  s_add_u32 s72, s72, 4096
  v_mfma_f32_16x16x32_bf16 v[108:111], a[128:131], a[156:159], v[108:111]
  buffer_store_dwordx4 v[200:203], v27, s[24:27], s72 offen offset:0 sc1
  v_cvt_pk_bf16_f32 v207, v94, v95
  v_cvt_pk_bf16_f32 v204, v96, v97
  v_mfma_f32_16x16x32_bf16 v[112:115], a[112:115], a[136:139], v[112:115]
  v_cvt_pk_bf16_f32 v206, v98, v99
  v_bfi_b32 v205, s80, v207, v31
  v_alignbit_b32 v207, v31, v207, 16
  v_mfma_f32_16x16x32_bf16 v[116:119], a[112:115], a[140:143], v[116:119]
  buffer_store_dwordx4 v[204:207], v27, s[24:27], s72 offen offset:1024 sc1
  v_cvt_pk_bf16_f32 v211, v104, v105
  v_cvt_pk_bf16_f32 v208, v100, v101
  v_mfma_f32_16x16x32_bf16 v[120:123], a[112:115], a[144:147], v[120:123]
  v_cvt_pk_bf16_f32 v210, v102, v103
  v_bfi_b32 v209, s80, v211, v31
  v_alignbit_b32 v211, v31, v211, 16
L_ws154:
  s_cbranch_execz L_wb_back
  v_mfma_f32_16x16x32_bf16 v[112:115], a[132:135], a[148:151], v[112:115]
  buffer_store_dwordx4 v[208:211], v27, s[24:27], s72 offen offset:2048 sc1
  v_cvt_pk_bf16_f32 v215, v106, v107
  v_cvt_pk_bf16_f32 v212, v108, v109
  v_mfma_f32_16x16x32_bf16 v[116:119], a[132:135], a[152:155], v[116:119]
  v_cvt_pk_bf16_f32 v214, v110, v111
  v_bfi_b32 v213, s80, v215, v31
  v_alignbit_b32 v215, v31, v215, 16
  v_mfma_f32_16x16x32_bf16 v[120:123], a[132:135], a[156:159], v[120:123]
  buffer_store_dwordx4 v[212:215], v27, s[24:27], s72 offen offset:3072 sc1
  s_nop 10
  v_cvt_pk_bf16_f32 v219, v116, v117
  v_cvt_pk_bf16_f32 v216, v112, v113
  v_cvt_pk_bf16_f32 v218, v114, v115
  v_bfi_b32 v217, s80, v219, v31
  v_alignbit_b32 v219, v31, v219, 16
  s_add_u32 s72, s72, 4096
  buffer_store_dwordx4 v[216:219], v27, s[24:27], s72 offen offset:0 sc1
  v_cvt_pk_bf16_f32 v223, v118, v119
  v_cvt_pk_bf16_f32 v220, v120, v121
  v_cvt_pk_bf16_f32 v222, v122, v123
  v_bfi_b32 v221, s80, v223, v31
  v_alignbit_b32 v223, v31, v223, 16
  buffer_store_dwordx4 v[220:223], v27, s[24:27], s72 offen offset:1024 sc1
  s_mov_b32 s7, 0
  s_waitcnt vmcnt(10)
  v_cmp_eq_u32 vcc, s60, v62
  s_andn2_b32 s37, vcc_lo, s7
  s_and_b32 s37, s37, 15
  s_and_b32 s3, s2, 3
  s_bitset1_b32 s37, s3
  s_or_b32 s7, s7, s37
  s_bitcmp1_b32 s37, 0
  s_cbranch_scc0 L_ara0
  s_add_u32 s3, s73, 0
  s_add_u32 s4, s74, 0
  buffer_load_dwordx4 v[64:67], v27, s[24:27], s3 offen offset:0 sc1
  buffer_load_dwordx4 v[80:83], v27, s[24:27], s3 offen offset:1024 sc1
L_ws155:
  s_cbranch_execz L_wb_back
  buffer_load_dwordx4 v[96:99], v27, s[24:27], s4 offen offset:0 sc1
L_ara0:
  s_bitcmp1_b32 s37, 1
  s_cbranch_scc0 L_ara1
  s_add_u32 s3, s73, 10240
  s_add_u32 s4, s74, 10240
  buffer_load_dwordx4 v[68:71], v27, s[24:27], s3 offen offset:0 sc1
  buffer_load_dwordx4 v[84:87], v27, s[24:27], s3 offen offset:1024 sc1
  buffer_load_dwordx4 v[100:103], v27, s[24:27], s4 offen offset:0 sc1
L_ara1:
  s_bitcmp1_b32 s37, 2
  s_cbranch_scc0 L_ara2
  s_add_u32 s3, s73, 20480
  s_add_u32 s4, s74, 20480
  buffer_load_dwordx4 v[72:75], v27, s[24:27], s3 offen offset:0 sc1
  buffer_load_dwordx4 v[88:91], v27, s[24:27], s3 offen offset:1024 sc1
  buffer_load_dwordx4 v[104:107], v27, s[24:27], s4 offen offset:0 sc1
L_ara2:
  s_bitcmp1_b32 s37, 3
  s_cbranch_scc0 L_ara3
  s_add_u32 s3, s73, 30720
  s_add_u32 s4, s74, 30720
  buffer_load_dwordx4 v[76:79], v27, s[24:27], s3 offen offset:0 sc1
  buffer_load_dwordx4 v[92:95], v27, s[24:27], s3 offen offset:1024 sc1
  buffer_load_dwordx4 v[108:111], v27, s[24:27], s4 offen offset:0 sc1
L_ara3:
  s_cmp_eq_u32 s7, 15
  s_cbranch_scc1 L_ara
  buffer_load_dword v62, v60, s[24:27], s85 offen sc1
L_ara:
  s_mov_b32 s42, 65536
  s_mov_b32 s5, 0
L_gather:
  s_mov_b32 s6, 0
  s_andn2_b32 s47, s7, s5
  s_waitcnt vmcnt(0)
  s_bitcmp1_b32 s47, 0
  s_cbranch_scc0 L_gc0
  v_perm_b32 v58, v65, v67, s81
  v_sad_u32 v63, v58, v31, 0
  v_perm_b32 v58, v81, v83, s81
  v_sad_u32 v63, v58, v31, v63
  v_perm_b32 v58, v97, v99, s81
  v_sad_u32 v63, v58, v31, v63
  v_cmp_ne_u32 vcc, 0, v63
L_ws156:
  s_cbranch_execz L_wb_back
  s_cbranch_vccz L_gn0
  s_add_u32 s3, s73, 0
  s_add_u32 s4, s74, 0
  buffer_load_dwordx4 v[64:67], v27, s[24:27], s3 offen offset:0 sc1
  buffer_load_dwordx4 v[80:83], v27, s[24:27], s3 offen offset:1024 sc1
  buffer_load_dwordx4 v[96:99], v27, s[24:27], s4 offen offset:0 sc1
  s_branch L_gc0
L_gn0:
  s_bitset1_b32 s6, 0
L_gc0:
  s_bitcmp1_b32 s47, 1
  s_cbranch_scc0 L_gc1
  v_perm_b32 v58, v69, v71, s81
  v_sad_u32 v63, v58, v31, 0
  v_perm_b32 v58, v85, v87, s81
  v_sad_u32 v63, v58, v31, v63
  v_perm_b32 v58, v101, v103, s81
  v_sad_u32 v63, v58, v31, v63
  v_cmp_ne_u32 vcc, 0, v63
  s_cbranch_vccz L_gn1
  s_add_u32 s3, s73, 10240
  s_add_u32 s4, s74, 10240
  buffer_load_dwordx4 v[68:71], v27, s[24:27], s3 offen offset:0 sc1
  buffer_load_dwordx4 v[84:87], v27, s[24:27], s3 offen offset:1024 sc1
  buffer_load_dwordx4 v[100:103], v27, s[24:27], s4 offen offset:0 sc1
  s_branch L_gc1
L_gn1:
  s_bitset1_b32 s6, 1
L_gc1:
  s_bitcmp1_b32 s47, 2
  s_cbranch_scc0 L_gc2
  v_perm_b32 v58, v73, v75, s81
  v_sad_u32 v63, v58, v31, 0
  v_perm_b32 v58, v89, v91, s81
  v_sad_u32 v63, v58, v31, v63
  v_perm_b32 v58, v105, v107, s81
  v_sad_u32 v63, v58, v31, v63
  v_cmp_ne_u32 vcc, 0, v63
  s_cbranch_vccz L_gn2
  s_add_u32 s3, s73, 20480
  s_add_u32 s4, s74, 20480
  buffer_load_dwordx4 v[72:75], v27, s[24:27], s3 offen offset:0 sc1
  buffer_load_dwordx4 v[88:91], v27, s[24:27], s3 offen offset:1024 sc1
L_ws157:
  s_cbranch_execz L_wb_back
  buffer_load_dwordx4 v[104:107], v27, s[24:27], s4 offen offset:0 sc1
  s_branch L_gc2
L_gn2:
  s_bitset1_b32 s6, 2
L_gc2:
  s_bitcmp1_b32 s47, 3
  s_cbranch_scc0 L_gc3
  v_perm_b32 v58, v77, v79, s81
  v_sad_u32 v63, v58, v31, 0
  v_perm_b32 v58, v93, v95, s81
  v_sad_u32 v63, v58, v31, v63
  v_perm_b32 v58, v109, v111, s81
  v_sad_u32 v63, v58, v31, v63
  v_cmp_ne_u32 vcc, 0, v63
  s_cbranch_vccz L_gn3
  s_add_u32 s3, s73, 30720
  s_add_u32 s4, s74, 30720
  buffer_load_dwordx4 v[76:79], v27, s[24:27], s3 offen offset:0 sc1
  buffer_load_dwordx4 v[92:95], v27, s[24:27], s3 offen offset:1024 sc1
  buffer_load_dwordx4 v[108:111], v27, s[24:27], s4 offen offset:0 sc1
  s_branch L_gc3
L_gn3:
  s_bitset1_b32 s6, 3
L_gc3:
  s_cmp_eq_u32 s7, 15
  s_cbranch_scc1 L_arb
  v_cmp_eq_u32 vcc, s60, v62
  s_andn2_b32 s37, vcc_lo, s7
  s_and_b32 s37, s37, 15
  s_or_b32 s7, s7, s37
  s_bitcmp1_b32 s37, 0
  s_cbranch_scc0 L_arb0
  s_add_u32 s3, s73, 0
  s_add_u32 s4, s74, 0
  buffer_load_dwordx4 v[64:67], v27, s[24:27], s3 offen offset:0 sc1
  buffer_load_dwordx4 v[80:83], v27, s[24:27], s3 offen offset:1024 sc1
  buffer_load_dwordx4 v[96:99], v27, s[24:27], s4 offen offset:0 sc1
L_arb0:
  s_bitcmp1_b32 s37, 1
  s_cbranch_scc0 L_arb1
  s_add_u32 s3, s73, 10240
  s_add_u32 s4, s74, 10240
  buffer_load_dwordx4 v[68:71], v27, s[24:27], s3 offen offset:0 sc1
  buffer_load_dwordx4 v[84:87], v27, s[24:27], s3 offen offset:1024 sc1
  buffer_load_dwordx4 v[100:103], v27, s[24:27], s4 offen offset:0 sc1
L_arb1:
  s_bitcmp1_b32 s37, 2
  s_cbranch_scc0 L_arb2
  s_add_u32 s3, s73, 20480
L_ws158:
  s_cbranch_execz L_wb_back
  s_add_u32 s4, s74, 20480
  buffer_load_dwordx4 v[72:75], v27, s[24:27], s3 offen offset:0 sc1
  buffer_load_dwordx4 v[88:91], v27, s[24:27], s3 offen offset:1024 sc1
  buffer_load_dwordx4 v[104:107], v27, s[24:27], s4 offen offset:0 sc1
L_arb2:
  s_bitcmp1_b32 s37, 3
  s_cbranch_scc0 L_arb3
  s_add_u32 s3, s73, 30720
  s_add_u32 s4, s74, 30720
  buffer_load_dwordx4 v[76:79], v27, s[24:27], s3 offen offset:0 sc1
  buffer_load_dwordx4 v[92:95], v27, s[24:27], s3 offen offset:1024 sc1
  buffer_load_dwordx4 v[108:111], v27, s[24:27], s4 offen offset:0 sc1
L_arb3:
  s_cmp_eq_u32 s7, 15
  s_cbranch_scc1 L_arb
  buffer_load_dword v62, v60, s[24:27], s85 offen sc1
L_arb:
  s_bitcmp1_b32 s6, 0
  s_cbranch_scc0 L_ga0
  v_dot2_f32_bf16 v124, v64, s82, v124
  v_dot2_f32_bf16 v125, v64, s83, v125
  v_dot2_f32_bf16 v126, v66, s82, v126
  v_dot2_f32_bf16 v127, v66, s83, v127
  v_dot2_f32_bf16 v128, v65, s82, v128
  v_dot2_f32_bf16 v129, v67, s82, v129
  v_dot2_f32_bf16 v130, v80, s82, v130
  v_dot2_f32_bf16 v131, v80, s83, v131
  v_dot2_f32_bf16 v132, v82, s82, v132
  v_dot2_f32_bf16 v133, v82, s83, v133
  v_dot2_f32_bf16 v134, v81, s82, v134
  v_dot2_f32_bf16 v135, v83, s82, v135
  v_dot2_f32_bf16 v136, v96, s82, v136
  v_dot2_f32_bf16 v137, v96, s83, v137
  v_dot2_f32_bf16 v138, v98, s82, v138
  v_dot2_f32_bf16 v139, v98, s83, v139
  v_dot2_f32_bf16 v140, v97, s82, v140
  v_dot2_f32_bf16 v141, v99, s82, v141
L_ga0:
L_ws159:
  s_cbranch_execz L_wb_back
  s_bitcmp1_b32 s6, 1
  s_cbranch_scc0 L_ga1
  v_dot2_f32_bf16 v124, v68, s82, v124
  v_dot2_f32_bf16 v125, v68, s83, v125
  v_dot2_f32_bf16 v126, v70, s82, v126
  v_dot2_f32_bf16 v127, v70, s83, v127
  v_dot2_f32_bf16 v128, v69, s82, v128
  v_dot2_f32_bf16 v129, v71, s82, v129
  v_dot2_f32_bf16 v130, v84, s82, v130
  v_dot2_f32_bf16 v131, v84, s83, v131
  v_dot2_f32_bf16 v132, v86, s82, v132
  v_dot2_f32_bf16 v133, v86, s83, v133
  v_dot2_f32_bf16 v134, v85, s82, v134
  v_dot2_f32_bf16 v135, v87, s82, v135
  v_dot2_f32_bf16 v136, v100, s82, v136
  v_dot2_f32_bf16 v137, v100, s83, v137
  v_dot2_f32_bf16 v138, v102, s82, v138
  v_dot2_f32_bf16 v139, v102, s83, v139
  v_dot2_f32_bf16 v140, v101, s82, v140
  v_dot2_f32_bf16 v141, v103, s82, v141
L_ga1:
  s_bitcmp1_b32 s6, 2
  s_cbranch_scc0 L_ga2
  v_dot2_f32_bf16 v124, v72, s82, v124
  v_dot2_f32_bf16 v125, v72, s83, v125
  v_dot2_f32_bf16 v126, v74, s82, v126
  v_dot2_f32_bf16 v127, v74, s83, v127
  v_dot2_f32_bf16 v128, v73, s82, v128
  v_dot2_f32_bf16 v129, v75, s82, v129
  v_dot2_f32_bf16 v130, v88, s82, v130
  v_dot2_f32_bf16 v131, v88, s83, v131
  v_dot2_f32_bf16 v132, v90, s82, v132
  v_dot2_f32_bf16 v133, v90, s83, v133
  v_dot2_f32_bf16 v134, v89, s82, v134
  v_dot2_f32_bf16 v135, v91, s82, v135
L_ws160:
  s_cbranch_execz L_wb_back
  v_dot2_f32_bf16 v136, v104, s82, v136
  v_dot2_f32_bf16 v137, v104, s83, v137
  v_dot2_f32_bf16 v138, v106, s82, v138
  v_dot2_f32_bf16 v139, v106, s83, v139
  v_dot2_f32_bf16 v140, v105, s82, v140
  v_dot2_f32_bf16 v141, v107, s82, v141
L_ga2:
  s_bitcmp1_b32 s6, 3
  s_cbranch_scc0 L_ga3
  v_dot2_f32_bf16 v124, v76, s82, v124
  v_dot2_f32_bf16 v125, v76, s83, v125
  v_dot2_f32_bf16 v126, v78, s82, v126
  v_dot2_f32_bf16 v127, v78, s83, v127
  v_dot2_f32_bf16 v128, v77, s82, v128
  v_dot2_f32_bf16 v129, v79, s82, v129
  v_dot2_f32_bf16 v130, v92, s82, v130
  v_dot2_f32_bf16 v131, v92, s83, v131
  v_dot2_f32_bf16 v132, v94, s82, v132
  v_dot2_f32_bf16 v133, v94, s83, v133
  v_dot2_f32_bf16 v134, v93, s82, v134
  v_dot2_f32_bf16 v135, v95, s82, v135
  v_dot2_f32_bf16 v136, v108, s82, v136
  v_dot2_f32_bf16 v137, v108, s83, v137
  v_dot2_f32_bf16 v138, v110, s82, v138
  v_dot2_f32_bf16 v139, v110, s83, v139
  v_dot2_f32_bf16 v140, v109, s82, v140
  v_dot2_f32_bf16 v141, v111, s82, v141
L_ga3:
  s_or_b32 s5, s5, s6
  s_cmp_eq_u32 s5, 15
  s_cbranch_scc1 L_gdone
  s_sub_u32 s42, s42, 1
  s_cmp_lg_u32 s42, 0
  s_cbranch_scc1 L_gather
L_gdone:
  s_nop 2
  v_cvt_pk_bf16_f32 v144, v124, v125
  v_cvt_pk_bf16_f32 v145, v126, v127
  buffer_store_dwordx2 v[144:145], v9, s[52:55], s75 offen
L_ws161:
  s_cbranch_execz L_wb_back
  v_cvt_pk_bf16_f32 v146, v128, v129
  v_cvt_pk_bf16_f32 v147, v134, v135
  buffer_store_dwordx2 v[146:147], v9, s[52:55], s76 offen
  v_cvt_pk_bf16_f32 v148, v130, v131
  v_cvt_pk_bf16_f32 v149, v132, v133
  buffer_store_dwordx2 v[148:149], v9, s[52:55], s77 offen
  v_cvt_pk_bf16_f32 v150, v136, v137
  v_cvt_pk_bf16_f32 v151, v138, v139
  buffer_store_dwordx2 v[150:151], v9, s[52:55], s78 offen
  v_cvt_pk_bf16_f32 v152, v140, v141
  buffer_store_dword v152, v9, s[52:55], s79 offen
L_k1_end:
  s_endpgm
L_slow_non:
  s_mov_b32 s42, 65536
  v_and_b32 v58, 0, v1
  v_lshlrev_b32 v58, 2, v58
L_spin_non:
  buffer_load_dword v63, v58, s[56:59], s43 offen sc1
  s_waitcnt vmcnt(0)
  v_readfirstlane_b32 s60, v63
  s_cmp_lg_u32 s60, 0
  s_cbranch_scc1 L_back_non
  s_sub_u32 s42, s42, 1
  s_cmp_lg_u32 s42, 0
  s_cbranch_scc1 L_spin_non
  s_branch L_back_non
L_slow_o01:
  s_cmp_eq_u32 s61, 0
  s_cbranch_scc1 L_vs_o01
  s_mov_b32 s42, 24
L_ss_o01:
  s_buffer_load_dwordx2 s[64:65], s[24:27], s46 glc
  s_waitcnt lgkmcnt(0)
  s_xor_b32 s64, s64, s60
  s_xor_b32 s65, s65, s60
  s_or_b32 s64, s64, s65
  s_cmp_eq_u32 s64, 0
  s_cbranch_scc1 L_back_o01
  s_sub_u32 s42, s42, 1
  s_cmp_lg_u32 s42, 0
  s_cbranch_scc1 L_ss_o01
L_vs_o01:
  s_mov_b32 s42, 65536
  v_and_b32 v58, 1, v1
  v_lshlrev_b32 v58, 2, v58
L_spin_o01:
  buffer_load_dword v63, v58, s[24:27], s46 offen sc1
  s_waitcnt vmcnt(0)
  v_cmp_ne_u32 vcc, s60, v63
  s_cbranch_vccz L_back_o01
  s_sub_u32 s42, s42, 1
  s_cmp_lg_u32 s42, 0
L_ws162:
  s_cbranch_execz L_wb_back
  s_cbranch_scc1 L_spin_o01
  s_branch L_back_o01
L_slow_o02:
  s_cmp_eq_u32 s61, 0
  s_cbranch_scc1 L_vs_o02
  s_mov_b32 s42, 24
L_ss_o02:
  s_buffer_load_dwordx2 s[64:65], s[24:27], s46 glc
  s_waitcnt lgkmcnt(0)
  s_xor_b32 s64, s64, s60
  s_xor_b32 s65, s65, s60
  s_or_b32 s64, s64, s65
  s_cmp_eq_u32 s64, 0
  s_cbranch_scc1 L_back_o02
  s_sub_u32 s42, s42, 1
  s_cmp_lg_u32 s42, 0
  s_cbranch_scc1 L_ss_o02
L_vs_o02:
  s_mov_b32 s42, 65536
  v_and_b32 v58, 1, v1
  v_lshlrev_b32 v58, 2, v58
L_spin_o02:
  buffer_load_dword v63, v58, s[24:27], s46 offen sc1
  s_waitcnt vmcnt(0)
  v_cmp_ne_u32 vcc, s60, v63
  s_cbranch_vccz L_back_o02
  s_sub_u32 s42, s42, 1
  s_cmp_lg_u32 s42, 0
  s_cbranch_scc1 L_spin_o02
  s_branch L_back_o02
L_slow_o03:
  s_cmp_eq_u32 s61, 0
  s_cbranch_scc1 L_vs_o03
  s_mov_b32 s42, 24
L_ss_o03:
  s_buffer_load_dwordx2 s[64:65], s[24:27], s46 glc
  s_waitcnt lgkmcnt(0)
  s_xor_b32 s64, s64, s60
  s_xor_b32 s65, s65, s60
  s_or_b32 s64, s64, s65
  s_cmp_eq_u32 s64, 0
  s_cbranch_scc1 L_back_o03
  s_sub_u32 s42, s42, 1
  s_cmp_lg_u32 s42, 0
  s_cbranch_scc1 L_ss_o03
L_vs_o03:
  s_mov_b32 s42, 65536
  v_and_b32 v58, 1, v1
  v_lshlrev_b32 v58, 2, v58
L_spin_o03:
  buffer_load_dword v63, v58, s[24:27], s46 offen sc1
  s_waitcnt vmcnt(0)
  v_cmp_ne_u32 vcc, s60, v63
  s_cbranch_vccz L_back_o03
  s_sub_u32 s42, s42, 1
  s_cmp_lg_u32 s42, 0
  s_cbranch_scc1 L_spin_o03
  s_branch L_back_o03
L_slow_o11:
  s_bfe_u32 s46, s45, 0x20009
  s_lshl_b32 s46, s46, 6
  s_add_u32 s46, s46, s62
  s_add_u32 s46, s46, 2048
  s_cmp_eq_u32 s61, 0
L_ws163:
  s_cbranch_execz L_wb_back
  s_cbranch_scc1 L_vs_o11
  s_mov_b32 s42, 24
L_ss_o11:
  s_buffer_load_dwordx2 s[64:65], s[24:27], s46 glc
  s_waitcnt lgkmcnt(0)
  s_xor_b32 s64, s64, s60
  s_xor_b32 s65, s65, s60
  s_or_b32 s64, s64, s65
  s_cmp_eq_u32 s64, 0
  s_cbranch_scc1 L_back_o11
  s_sub_u32 s42, s42, 1
  s_cmp_lg_u32 s42, 0
  s_cbranch_scc1 L_ss_o11
L_vs_o11:
  s_mov_b32 s42, 65536
  v_and_b32 v58, 1, v1
  v_lshlrev_b32 v58, 2, v58
L_spin_o11:
  buffer_load_dword v63, v58, s[24:27], s46 offen sc1
  s_waitcnt vmcnt(0)
  v_cmp_ne_u32 vcc, s60, v63
  s_cbranch_vccz L_back_o11
  s_sub_u32 s42, s42, 1
  s_cmp_lg_u32 s42, 0
  s_cbranch_scc1 L_spin_o11
  s_branch L_back_o11
L_slow_o12:
  s_bfe_u32 s46, s45, 0x20011
  s_lshl_b32 s46, s46, 6
  s_add_u32 s46, s46, s62
  s_add_u32 s46, s46, 2048
  s_cmp_eq_u32 s61, 0
  s_cbranch_scc1 L_vs_o12
  s_mov_b32 s42, 24
L_ss_o12:
  s_buffer_load_dwordx2 s[64:65], s[24:27], s46 glc
  s_waitcnt lgkmcnt(0)
  s_xor_b32 s64, s64, s60
  s_xor_b32 s65, s65, s60
  s_or_b32 s64, s64, s65
  s_cmp_eq_u32 s64, 0
  s_cbranch_scc1 L_back_o12
  s_sub_u32 s42, s42, 1
  s_cmp_lg_u32 s42, 0
  s_cbranch_scc1 L_ss_o12
L_vs_o12:
  s_mov_b32 s42, 65536
  v_and_b32 v58, 1, v1
  v_lshlrev_b32 v58, 2, v58
L_spin_o12:
  buffer_load_dword v63, v58, s[24:27], s46 offen sc1
  s_waitcnt vmcnt(0)
  v_cmp_ne_u32 vcc, s60, v63
  s_cbranch_vccz L_back_o12
  s_sub_u32 s42, s42, 1
  s_cmp_lg_u32 s42, 0
  s_cbranch_scc1 L_spin_o12
  s_branch L_back_o12
L_slow_o13:
  s_bfe_u32 s46, s45, 0x20019
  s_lshl_b32 s46, s46, 6
  s_add_u32 s46, s46, s62
L_ws164:
  s_cbranch_execz L_wb_back
  s_add_u32 s46, s46, 2048
  s_cmp_eq_u32 s61, 0
  s_cbranch_scc1 L_vs_o13
  s_mov_b32 s42, 24
L_ss_o13:
  s_buffer_load_dwordx2 s[64:65], s[24:27], s46 glc
  s_waitcnt lgkmcnt(0)
  s_xor_b32 s64, s64, s60
  s_xor_b32 s65, s65, s60
  s_or_b32 s64, s64, s65
  s_cmp_eq_u32 s64, 0
  s_cbranch_scc1 L_back_o13
  s_sub_u32 s42, s42, 1
  s_cmp_lg_u32 s42, 0
  s_cbranch_scc1 L_ss_o13
L_vs_o13:
  s_mov_b32 s42, 65536
  v_and_b32 v58, 1, v1
  v_lshlrev_b32 v58, 2, v58
L_spin_o13:
  buffer_load_dword v63, v58, s[24:27], s46 offen sc1
  s_waitcnt vmcnt(0)
  v_cmp_ne_u32 vcc, s60, v63
  s_cbranch_vccz L_back_o13
  s_sub_u32 s42, s42, 1
  s_cmp_lg_u32 s42, 0
  s_cbranch_scc1 L_spin_o13
  s_branch L_back_o13
  s_endpgm
.set L_wa_base, L_ws0-0
.set L_wb_base, L_ws128-4
.section .rodata,"a"
.p2align 6
.amdhsa_kernel concat_heads__gqa_block_cached__gqa_block_cached__near_ridge_kernel
  .amdhsa_next_free_vgpr 512
  .amdhsa_next_free_sgpr 102
  .amdhsa_accum_offset 256
  .amdhsa_group_segment_fixed_size 0
  .amdhsa_kernarg_size 104
  .amdhsa_user_sgpr_count 2
  .amdhsa_user_sgpr_kernarg_segment_ptr 1
  .amdhsa_system_sgpr_workgroup_id_x 1
.end_amdhsa_kernel
```
